```python
import torch

def _softmax(x, axis=-1):
    return torch.softmax(x, dim=axis)
def _gelu(x):
    return torch.nn.functional.gelu(x, approximate="tanh")
def _silu(x):
    return torch.nn.functional.silu(x)
def _sigmoid(x):
    return torch.sigmoid(x)
def _layernorm(x, axis=-1, eps=1e-5):
    m = x.mean(dim=axis, keepdim=True)
    v = x.var(dim=axis, keepdim=True, unbiased=False)
    return (x - m) / torch.sqrt(v + eps)
def _scatter_add(tgt, idx, src, axis=0):
    return tgt.clone().index_add_(axis, idx, src)
def _segment_sum(src, seg, n):
    out = torch.zeros((n,) + src.shape[1:], dtype=src.dtype)
    return out.index_add_(0, seg, src)
def _pad(x, pw):
    flat = tuple(v for pair in reversed(pw) for v in pair)
    return torch.nn.functional.pad(x, flat)

kernel_name = 'interleave_layers__sliding_local_dilated__ssm_conv_s4d__prompt'

def setup_inputs():

    _w = (lambda a: (lambda t: t.to(torch.bfloat16) if t.is_floating_point() else t)(torch.as_tensor(a)))
    def _A_setup():
        B, S, D = 1, 2048, 512
        return {
            "x": _w((lambda *s: torch.randn(*s, dtype=torch.bfloat16) * 0.05)(B, S, D)),
            "wqkv": _w((lambda *s: torch.randn(*s, dtype=torch.bfloat16) * 0.05)(D, 3 * D)),
            "wo": _w((lambda *s: torch.randn(*s, dtype=torch.bfloat16) * 0.05)(D, D)),
        }
    _A_in = _A_setup()

    def _B_setup():
        Bsz, L, D, N = 1, 2048, 512, 128
        return {
            "u": _w((lambda *s: torch.randn(*s, dtype=torch.bfloat16) * 0.05)(Bsz, L, D)),
            "log_A_real": _w((lambda *s: torch.randn(*s, dtype=torch.bfloat16) * 6.4)(D, N) * 0.5),
            "A_imag": _w((lambda *s: torch.randn(*s, dtype=torch.bfloat16) * 0.1)(D, N) * 3.14),
            "C_real": _w((lambda *s: torch.randn(*s, dtype=torch.bfloat16) * 0.1)(D, N) / N ** 0.5),
            "C_imag": _w((lambda *s: torch.randn(*s, dtype=torch.bfloat16) * 0.1)(D, N) / N ** 0.5),
            "log_dt": _w((lambda *s: torch.randn(*s, dtype=torch.bfloat16) * 0.1)(D) * 0.5 - 4.0),
            "D_skip": _w((lambda *s: torch.randn(*s, dtype=torch.bfloat16) * 0.1)(D)),
        }
    _B_in = _B_setup()

    return {
        "A_x": _A_in["x"],
        "A_wqkv": _A_in["wqkv"],
        "A_wo": _A_in["wo"],
        "B_u": _B_in["u"],
        "B_log_A_real": _B_in["log_A_real"],
        "B_A_imag": _B_in["A_imag"],
        "B_C_real": _B_in["C_real"],
        "B_C_imag": _B_in["C_imag"],
        "B_log_dt": _B_in["log_dt"],
        "B_D_skip": _B_in["D_skip"],
    }

def reference(A_x, A_wqkv, A_wo, B_u, B_log_A_real, B_A_imag, B_C_real, B_C_imag, B_log_dt, B_D_skip):
    def _A_ref(x, wqkv, wo):
        B, S, D = x.shape
        H = 32; Dh = D // H
        W, dil = 8, 2
        qkv = (lambda x, *d: x.permute(*d))((x @ wqkv).reshape(B, S, 3, H, Dh), 2, 0, 3, 1, 4)
        q, k, v = qkv[0], qkv[1], qkv[2]
        scale = Dh ** -0.5
        pos = torch.arange(S)
        off = torch.arange(W) * dil
        idx = pos[:, None] - off[None, :]
        mask = idx >= 0
        idx_c = torch.where(mask, idx, 0).reshape(-1)
        kg = k[:, :, idx_c, :].reshape(B, H, S, W, Dh)
        vg = v[:, :, idx_c, :].reshape(B, H, S, W, Dh)
        logits = torch.einsum("bhsd,bhswd->bhsw", q, kg) * scale
        logits = torch.where(mask[None, None, :, :], logits, -1e9)
        attn = _softmax(logits, axis=-1)
        o = torch.einsum("bhsw,bhswd->bhsd", attn, vg)
        return (lambda x, *d: x.permute(*d))(o, 0, 2, 1, 3).reshape(B, S, D) @ wo

    def _B_ref(u, log_A_real, A_imag, C_real, C_imag, log_dt, D_skip):
        L = u.shape[1]
        dt = torch.exp(log_dt)
        A = -torch.exp(log_A_real) + 1j * A_imag
        C = (C_real + 1j * C_imag) * dt[:, None]
        pos = (lambda x, dt: x.to(dt))(torch.arange(L), log_dt.dtype)
        P = torch.exp((A * dt[:, None])[:, :, None] * pos[None, None, :])
        K = 2.0 * torch.einsum("dn,dnl->dl", C, P).real
        L2 = 2 * L
        u_t = (lambda x, *d: x.permute(*d))(u, 0, 2, 1)
        Kf = (lambda x, *a, **k: torch.fft.rfft(x.float(), *a, **k))(K, L2)
        Uf = (lambda x, *a, **k: torch.fft.rfft(x.float(), *a, **k))(u_t, L2)
        y = (lambda x, *a, **k: torch.fft.irfft(x, *a, **k).to(torch.bfloat16))(Uf * Kf[None, :, :], L2)[:, :, :L]
        y = (lambda x, *d: x.permute(*d))(y, 0, 2, 1)
        return y + u * D_skip[None, None, :]

    x = A_x
    x = x + _A_ref(_layernorm(x, axis=-1), A_wqkv, A_wo)
    x = x + _B_ref(_layernorm(x, axis=-1), B_log_A_real, B_A_imag, B_C_real, B_C_imag, B_log_dt, B_D_skip)
    x = x + _A_ref(_layernorm(x, axis=-1), A_wqkv, A_wo)
    x = x + _B_ref(_layernorm(x, axis=-1), B_log_A_real, B_A_imag, B_C_real, B_C_imag, B_log_dt, B_D_skip)
    return x
```

```asm
; @launch grid=(256,1,1) block=(512,1,1) lds=157968
.amdgcn_target "amdgcn-amd-amdhsa--gfx950"
.text
.globl interleave_layers__sliding_local_dilated__ssm_conv_s4d__prompt_kernel
.p2align 8
.type interleave_layers__sliding_local_dilated__ssm_conv_s4d__prompt_kernel,@function
interleave_layers__sliding_local_dilated__ssm_conv_s4d__prompt_kernel:

    s_cmp_ge_u32 s2, 256
    s_cbranch_scc1 PK_END
    s_load_dwordx4 s[4:7], s[0:1], 0
    s_load_dwordx2 s[8:9], s[0:1], 96
    s_load_dwordx2 s[50:51], s[0:1], 72
    s_load_dwordx2 s[64:65], s[0:1], 16
    s_load_dwordx2 s[66:67], s[0:1], 80
    v_and_b32 v1, 63, v0
    v_lshrrev_b32 v11, 6, v0
    s_nop 0
    v_readfirstlane_b32 s28, v11
    s_and_b32 s35, s2, 7
    s_lshr_b32 s36, s2, 3
    s_lshr_b32 s31, s35, 1
    s_lshl_b32 s31, s31, 3
    s_and_b32 s37, s36, 7
    s_add_u32 s31, s31, s37
    s_and_b32 s32, s35, 1
    s_lshl_b32 s32, s32, 2
    s_lshr_b32 s37, s36, 3
    s_add_u32 s32, s32, s37
    s_lshl_b32 s33, s35, 5
    s_add_u32 s33, s33, s36
    v_and_b32 v2, 15, v1
    v_lshrrev_b32 v3, 4, v1
    s_lshr_b32 s29, s28, 2
    s_and_b32 s30, s28, 3
A1L0_BEGIN:
    s_cmp_lt_u32 s28, 4
    s_cbranch_scc1 A1L0_C
    v_lshrrev_b32 v11, 3, v1
    v_mul_u32_u24 v14, 3072, v11
    v_and_b32 v15, 1, v3
    v_lshrrev_b32 v13, 1, v1
    v_and_b32 v13, 3, v13
    v_xor_b32 v13, v13, v15
    v_lshlrev_b32 v13, 5, v13
    v_and_b32 v12, 1, v1
    v_lshlrev_b32 v12, 4, v12
    v_add_u32 v14, v14, v12
    s_lshl_b32 s35, s32, 7
    v_add_u32 v14, s35, v14
    v_add_u32 v7, v14, v13
    v_xor_b32 v13, 64, v13
    v_add_u32 v8, v14, v13
    v_and_b32 v13, 7, v1
    v_xor_b32 v13, v13, v3
    v_lshlrev_b32 v13, 4, v13
    v_xor_b32 v12, 64, v13
    s_lshl_b32 s35, s31, 6
    s_sub_u32 s35, s35, 16
    v_add_u32 v11, s35, v11
    v_lshlrev_b32 v11, 10, v11
    s_mov_b32 s46, 0xffffff00
    s_mov_b32 s47, -1
    s_cmp_eq_u32 s28, 5
    s_cbranch_scc1 A1L0_L1
    s_cmp_eq_u32 s28, 6
    s_cbranch_scc1 A1L0_L2
    s_cmp_eq_u32 s28, 7
    s_cbranch_scc1 A1L0_L3
A1L0_L0:
    v_add_u32 v4, 0, v11
    v_add_u32 v4, v4, v13
    v_add_u32 v5, 8192, v11
    v_add_u32 v5, v5, v12
    v_add_u32 v6, 16384, v11
    v_add_u32 v6, v6, v13
    s_waitcnt lgkmcnt(0)
    s_mov_b32 s12, s4
    s_mov_b32 s13, s5
    s_mov_b32 s14, 2097152
    s_mov_b32 s15, 0x20000
    s_mov_b32 s16, s6
    s_mov_b32 s17, s7
    s_mov_b32 s18, 1572864
    s_mov_b32 s19, 0x20000
    s_mov_b32 m0, 0
    s_mov_b32 s44, 0
    s_mov_b64 exec, s[46:47]
    buffer_load_dwordx4 v4, s[12:15], s44 offen lds
    s_mov_b64 exec, -1
    s_mov_b32 m0, 1024
    s_mov_b32 s44, 0
    buffer_load_dwordx4 v5, s[12:15], s44 offen lds
    s_mov_b32 m0, 2048
    s_mov_b32 s44, 0
    buffer_load_dwordx4 v6, s[12:15], s44 offen lds
    s_mov_b32 m0, 49152
    s_mov_b32 s45, 0
    buffer_load_dwordx4 v7, s[16:19], s45 offen lds
    s_mov_b32 m0, 50176
    s_mov_b32 s45, 24576
    buffer_load_dwordx4 v8, s[16:19], s45 offen lds
    s_mov_b32 m0, 57344
    s_mov_b32 s45, 1024
    buffer_load_dwordx4 v7, s[16:19], s45 offen lds
    s_mov_b32 m0, 58368
    s_mov_b32 s45, 25600
    buffer_load_dwordx4 v8, s[16:19], s45 offen lds
    s_mov_b32 m0, 65536
    s_mov_b32 s45, 2048
    buffer_load_dwordx4 v7, s[16:19], s45 offen lds
    s_mov_b32 m0, 66560
    s_mov_b32 s45, 26624
    buffer_load_dwordx4 v8, s[16:19], s45 offen lds
    s_mov_b32 m0, 10240
    s_mov_b32 s44, 128
    s_mov_b64 exec, s[46:47]
    buffer_load_dwordx4 v4, s[12:15], s44 offen lds
    s_mov_b64 exec, -1
    s_mov_b32 m0, 11264
    s_mov_b32 s44, 128
    buffer_load_dwordx4 v5, s[12:15], s44 offen lds
    s_mov_b32 m0, 12288
    s_mov_b32 s44, 128
    buffer_load_dwordx4 v6, s[12:15], s44 offen lds
    s_mov_b32 m0, 73728
    s_mov_b32 s45, 196608
    buffer_load_dwordx4 v7, s[16:19], s45 offen lds
    s_mov_b32 m0, 74752
    s_mov_b32 s45, 221184
    buffer_load_dwordx4 v8, s[16:19], s45 offen lds
    s_mov_b32 m0, 81920
    s_mov_b32 s45, 197632
    buffer_load_dwordx4 v7, s[16:19], s45 offen lds
    s_mov_b32 m0, 82944
    s_mov_b32 s45, 222208
    buffer_load_dwordx4 v8, s[16:19], s45 offen lds
    s_mov_b32 m0, 90112
    s_mov_b32 s45, 198656
    buffer_load_dwordx4 v7, s[16:19], s45 offen lds
    s_mov_b32 m0, 91136
    s_mov_b32 s45, 223232
    buffer_load_dwordx4 v8, s[16:19], s45 offen lds
    s_load_dword s34, s[8:9], 0
    s_lshl_b32 s35, s33, 2
    s_load_dword s68, s[50:51], s35
    s_add_u32 s72, s8, 65536
    s_addc_u32 s73, s9, 0
    s_mov_b32 s74, 163840
    s_mov_b32 s75, 0x20000
    v_lshrrev_b32 v11, 3, v1
    v_lshlrev_b32 v11, 10, v11
    v_and_b32 v12, 1, v3
    v_lshrrev_b32 v13, 1, v1
    v_and_b32 v13, 3, v13
    v_xor_b32 v13, v13, v12
    v_lshlrev_b32 v13, 5, v13
    v_and_b32 v14, 1, v1
    v_lshlrev_b32 v14, 4, v14
    v_add_u32 v11, v11, v14
    s_lshl_b32 s35, s32, 7
    v_add_u32 v11, s35, v11
    v_add_u32 v224, v11, v13
    v_xor_b32 v13, 64, v13
    v_add_u32 v11, 8192, v11
    v_add_u32 v225, v11, v13
    s_mov_b32 s24, s64
    s_mov_b32 s25, s65
    s_mov_b32 s26, 524288
    s_mov_b32 s27, 0x20000
    s_mov_b32 s71, 0
    v_mov_b32 v250, 157956
    v_mov_b32 v251, 0
    ds_write_b32 v250, v251
    s_waitcnt vmcnt(9)
    s_barrier
    s_mov_b32 m0, 20480
    s_mov_b32 s44, 256
    s_mov_b64 exec, s[46:47]
    buffer_load_dwordx4 v4, s[12:15], s44 offen lds
    s_mov_b64 exec, -1
    s_mov_b32 m0, 21504
    s_mov_b32 s44, 256
    buffer_load_dwordx4 v5, s[12:15], s44 offen lds
    s_mov_b32 m0, 22528
    s_mov_b32 s44, 256
    buffer_load_dwordx4 v6, s[12:15], s44 offen lds
    s_mov_b32 m0, 98304
    s_mov_b32 s45, 393216
    buffer_load_dwordx4 v7, s[16:19], s45 offen lds
    s_mov_b32 m0, 99328
    s_mov_b32 s45, 417792
    buffer_load_dwordx4 v8, s[16:19], s45 offen lds
    s_mov_b32 m0, 106496
    s_mov_b32 s45, 394240
    buffer_load_dwordx4 v7, s[16:19], s45 offen lds
    s_mov_b32 m0, 107520
    s_mov_b32 s45, 418816
    buffer_load_dwordx4 v8, s[16:19], s45 offen lds
    s_mov_b32 m0, 114688
    s_mov_b32 s45, 395264
    buffer_load_dwordx4 v7, s[16:19], s45 offen lds
    s_mov_b32 m0, 115712
    s_mov_b32 s45, 419840
    buffer_load_dwordx4 v8, s[16:19], s45 offen lds
    s_mov_b32 m0, 30720
    s_mov_b32 s44, 384
    s_mov_b64 exec, s[46:47]
    buffer_load_dwordx4 v4, s[12:15], s44 offen lds
    s_mov_b64 exec, -1
    s_mov_b32 m0, 31744
    s_mov_b32 s44, 384
    buffer_load_dwordx4 v5, s[12:15], s44 offen lds
    s_mov_b32 m0, 32768
    s_mov_b32 s44, 384
    buffer_load_dwordx4 v6, s[12:15], s44 offen lds
    s_mov_b32 m0, 122880
    s_mov_b32 s45, 589824
    buffer_load_dwordx4 v7, s[16:19], s45 offen lds
    s_mov_b32 m0, 123904
    s_mov_b32 s45, 614400
    buffer_load_dwordx4 v8, s[16:19], s45 offen lds
    s_mov_b32 m0, 131072
    s_mov_b32 s45, 590848
    buffer_load_dwordx4 v7, s[16:19], s45 offen lds
    s_mov_b32 m0, 132096
    s_mov_b32 s45, 615424
    buffer_load_dwordx4 v8, s[16:19], s45 offen lds
    s_mov_b32 m0, 139264
    s_mov_b32 s45, 591872
    buffer_load_dwordx4 v7, s[16:19], s45 offen lds
    s_mov_b32 m0, 140288
    s_mov_b32 s45, 616448
    buffer_load_dwordx4 v8, s[16:19], s45 offen lds
    s_mov_b32 s38, 0
    s_mov_b32 s42, 49152
    s_mov_b32 s43, 786432
    s_mov_b32 s39, 512
    s_mov_b32 s41, 0
A1L0_LL0:
    s_waitcnt vmcnt(18)
    s_barrier
    s_add_u32 m0, s38, 0
    s_mov_b64 exec, s[46:47]
    buffer_load_dwordx4 v4, s[12:15], s39 offen lds
    s_mov_b64 exec, -1
    s_add_u32 m0, s38, 1024
    s_nop 0
    buffer_load_dwordx4 v5, s[12:15], s39 offen lds
    s_add_u32 m0, s38, 2048
    s_nop 0
    buffer_load_dwordx4 v6, s[12:15], s39 offen lds
    s_add_u32 m0, s42, 0
    s_add_u32 s45, s43, 0
    buffer_load_dwordx4 v7, s[16:19], s45 offen lds
    s_add_u32 m0, s42, 1024
    s_add_u32 s45, s43, 24576
    buffer_load_dwordx4 v8, s[16:19], s45 offen lds
    s_add_u32 m0, s42, 8192
    s_add_u32 s45, s43, 1024
    buffer_load_dwordx4 v7, s[16:19], s45 offen lds
    s_add_u32 m0, s42, 9216
    s_add_u32 s45, s43, 25600
    buffer_load_dwordx4 v8, s[16:19], s45 offen lds
    s_add_u32 m0, s42, 16384
    s_add_u32 s45, s43, 2048
    buffer_load_dwordx4 v7, s[16:19], s45 offen lds
    s_add_u32 m0, s42, 17408
    s_add_u32 s45, s43, 26624
    buffer_load_dwordx4 v8, s[16:19], s45 offen lds
    s_add_u32 s38, s38, 10240
    s_add_u32 s39, s39, 128
    s_add_u32 s42, s42, 24576
    s_add_u32 s43, s43, 196608
    s_add_u32 s41, s41, 1
    s_cmp_lt_u32 s41, 4
    s_cbranch_scc1 A1L0_LL0
    s_waitcnt vmcnt(18)
    s_barrier
    s_waitcnt vmcnt(9)
    s_barrier
    s_waitcnt vmcnt(0)
    s_barrier
    s_barrier
    s_lshl_b32 s95, s31, 16
    s_mov_b32 m0, 49152
    s_mov_b32 s78, 0
    buffer_load_dwordx4 v224, s[24:27], s78 offen lds
    s_mov_b32 m0, 50176
    s_mov_b32 s78, 0
    buffer_load_dwordx4 v225, s[24:27], s78 offen lds
    s_mov_b32 m0, 65536
    s_mov_b32 s78, 131072
    buffer_load_dwordx4 v224, s[24:27], s78 offen lds
    s_mov_b32 m0, 66560
    s_mov_b32 s78, 131072
    buffer_load_dwordx4 v225, s[24:27], s78 offen lds
    s_mov_b32 m0, 81920
    s_mov_b32 s78, 262144
    buffer_load_dwordx4 v224, s[24:27], s78 offen lds
    s_mov_b32 m0, 82944
    s_mov_b32 s78, 262144
    buffer_load_dwordx4 v225, s[24:27], s78 offen lds
    s_mov_b32 m0, 98304
    s_mov_b32 s78, 393216
    buffer_load_dwordx4 v224, s[24:27], s78 offen lds
    s_mov_b32 m0, 99328
    s_mov_b32 s78, 393216
    buffer_load_dwordx4 v225, s[24:27], s78 offen lds
    s_mov_b32 m0, 51200
    s_mov_b32 s78, 16384
    buffer_load_dwordx4 v224, s[24:27], s78 offen lds
    s_mov_b32 m0, 52224
    s_mov_b32 s78, 16384
    buffer_load_dwordx4 v225, s[24:27], s78 offen lds
    s_mov_b32 m0, 67584
    s_mov_b32 s78, 147456
    buffer_load_dwordx4 v224, s[24:27], s78 offen lds
    s_mov_b32 m0, 68608
    s_mov_b32 s78, 147456
    buffer_load_dwordx4 v225, s[24:27], s78 offen lds
    s_mov_b32 m0, 83968
    s_mov_b32 s78, 278528
    buffer_load_dwordx4 v224, s[24:27], s78 offen lds
    s_mov_b32 m0, 84992
    s_mov_b32 s78, 278528
    buffer_load_dwordx4 v225, s[24:27], s78 offen lds
    s_mov_b32 m0, 100352
    s_mov_b32 s78, 409600
    buffer_load_dwordx4 v224, s[24:27], s78 offen lds
    s_mov_b32 m0, 101376
    s_mov_b32 s78, 409600
    buffer_load_dwordx4 v225, s[24:27], s78 offen lds
    s_cmp_lt_u32 s28, 4
    s_cbranch_scc1 KG_NOLDU0
    s_cmp_ge_u32 s28, 8
    s_cbranch_scc1 KG_NOLDU0
    s_load_dwordx8 s[40:47], s[0:1], 32
    s_load_dwordx2 s[48:49], s[0:1], 64
    s_and_b32 s35, s28, 3
    s_lshr_b32 s36, s35, 1
    s_and_b32 s35, s35, 1
    s_lshl_b32 s37, s33, 1
    s_add_u32 s37, s37, s36
    s_lshl_b32 s35, s35, 6
    v_add_u32 v11, s35, v1
    s_lshl_b32 s38, s37, 8
    v_lshlrev_b32 v11, 1, v11
    v_add_u32 v11, s38, v11
    s_lshl_b32 s38, s37, 1
    v_mov_b32 v12, s38
    s_waitcnt lgkmcnt(0)
    global_load_short_d16_hi v186, v11, s[40:41]
    global_load_short_d16_hi v187, v11, s[42:43]
    global_load_short_d16_hi v188, v11, s[44:45]
    global_load_short_d16_hi v189, v11, s[46:47]
    global_load_short_d16_hi v190, v12, s[48:49]
KG_NOLDU0:
    s_barrier
    v_lshrrev_b32 v13, 3, v1
    s_lshl_b32 s35, s28, 3
    v_add_u32 v13, s35, v13
    v_and_b32 v14, 7, v1
    v_lshlrev_b32 v14, 4, v14
    v_mul_u32_u24 v15, 144, v13
    v_add_u32 v15, v15, v14
    v_add_u32 v170, 0, v15
    v_lshlrev_b32 v13, 10, v13
    v_add_u32 v171, v13, v14
    s_lshl_b32 s36, s31, 16
    s_lshl_b32 s35, s32, 7
    s_add_u32 s36, s36, s35
    s_add_u32 s20, s8, 4718592
    s_addc_u32 s21, s9, 0
    s_mov_b32 s22, 2097152
    s_mov_b32 s23, 0x20000
    s_branch A1L0_ST
A1L0_L1:
    v_add_u32 v4, 24576, v11
    v_add_u32 v4, v4, v12
    v_add_u32 v5, 32768, v11
    v_add_u32 v5, v5, v13
    v_add_u32 v6, 40960, v11
    v_add_u32 v6, v6, v12
    s_waitcnt lgkmcnt(0)
    s_mov_b32 s12, s4
    s_mov_b32 s13, s5
    s_mov_b32 s14, 2097152
    s_mov_b32 s15, 0x20000
    s_mov_b32 s16, s6
    s_mov_b32 s17, s7
    s_mov_b32 s18, 1572864
    s_mov_b32 s19, 0x20000
    s_mov_b32 m0, 3072
    s_mov_b32 s44, 0
    buffer_load_dwordx4 v4, s[12:15], s44 offen lds
    s_mov_b32 m0, 4096
    s_mov_b32 s44, 0
    buffer_load_dwordx4 v5, s[12:15], s44 offen lds
    s_mov_b32 m0, 5120
    s_mov_b32 s44, 0
    buffer_load_dwordx4 v6, s[12:15], s44 offen lds
    s_mov_b32 m0, 51200
    s_mov_b32 s45, 49152
    buffer_load_dwordx4 v7, s[16:19], s45 offen lds
    s_mov_b32 m0, 52224
    s_mov_b32 s45, 73728
    buffer_load_dwordx4 v8, s[16:19], s45 offen lds
    s_mov_b32 m0, 59392
    s_mov_b32 s45, 50176
    buffer_load_dwordx4 v7, s[16:19], s45 offen lds
    s_mov_b32 m0, 60416
    s_mov_b32 s45, 74752
    buffer_load_dwordx4 v8, s[16:19], s45 offen lds
    s_mov_b32 m0, 67584
    s_mov_b32 s45, 51200
    buffer_load_dwordx4 v7, s[16:19], s45 offen lds
    s_mov_b32 m0, 68608
    s_mov_b32 s45, 75776
    buffer_load_dwordx4 v8, s[16:19], s45 offen lds
    s_mov_b32 m0, 13312
    s_mov_b32 s44, 128
    buffer_load_dwordx4 v4, s[12:15], s44 offen lds
    s_mov_b32 m0, 14336
    s_mov_b32 s44, 128
    buffer_load_dwordx4 v5, s[12:15], s44 offen lds
    s_mov_b32 m0, 15360
    s_mov_b32 s44, 128
    buffer_load_dwordx4 v6, s[12:15], s44 offen lds
    s_mov_b32 m0, 75776
    s_mov_b32 s45, 245760
    buffer_load_dwordx4 v7, s[16:19], s45 offen lds
    s_mov_b32 m0, 76800
    s_mov_b32 s45, 270336
    buffer_load_dwordx4 v8, s[16:19], s45 offen lds
    s_mov_b32 m0, 83968
    s_mov_b32 s45, 246784
    buffer_load_dwordx4 v7, s[16:19], s45 offen lds
    s_mov_b32 m0, 84992
    s_mov_b32 s45, 271360
    buffer_load_dwordx4 v8, s[16:19], s45 offen lds
    s_mov_b32 m0, 92160
    s_mov_b32 s45, 247808
    buffer_load_dwordx4 v7, s[16:19], s45 offen lds
    s_mov_b32 m0, 93184
    s_mov_b32 s45, 272384
    buffer_load_dwordx4 v8, s[16:19], s45 offen lds
    s_load_dword s34, s[8:9], 0
    s_lshl_b32 s35, s33, 2
    s_load_dword s68, s[50:51], s35
    s_add_u32 s72, s8, 65536
    s_addc_u32 s73, s9, 0
    s_mov_b32 s74, 163840
    s_mov_b32 s75, 0x20000
    v_lshrrev_b32 v11, 3, v1
    v_lshlrev_b32 v11, 10, v11
    v_and_b32 v12, 1, v3
    v_lshrrev_b32 v13, 1, v1
    v_and_b32 v13, 3, v13
    v_xor_b32 v13, v13, v12
    v_lshlrev_b32 v13, 5, v13
    v_and_b32 v14, 1, v1
    v_lshlrev_b32 v14, 4, v14
    v_add_u32 v11, v11, v14
    s_lshl_b32 s35, s32, 7
    v_add_u32 v11, s35, v11
    v_add_u32 v224, v11, v13
    v_xor_b32 v13, 64, v13
    v_add_u32 v11, 8192, v11
    v_add_u32 v225, v11, v13
    s_mov_b32 s24, s64
    s_mov_b32 s25, s65
    s_mov_b32 s26, 524288
    s_mov_b32 s27, 0x20000
    s_mov_b32 s71, 0
    v_mov_b32 v250, 157956
    v_mov_b32 v251, 0
    ds_write_b32 v250, v251
    s_waitcnt vmcnt(9)
    s_barrier
    s_mov_b32 m0, 23552
    s_mov_b32 s44, 256
    buffer_load_dwordx4 v4, s[12:15], s44 offen lds
    s_mov_b32 m0, 24576
    s_mov_b32 s44, 256
    buffer_load_dwordx4 v5, s[12:15], s44 offen lds
    s_mov_b32 m0, 25600
    s_mov_b32 s44, 256
    buffer_load_dwordx4 v6, s[12:15], s44 offen lds
    s_mov_b32 m0, 100352
    s_mov_b32 s45, 442368
    buffer_load_dwordx4 v7, s[16:19], s45 offen lds
    s_mov_b32 m0, 101376
    s_mov_b32 s45, 466944
    buffer_load_dwordx4 v8, s[16:19], s45 offen lds
    s_mov_b32 m0, 108544
    s_mov_b32 s45, 443392
    buffer_load_dwordx4 v7, s[16:19], s45 offen lds
    s_mov_b32 m0, 109568
    s_mov_b32 s45, 467968
    buffer_load_dwordx4 v8, s[16:19], s45 offen lds
    s_mov_b32 m0, 116736
    s_mov_b32 s45, 444416
    buffer_load_dwordx4 v7, s[16:19], s45 offen lds
    s_mov_b32 m0, 117760
    s_mov_b32 s45, 468992
    buffer_load_dwordx4 v8, s[16:19], s45 offen lds
    s_mov_b32 m0, 33792
    s_mov_b32 s44, 384
    buffer_load_dwordx4 v4, s[12:15], s44 offen lds
    s_mov_b32 m0, 34816
    s_mov_b32 s44, 384
    buffer_load_dwordx4 v5, s[12:15], s44 offen lds
    s_mov_b32 m0, 35840
    s_mov_b32 s44, 384
    buffer_load_dwordx4 v6, s[12:15], s44 offen lds
    s_mov_b32 m0, 124928
    s_mov_b32 s45, 638976
    buffer_load_dwordx4 v7, s[16:19], s45 offen lds
    s_mov_b32 m0, 125952
    s_mov_b32 s45, 663552
    buffer_load_dwordx4 v8, s[16:19], s45 offen lds
    s_mov_b32 m0, 133120
    s_mov_b32 s45, 640000
    buffer_load_dwordx4 v7, s[16:19], s45 offen lds
    s_mov_b32 m0, 134144
    s_mov_b32 s45, 664576
    buffer_load_dwordx4 v8, s[16:19], s45 offen lds
    s_mov_b32 m0, 141312
    s_mov_b32 s45, 641024
    buffer_load_dwordx4 v7, s[16:19], s45 offen lds
    s_mov_b32 m0, 142336
    s_mov_b32 s45, 665600
    buffer_load_dwordx4 v8, s[16:19], s45 offen lds
    s_mov_b32 s38, 0
    s_mov_b32 s42, 49152
    s_mov_b32 s43, 786432
    s_mov_b32 s39, 512
    s_mov_b32 s41, 0
A1L0_LL1:
    s_waitcnt vmcnt(18)
    s_barrier
    s_add_u32 m0, s38, 3072
    s_nop 0
    buffer_load_dwordx4 v4, s[12:15], s39 offen lds
    s_add_u32 m0, s38, 4096
    s_nop 0
    buffer_load_dwordx4 v5, s[12:15], s39 offen lds
    s_add_u32 m0, s38, 5120
    s_nop 0
    buffer_load_dwordx4 v6, s[12:15], s39 offen lds
    s_add_u32 m0, s42, 2048
    s_add_u32 s45, s43, 49152
    buffer_load_dwordx4 v7, s[16:19], s45 offen lds
    s_add_u32 m0, s42, 3072
    s_add_u32 s45, s43, 73728
    buffer_load_dwordx4 v8, s[16:19], s45 offen lds
    s_add_u32 m0, s42, 10240
    s_add_u32 s45, s43, 50176
    buffer_load_dwordx4 v7, s[16:19], s45 offen lds
    s_add_u32 m0, s42, 11264
    s_add_u32 s45, s43, 74752
    buffer_load_dwordx4 v8, s[16:19], s45 offen lds
    s_add_u32 m0, s42, 18432
    s_add_u32 s45, s43, 51200
    buffer_load_dwordx4 v7, s[16:19], s45 offen lds
    s_add_u32 m0, s42, 19456
    s_add_u32 s45, s43, 75776
    buffer_load_dwordx4 v8, s[16:19], s45 offen lds
    s_add_u32 s38, s38, 10240
    s_add_u32 s39, s39, 128
    s_add_u32 s42, s42, 24576
    s_add_u32 s43, s43, 196608
    s_add_u32 s41, s41, 1
    s_cmp_lt_u32 s41, 4
    s_cbranch_scc1 A1L0_LL1
    s_waitcnt vmcnt(18)
    s_barrier
    s_waitcnt vmcnt(9)
    s_barrier
    s_waitcnt vmcnt(0)
    s_barrier
    s_barrier
    s_mov_b32 m0, 53248
    s_mov_b32 s78, 32768
    buffer_load_dwordx4 v224, s[24:27], s78 offen lds
    s_mov_b32 m0, 54272
    s_mov_b32 s78, 32768
    buffer_load_dwordx4 v225, s[24:27], s78 offen lds
    s_mov_b32 m0, 69632
    s_mov_b32 s78, 163840
    buffer_load_dwordx4 v224, s[24:27], s78 offen lds
    s_mov_b32 m0, 70656
    s_mov_b32 s78, 163840
    buffer_load_dwordx4 v225, s[24:27], s78 offen lds
    s_mov_b32 m0, 86016
    s_mov_b32 s78, 294912
    buffer_load_dwordx4 v224, s[24:27], s78 offen lds
    s_mov_b32 m0, 87040
    s_mov_b32 s78, 294912
    buffer_load_dwordx4 v225, s[24:27], s78 offen lds
    s_mov_b32 m0, 102400
    s_mov_b32 s78, 425984
    buffer_load_dwordx4 v224, s[24:27], s78 offen lds
    s_mov_b32 m0, 103424
    s_mov_b32 s78, 425984
    buffer_load_dwordx4 v225, s[24:27], s78 offen lds
    s_mov_b32 m0, 55296
    s_mov_b32 s78, 49152
    buffer_load_dwordx4 v224, s[24:27], s78 offen lds
    s_mov_b32 m0, 56320
    s_mov_b32 s78, 49152
    buffer_load_dwordx4 v225, s[24:27], s78 offen lds
    s_mov_b32 m0, 71680
    s_mov_b32 s78, 180224
    buffer_load_dwordx4 v224, s[24:27], s78 offen lds
    s_mov_b32 m0, 72704
    s_mov_b32 s78, 180224
    buffer_load_dwordx4 v225, s[24:27], s78 offen lds
    s_mov_b32 m0, 88064
    s_mov_b32 s78, 311296
    buffer_load_dwordx4 v224, s[24:27], s78 offen lds
    s_mov_b32 m0, 89088
    s_mov_b32 s78, 311296
    buffer_load_dwordx4 v225, s[24:27], s78 offen lds
    s_mov_b32 m0, 104448
    s_mov_b32 s78, 442368
    buffer_load_dwordx4 v224, s[24:27], s78 offen lds
    s_mov_b32 m0, 105472
    s_mov_b32 s78, 442368
    buffer_load_dwordx4 v225, s[24:27], s78 offen lds
    s_cmp_lt_u32 s28, 4
    s_cbranch_scc1 KG_NOLDU1
    s_cmp_ge_u32 s28, 8
    s_cbranch_scc1 KG_NOLDU1
    s_load_dwordx8 s[40:47], s[0:1], 32
    s_load_dwordx2 s[48:49], s[0:1], 64
    s_and_b32 s35, s28, 3
    s_lshr_b32 s36, s35, 1
    s_and_b32 s35, s35, 1
    s_lshl_b32 s37, s33, 1
    s_add_u32 s37, s37, s36
    s_lshl_b32 s35, s35, 6
    v_add_u32 v11, s35, v1
    s_lshl_b32 s38, s37, 8
    v_lshlrev_b32 v11, 1, v11
    v_add_u32 v11, s38, v11
    s_lshl_b32 s38, s37, 1
    v_mov_b32 v12, s38
    s_waitcnt lgkmcnt(0)
    global_load_short_d16_hi v186, v11, s[40:41]
    global_load_short_d16_hi v187, v11, s[42:43]
    global_load_short_d16_hi v188, v11, s[44:45]
    global_load_short_d16_hi v189, v11, s[46:47]
    global_load_short_d16_hi v190, v12, s[48:49]
KG_NOLDU1:
    s_barrier
    v_lshrrev_b32 v13, 3, v1
    s_lshl_b32 s35, s28, 3
    v_add_u32 v13, s35, v13
    v_and_b32 v14, 7, v1
    v_lshlrev_b32 v14, 4, v14
    v_mul_u32_u24 v15, 144, v13
    v_add_u32 v15, v15, v14
    v_add_u32 v170, 0, v15
    v_lshlrev_b32 v13, 10, v13
    v_add_u32 v171, v13, v14
    s_lshl_b32 s36, s31, 16
    s_lshl_b32 s35, s32, 7
    s_add_u32 s36, s36, s35
    s_add_u32 s20, s8, 4718592
    s_addc_u32 s21, s9, 0
    s_mov_b32 s22, 2097152
    s_mov_b32 s23, 0x20000
    s_branch A1L0_ST
A1L0_L2:
    v_add_u32 v4, 49152, v11
    v_add_u32 v4, v4, v13
    v_add_u32 v5, 57344, v11
    v_add_u32 v5, v5, v12
    s_waitcnt lgkmcnt(0)
    s_mov_b32 s12, s4
    s_mov_b32 s13, s5
    s_mov_b32 s14, 2097152
    s_mov_b32 s15, 0x20000
    s_mov_b32 s16, s6
    s_mov_b32 s17, s7
    s_mov_b32 s18, 1572864
    s_mov_b32 s19, 0x20000
    s_mov_b32 m0, 6144
    s_mov_b32 s44, 0
    buffer_load_dwordx4 v4, s[12:15], s44 offen lds
    s_mov_b32 m0, 7168
    s_mov_b32 s44, 0
    buffer_load_dwordx4 v5, s[12:15], s44 offen lds
    s_mov_b32 m0, 53248
    s_mov_b32 s45, 98304
    buffer_load_dwordx4 v7, s[16:19], s45 offen lds
    s_mov_b32 m0, 54272
    s_mov_b32 s45, 122880
    buffer_load_dwordx4 v8, s[16:19], s45 offen lds
    s_mov_b32 m0, 61440
    s_mov_b32 s45, 99328
    buffer_load_dwordx4 v7, s[16:19], s45 offen lds
    s_mov_b32 m0, 62464
    s_mov_b32 s45, 123904
    buffer_load_dwordx4 v8, s[16:19], s45 offen lds
    s_mov_b32 m0, 69632
    s_mov_b32 s45, 100352
    buffer_load_dwordx4 v7, s[16:19], s45 offen lds
    s_mov_b32 m0, 70656
    s_mov_b32 s45, 124928
    buffer_load_dwordx4 v8, s[16:19], s45 offen lds
    s_mov_b32 m0, 16384
    s_mov_b32 s44, 128
    buffer_load_dwordx4 v4, s[12:15], s44 offen lds
    s_mov_b32 m0, 17408
    s_mov_b32 s44, 128
    buffer_load_dwordx4 v5, s[12:15], s44 offen lds
    s_mov_b32 m0, 77824
    s_mov_b32 s45, 294912
    buffer_load_dwordx4 v7, s[16:19], s45 offen lds
    s_mov_b32 m0, 78848
    s_mov_b32 s45, 319488
    buffer_load_dwordx4 v8, s[16:19], s45 offen lds
    s_mov_b32 m0, 86016
    s_mov_b32 s45, 295936
    buffer_load_dwordx4 v7, s[16:19], s45 offen lds
    s_mov_b32 m0, 87040
    s_mov_b32 s45, 320512
    buffer_load_dwordx4 v8, s[16:19], s45 offen lds
    s_mov_b32 m0, 94208
    s_mov_b32 s45, 296960
    buffer_load_dwordx4 v7, s[16:19], s45 offen lds
    s_mov_b32 m0, 95232
    s_mov_b32 s45, 321536
    buffer_load_dwordx4 v8, s[16:19], s45 offen lds
    s_load_dword s34, s[8:9], 0
    s_lshl_b32 s35, s33, 2
    s_load_dword s68, s[50:51], s35
    s_add_u32 s72, s8, 65536
    s_addc_u32 s73, s9, 0
    s_mov_b32 s74, 163840
    s_mov_b32 s75, 0x20000
    v_lshrrev_b32 v11, 3, v1
    v_lshlrev_b32 v11, 10, v11
    v_and_b32 v12, 1, v3
    v_lshrrev_b32 v13, 1, v1
    v_and_b32 v13, 3, v13
    v_xor_b32 v13, v13, v12
    v_lshlrev_b32 v13, 5, v13
    v_and_b32 v14, 1, v1
    v_lshlrev_b32 v14, 4, v14
    v_add_u32 v11, v11, v14
    s_lshl_b32 s35, s32, 7
    v_add_u32 v11, s35, v11
    v_add_u32 v224, v11, v13
    v_xor_b32 v13, 64, v13
    v_add_u32 v11, 8192, v11
    v_add_u32 v225, v11, v13
    s_mov_b32 s24, s64
    s_mov_b32 s25, s65
    s_mov_b32 s26, 524288
    s_mov_b32 s27, 0x20000
    s_mov_b32 s71, 0
    v_mov_b32 v250, 157956
    v_mov_b32 v251, 0
    ds_write_b32 v250, v251
    s_waitcnt vmcnt(8)
    s_barrier
    s_mov_b32 m0, 26624
    s_mov_b32 s44, 256
    buffer_load_dwordx4 v4, s[12:15], s44 offen lds
    s_mov_b32 m0, 27648
    s_mov_b32 s44, 256
    buffer_load_dwordx4 v5, s[12:15], s44 offen lds
    s_mov_b32 m0, 102400
    s_mov_b32 s45, 491520
    buffer_load_dwordx4 v7, s[16:19], s45 offen lds
    s_mov_b32 m0, 103424
    s_mov_b32 s45, 516096
    buffer_load_dwordx4 v8, s[16:19], s45 offen lds
    s_mov_b32 m0, 110592
    s_mov_b32 s45, 492544
    buffer_load_dwordx4 v7, s[16:19], s45 offen lds
    s_mov_b32 m0, 111616
    s_mov_b32 s45, 517120
    buffer_load_dwordx4 v8, s[16:19], s45 offen lds
    s_mov_b32 m0, 118784
    s_mov_b32 s45, 493568
    buffer_load_dwordx4 v7, s[16:19], s45 offen lds
    s_mov_b32 m0, 119808
    s_mov_b32 s45, 518144
    buffer_load_dwordx4 v8, s[16:19], s45 offen lds
    s_mov_b32 m0, 36864
    s_mov_b32 s44, 384
    buffer_load_dwordx4 v4, s[12:15], s44 offen lds
    s_mov_b32 m0, 37888
    s_mov_b32 s44, 384
    buffer_load_dwordx4 v5, s[12:15], s44 offen lds
    s_mov_b32 m0, 126976
    s_mov_b32 s45, 688128
    buffer_load_dwordx4 v7, s[16:19], s45 offen lds
    s_mov_b32 m0, 128000
    s_mov_b32 s45, 712704
    buffer_load_dwordx4 v8, s[16:19], s45 offen lds
    s_mov_b32 m0, 135168
    s_mov_b32 s45, 689152
    buffer_load_dwordx4 v7, s[16:19], s45 offen lds
    s_mov_b32 m0, 136192
    s_mov_b32 s45, 713728
    buffer_load_dwordx4 v8, s[16:19], s45 offen lds
    s_mov_b32 m0, 143360
    s_mov_b32 s45, 690176
    buffer_load_dwordx4 v7, s[16:19], s45 offen lds
    s_mov_b32 m0, 144384
    s_mov_b32 s45, 714752
    buffer_load_dwordx4 v8, s[16:19], s45 offen lds
    s_mov_b32 s38, 0
    s_mov_b32 s42, 49152
    s_mov_b32 s43, 786432
    s_mov_b32 s39, 512
    s_mov_b32 s41, 0
A1L0_LL2:
    s_waitcnt vmcnt(16)
    s_barrier
    s_add_u32 m0, s38, 6144
    s_nop 0
    buffer_load_dwordx4 v4, s[12:15], s39 offen lds
    s_add_u32 m0, s38, 7168
    s_nop 0
    buffer_load_dwordx4 v5, s[12:15], s39 offen lds
    s_add_u32 m0, s42, 4096
    s_add_u32 s45, s43, 98304
    buffer_load_dwordx4 v7, s[16:19], s45 offen lds
    s_add_u32 m0, s42, 5120
    s_add_u32 s45, s43, 122880
    buffer_load_dwordx4 v8, s[16:19], s45 offen lds
    s_add_u32 m0, s42, 12288
    s_add_u32 s45, s43, 99328
    buffer_load_dwordx4 v7, s[16:19], s45 offen lds
    s_add_u32 m0, s42, 13312
    s_add_u32 s45, s43, 123904
    buffer_load_dwordx4 v8, s[16:19], s45 offen lds
    s_add_u32 m0, s42, 20480
    s_add_u32 s45, s43, 100352
    buffer_load_dwordx4 v7, s[16:19], s45 offen lds
    s_add_u32 m0, s42, 21504
    s_add_u32 s45, s43, 124928
    buffer_load_dwordx4 v8, s[16:19], s45 offen lds
    s_add_u32 s38, s38, 10240
    s_add_u32 s39, s39, 128
    s_add_u32 s42, s42, 24576
    s_add_u32 s43, s43, 196608
    s_add_u32 s41, s41, 1
    s_cmp_lt_u32 s41, 4
    s_cbranch_scc1 A1L0_LL2
    s_waitcnt vmcnt(16)
    s_barrier
    s_waitcnt vmcnt(8)
    s_barrier
    s_waitcnt vmcnt(0)
    s_barrier
    s_barrier
    s_mov_b32 m0, 57344
    s_mov_b32 s78, 65536
    buffer_load_dwordx4 v224, s[24:27], s78 offen lds
    s_mov_b32 m0, 58368
    s_mov_b32 s78, 65536
    buffer_load_dwordx4 v225, s[24:27], s78 offen lds
    s_mov_b32 m0, 73728
    s_mov_b32 s78, 196608
    buffer_load_dwordx4 v224, s[24:27], s78 offen lds
    s_mov_b32 m0, 74752
    s_mov_b32 s78, 196608
    buffer_load_dwordx4 v225, s[24:27], s78 offen lds
    s_mov_b32 m0, 90112
    s_mov_b32 s78, 327680
    buffer_load_dwordx4 v224, s[24:27], s78 offen lds
    s_mov_b32 m0, 91136
    s_mov_b32 s78, 327680
    buffer_load_dwordx4 v225, s[24:27], s78 offen lds
    s_mov_b32 m0, 106496
    s_mov_b32 s78, 458752
    buffer_load_dwordx4 v224, s[24:27], s78 offen lds
    s_mov_b32 m0, 107520
    s_mov_b32 s78, 458752
    buffer_load_dwordx4 v225, s[24:27], s78 offen lds
    s_mov_b32 m0, 59392
    s_mov_b32 s78, 81920
    buffer_load_dwordx4 v224, s[24:27], s78 offen lds
    s_mov_b32 m0, 60416
    s_mov_b32 s78, 81920
    buffer_load_dwordx4 v225, s[24:27], s78 offen lds
    s_mov_b32 m0, 75776
    s_mov_b32 s78, 212992
    buffer_load_dwordx4 v224, s[24:27], s78 offen lds
    s_mov_b32 m0, 76800
    s_mov_b32 s78, 212992
    buffer_load_dwordx4 v225, s[24:27], s78 offen lds
    s_mov_b32 m0, 92160
    s_mov_b32 s78, 344064
    buffer_load_dwordx4 v224, s[24:27], s78 offen lds
    s_mov_b32 m0, 93184
    s_mov_b32 s78, 344064
    buffer_load_dwordx4 v225, s[24:27], s78 offen lds
    s_mov_b32 m0, 108544
    s_mov_b32 s78, 475136
    buffer_load_dwordx4 v224, s[24:27], s78 offen lds
    s_mov_b32 m0, 109568
    s_mov_b32 s78, 475136
    buffer_load_dwordx4 v225, s[24:27], s78 offen lds
    s_cmp_lt_u32 s28, 4
    s_cbranch_scc1 KG_NOLDU2
    s_cmp_ge_u32 s28, 8
    s_cbranch_scc1 KG_NOLDU2
    s_load_dwordx8 s[40:47], s[0:1], 32
    s_load_dwordx2 s[48:49], s[0:1], 64
    s_and_b32 s35, s28, 3
    s_lshr_b32 s36, s35, 1
    s_and_b32 s35, s35, 1
    s_lshl_b32 s37, s33, 1
    s_add_u32 s37, s37, s36
    s_lshl_b32 s35, s35, 6
    v_add_u32 v11, s35, v1
    s_lshl_b32 s38, s37, 8
    v_lshlrev_b32 v11, 1, v11
    v_add_u32 v11, s38, v11
    s_lshl_b32 s38, s37, 1
    v_mov_b32 v12, s38
    s_waitcnt lgkmcnt(0)
    global_load_short_d16_hi v186, v11, s[40:41]
    global_load_short_d16_hi v187, v11, s[42:43]
    global_load_short_d16_hi v188, v11, s[44:45]
    global_load_short_d16_hi v189, v11, s[46:47]
    global_load_short_d16_hi v190, v12, s[48:49]
KG_NOLDU2:
    s_barrier
    v_lshrrev_b32 v13, 3, v1
    s_lshl_b32 s35, s28, 3
    v_add_u32 v13, s35, v13
    v_and_b32 v14, 7, v1
    v_lshlrev_b32 v14, 4, v14
    v_mul_u32_u24 v15, 144, v13
    v_add_u32 v15, v15, v14
    v_add_u32 v170, 0, v15
    v_lshlrev_b32 v13, 10, v13
    v_add_u32 v171, v13, v14
    s_lshl_b32 s36, s31, 16
    s_lshl_b32 s35, s32, 7
    s_add_u32 s36, s36, s35
    s_add_u32 s20, s8, 4718592
    s_addc_u32 s21, s9, 0
    s_mov_b32 s22, 2097152
    s_mov_b32 s23, 0x20000
    s_branch A1L0_ST
A1L0_L3:
    v_add_u32 v4, 65536, v11
    v_add_u32 v4, v4, v13
    v_add_u32 v5, 73728, v11
    v_add_u32 v5, v5, v12
    s_waitcnt lgkmcnt(0)
    s_mov_b32 s12, s4
    s_mov_b32 s13, s5
    s_mov_b32 s14, 2097152
    s_mov_b32 s15, 0x20000
    s_mov_b32 s16, s6
    s_mov_b32 s17, s7
    s_mov_b32 s18, 1572864
    s_mov_b32 s19, 0x20000
    s_mov_b32 m0, 8192
    s_mov_b32 s44, 0
    buffer_load_dwordx4 v4, s[12:15], s44 offen lds
    s_mov_b32 m0, 9216
    s_mov_b32 s44, 0
    buffer_load_dwordx4 v5, s[12:15], s44 offen lds
    s_mov_b32 m0, 55296
    s_mov_b32 s45, 147456
    buffer_load_dwordx4 v7, s[16:19], s45 offen lds
    s_mov_b32 m0, 56320
    s_mov_b32 s45, 172032
    buffer_load_dwordx4 v8, s[16:19], s45 offen lds
    s_mov_b32 m0, 63488
    s_mov_b32 s45, 148480
    buffer_load_dwordx4 v7, s[16:19], s45 offen lds
    s_mov_b32 m0, 64512
    s_mov_b32 s45, 173056
    buffer_load_dwordx4 v8, s[16:19], s45 offen lds
    s_mov_b32 m0, 71680
    s_mov_b32 s45, 149504
    buffer_load_dwordx4 v7, s[16:19], s45 offen lds
    s_mov_b32 m0, 72704
    s_mov_b32 s45, 174080
    buffer_load_dwordx4 v8, s[16:19], s45 offen lds
    s_mov_b32 m0, 18432
    s_mov_b32 s44, 128
    buffer_load_dwordx4 v4, s[12:15], s44 offen lds
    s_mov_b32 m0, 19456
    s_mov_b32 s44, 128
    buffer_load_dwordx4 v5, s[12:15], s44 offen lds
    s_mov_b32 m0, 79872
    s_mov_b32 s45, 344064
    buffer_load_dwordx4 v7, s[16:19], s45 offen lds
    s_mov_b32 m0, 80896
    s_mov_b32 s45, 368640
    buffer_load_dwordx4 v8, s[16:19], s45 offen lds
    s_mov_b32 m0, 88064
    s_mov_b32 s45, 345088
    buffer_load_dwordx4 v7, s[16:19], s45 offen lds
    s_mov_b32 m0, 89088
    s_mov_b32 s45, 369664
    buffer_load_dwordx4 v8, s[16:19], s45 offen lds
    s_mov_b32 m0, 96256
    s_mov_b32 s45, 346112
    buffer_load_dwordx4 v7, s[16:19], s45 offen lds
    s_mov_b32 m0, 97280
    s_mov_b32 s45, 370688
    buffer_load_dwordx4 v8, s[16:19], s45 offen lds
    s_load_dword s34, s[8:9], 0
    s_lshl_b32 s35, s33, 2
    s_load_dword s68, s[50:51], s35
    s_add_u32 s72, s8, 65536
    s_addc_u32 s73, s9, 0
    s_mov_b32 s74, 163840
    s_mov_b32 s75, 0x20000
    v_lshrrev_b32 v11, 3, v1
    v_lshlrev_b32 v11, 10, v11
    v_and_b32 v12, 1, v3
    v_lshrrev_b32 v13, 1, v1
    v_and_b32 v13, 3, v13
    v_xor_b32 v13, v13, v12
    v_lshlrev_b32 v13, 5, v13
    v_and_b32 v14, 1, v1
    v_lshlrev_b32 v14, 4, v14
    v_add_u32 v11, v11, v14
    s_lshl_b32 s35, s32, 7
    v_add_u32 v11, s35, v11
    v_add_u32 v224, v11, v13
    v_xor_b32 v13, 64, v13
    v_add_u32 v11, 8192, v11
    v_add_u32 v225, v11, v13
    s_mov_b32 s24, s64
    s_mov_b32 s25, s65
    s_mov_b32 s26, 524288
    s_mov_b32 s27, 0x20000
    s_mov_b32 s71, 0
    v_mov_b32 v250, 157956
    v_mov_b32 v251, 0
    ds_write_b32 v250, v251
    s_waitcnt vmcnt(8)
    s_barrier
    s_mov_b32 m0, 28672
    s_mov_b32 s44, 256
    buffer_load_dwordx4 v4, s[12:15], s44 offen lds
    s_mov_b32 m0, 29696
    s_mov_b32 s44, 256
    buffer_load_dwordx4 v5, s[12:15], s44 offen lds
    s_mov_b32 m0, 104448
    s_mov_b32 s45, 540672
    buffer_load_dwordx4 v7, s[16:19], s45 offen lds
    s_mov_b32 m0, 105472
    s_mov_b32 s45, 565248
    buffer_load_dwordx4 v8, s[16:19], s45 offen lds
    s_mov_b32 m0, 112640
    s_mov_b32 s45, 541696
    buffer_load_dwordx4 v7, s[16:19], s45 offen lds
    s_mov_b32 m0, 113664
    s_mov_b32 s45, 566272
    buffer_load_dwordx4 v8, s[16:19], s45 offen lds
    s_mov_b32 m0, 120832
    s_mov_b32 s45, 542720
    buffer_load_dwordx4 v7, s[16:19], s45 offen lds
    s_mov_b32 m0, 121856
    s_mov_b32 s45, 567296
    buffer_load_dwordx4 v8, s[16:19], s45 offen lds
    s_mov_b32 m0, 38912
    s_mov_b32 s44, 384
    buffer_load_dwordx4 v4, s[12:15], s44 offen lds
    s_mov_b32 m0, 39936
    s_mov_b32 s44, 384
    buffer_load_dwordx4 v5, s[12:15], s44 offen lds
    s_mov_b32 m0, 129024
    s_mov_b32 s45, 737280
    buffer_load_dwordx4 v7, s[16:19], s45 offen lds
    s_mov_b32 m0, 130048
    s_mov_b32 s45, 761856
    buffer_load_dwordx4 v8, s[16:19], s45 offen lds
    s_mov_b32 m0, 137216
    s_mov_b32 s45, 738304
    buffer_load_dwordx4 v7, s[16:19], s45 offen lds
    s_mov_b32 m0, 138240
    s_mov_b32 s45, 762880
    buffer_load_dwordx4 v8, s[16:19], s45 offen lds
    s_mov_b32 m0, 145408
    s_mov_b32 s45, 739328
    buffer_load_dwordx4 v7, s[16:19], s45 offen lds
    s_mov_b32 m0, 146432
    s_mov_b32 s45, 763904
    buffer_load_dwordx4 v8, s[16:19], s45 offen lds
    s_mov_b32 s38, 0
    s_mov_b32 s42, 49152
    s_mov_b32 s43, 786432
    s_mov_b32 s39, 512
    s_mov_b32 s41, 0
A1L0_LL3:
    s_waitcnt vmcnt(16)
    s_barrier
    s_add_u32 m0, s38, 8192
    s_nop 0
    buffer_load_dwordx4 v4, s[12:15], s39 offen lds
    s_add_u32 m0, s38, 9216
    s_nop 0
    buffer_load_dwordx4 v5, s[12:15], s39 offen lds
    s_add_u32 m0, s42, 6144
    s_add_u32 s45, s43, 147456
    buffer_load_dwordx4 v7, s[16:19], s45 offen lds
    s_add_u32 m0, s42, 7168
    s_add_u32 s45, s43, 172032
    buffer_load_dwordx4 v8, s[16:19], s45 offen lds
    s_add_u32 m0, s42, 14336
    s_add_u32 s45, s43, 148480
    buffer_load_dwordx4 v7, s[16:19], s45 offen lds
    s_add_u32 m0, s42, 15360
    s_add_u32 s45, s43, 173056
    buffer_load_dwordx4 v8, s[16:19], s45 offen lds
    s_add_u32 m0, s42, 22528
    s_add_u32 s45, s43, 149504
    buffer_load_dwordx4 v7, s[16:19], s45 offen lds
    s_add_u32 m0, s42, 23552
    s_add_u32 s45, s43, 174080
    buffer_load_dwordx4 v8, s[16:19], s45 offen lds
    s_add_u32 s38, s38, 10240
    s_add_u32 s39, s39, 128
    s_add_u32 s42, s42, 24576
    s_add_u32 s43, s43, 196608
    s_add_u32 s41, s41, 1
    s_cmp_lt_u32 s41, 4
    s_cbranch_scc1 A1L0_LL3
    s_waitcnt vmcnt(16)
    s_barrier
    s_waitcnt vmcnt(8)
    s_barrier
    s_waitcnt vmcnt(0)
    s_barrier
    s_barrier
    s_mov_b32 m0, 61440
    s_mov_b32 s78, 98304
    buffer_load_dwordx4 v224, s[24:27], s78 offen lds
    s_mov_b32 m0, 62464
    s_mov_b32 s78, 98304
    buffer_load_dwordx4 v225, s[24:27], s78 offen lds
    s_mov_b32 m0, 77824
    s_mov_b32 s78, 229376
    buffer_load_dwordx4 v224, s[24:27], s78 offen lds
    s_mov_b32 m0, 78848
    s_mov_b32 s78, 229376
    buffer_load_dwordx4 v225, s[24:27], s78 offen lds
    s_mov_b32 m0, 94208
    s_mov_b32 s78, 360448
    buffer_load_dwordx4 v224, s[24:27], s78 offen lds
    s_mov_b32 m0, 95232
    s_mov_b32 s78, 360448
    buffer_load_dwordx4 v225, s[24:27], s78 offen lds
    s_mov_b32 m0, 110592
    s_mov_b32 s78, 491520
    buffer_load_dwordx4 v224, s[24:27], s78 offen lds
    s_mov_b32 m0, 111616
    s_mov_b32 s78, 491520
    buffer_load_dwordx4 v225, s[24:27], s78 offen lds
    s_mov_b32 m0, 63488
    s_mov_b32 s78, 114688
    buffer_load_dwordx4 v224, s[24:27], s78 offen lds
    s_mov_b32 m0, 64512
    s_mov_b32 s78, 114688
    buffer_load_dwordx4 v225, s[24:27], s78 offen lds
    s_mov_b32 m0, 79872
    s_mov_b32 s78, 245760
    buffer_load_dwordx4 v224, s[24:27], s78 offen lds
    s_mov_b32 m0, 80896
    s_mov_b32 s78, 245760
    buffer_load_dwordx4 v225, s[24:27], s78 offen lds
    s_mov_b32 m0, 96256
    s_mov_b32 s78, 376832
    buffer_load_dwordx4 v224, s[24:27], s78 offen lds
    s_mov_b32 m0, 97280
    s_mov_b32 s78, 376832
    buffer_load_dwordx4 v225, s[24:27], s78 offen lds
    s_mov_b32 m0, 112640
    s_mov_b32 s78, 507904
    buffer_load_dwordx4 v224, s[24:27], s78 offen lds
    s_mov_b32 m0, 113664
    s_mov_b32 s78, 507904
    buffer_load_dwordx4 v225, s[24:27], s78 offen lds
    s_cmp_lt_u32 s28, 4
    s_cbranch_scc1 KG_NOLDU3
    s_cmp_ge_u32 s28, 8
    s_cbranch_scc1 KG_NOLDU3
    s_load_dwordx8 s[40:47], s[0:1], 32
    s_load_dwordx2 s[48:49], s[0:1], 64
    s_and_b32 s35, s28, 3
    s_lshr_b32 s36, s35, 1
    s_and_b32 s35, s35, 1
    s_lshl_b32 s37, s33, 1
    s_add_u32 s37, s37, s36
    s_lshl_b32 s35, s35, 6
    v_add_u32 v11, s35, v1
    s_lshl_b32 s38, s37, 8
    v_lshlrev_b32 v11, 1, v11
    v_add_u32 v11, s38, v11
    s_lshl_b32 s38, s37, 1
    v_mov_b32 v12, s38
    s_waitcnt lgkmcnt(0)
    global_load_short_d16_hi v186, v11, s[40:41]
    global_load_short_d16_hi v187, v11, s[42:43]
    global_load_short_d16_hi v188, v11, s[44:45]
    global_load_short_d16_hi v189, v11, s[46:47]
    global_load_short_d16_hi v190, v12, s[48:49]
KG_NOLDU3:
    s_barrier
    v_lshrrev_b32 v13, 3, v1
    s_lshl_b32 s35, s28, 3
    v_add_u32 v13, s35, v13
    v_and_b32 v14, 7, v1
    v_lshlrev_b32 v14, 4, v14
    v_mul_u32_u24 v15, 144, v13
    v_add_u32 v15, v15, v14
    v_add_u32 v170, 0, v15
    v_lshlrev_b32 v13, 10, v13
    v_add_u32 v171, v13, v14
    s_lshl_b32 s36, s31, 16
    s_lshl_b32 s35, s32, 7
    s_add_u32 s36, s36, s35
    s_add_u32 s20, s8, 4718592
    s_addc_u32 s21, s9, 0
    s_mov_b32 s22, 2097152
    s_mov_b32 s23, 0x20000
    s_branch A1L0_ST
A1L0_C:
    s_waitcnt lgkmcnt(0)
    s_mov_b32 s12, s4
    s_mov_b32 s13, s5
    s_mov_b32 s14, 2097152
    s_mov_b32 s15, 0x20000
    s_mov_b32 s16, s6
    s_mov_b32 s17, s7
    s_mov_b32 s18, 1572864
    s_mov_b32 s19, 0x20000
    s_mov_b32 s24, s64
    s_mov_b32 s25, s65
    s_mov_b32 s26, 524288
    s_mov_b32 s27, 0x20000
    s_lshr_b32 s38, s2, 3
    s_and_b32 s39, s2, 7
    s_mul_i32 s40, s38, 132
    s_lshr_b32 s41, s39, 1
    s_lshl_b32 s41, s41, 12
    s_add_u32 s40, s40, s41
    v_add_u32 v11, s40, v0
    v_subrev_u32 v11, 128, v11
    v_max_i32 v11, 0, v11
    v_lshlrev_b32 v11, 7, v11
    v_cmp_gt_u32 vcc, 132, v0
    s_nop 0
    s_and_saveexec_b64 s[42:43], vcc
    s_cbranch_execz PK_WU0
    buffer_load_dword v254, v11, s[12:15], 0 offen
PK_WU0:
    s_mov_b64 exec, s[42:43]
    s_lshl_b32 s40, s38, 4
    s_and_b32 s41, s39, 1
    s_lshl_b32 s41, s41, 9
    v_subrev_u32 v14, 132, v0
    v_mul_u32_u24 v12, 5462, v14
    v_lshrrev_b32 v12, 16, v12
    v_mul_u32_u24 v13, 12, v12
    v_sub_u32 v13, v14, v13
    v_add_u32 v12, s40, v12
    v_mul_u32_u24 v12, 3072, v12
    v_lshrrev_b32 v15, 2, v13
    v_lshlrev_b32 v15, 10, v15
    v_and_b32 v13, 3, v13
    v_lshlrev_b32 v13, 7, v13
    v_add3_u32 v12, v12, v15, v13
    v_cmp_gt_u32 vcc, 124, v14
    s_nop 0
    s_and_saveexec_b64 s[42:43], vcc
    s_cbranch_execz PK_WU1
    buffer_load_dword v254, v12, s[16:19], s41 offen
PK_WU1:
    s_mov_b64 exec, s[42:43]
    v_add_u32 v14, 124, v0
    v_mul_u32_u24 v12, 5462, v14
    v_lshrrev_b32 v12, 16, v12
    v_mul_u32_u24 v13, 12, v12
    v_sub_u32 v13, v14, v13
    v_add_u32 v12, s40, v12
    v_mul_u32_u24 v12, 3072, v12
    v_lshrrev_b32 v15, 2, v13
    v_lshlrev_b32 v15, 10, v15
    v_and_b32 v13, 3, v13
    v_lshlrev_b32 v13, 7, v13
    v_add3_u32 v12, v12, v15, v13
    v_cmp_gt_u32 vcc, 192, v14
    s_nop 0
    s_and_saveexec_b64 s[42:43], vcc
    s_cbranch_execz PK_WU2
    buffer_load_dword v254, v12, s[16:19], s41 offen
PK_WU2:
    s_mov_b64 exec, s[42:43]
    v_subrev_u32 v14, 68, v0
    v_lshrrev_b32 v13, 2, v14
    v_add_u32 v13, s40, v13
    v_lshlrev_b32 v13, 10, v13
    v_and_b32 v12, 3, v14
    v_lshlrev_b32 v12, 7, v12
    v_add_u32 v13, v13, v12
    v_cmp_gt_u32 vcc, 64, v14
    s_nop 0
    s_and_saveexec_b64 s[42:43], vcc
    s_cbranch_execz PK_WU3
    buffer_load_dword v254, v13, s[24:27], s41 offen
PK_WU3:
    s_mov_b64 exec, s[42:43]
    s_load_dword s34, s[8:9], 0
    s_lshl_b32 s35, s33, 2
    s_load_dword s68, s[50:51], s35
    s_add_u32 s72, s8, 65536
    s_addc_u32 s73, s9, 0
    s_mov_b32 s74, 163840
    s_mov_b32 s75, 0x20000
    v_lshrrev_b32 v11, 3, v1
    v_lshlrev_b32 v11, 10, v11
    v_and_b32 v12, 1, v3
    v_lshrrev_b32 v13, 1, v1
    v_and_b32 v13, 3, v13
    v_xor_b32 v13, v13, v12
    v_lshlrev_b32 v13, 5, v13
    v_and_b32 v14, 1, v1
    v_lshlrev_b32 v14, 4, v14
    v_add_u32 v11, v11, v14
    s_lshl_b32 s35, s32, 7
    v_add_u32 v11, s35, v11
    v_add_u32 v224, v11, v13
    v_xor_b32 v13, 64, v13
    v_add_u32 v11, 8192, v11
    v_add_u32 v225, v11, v13
    s_mov_b32 s24, s64
    s_mov_b32 s25, s65
    s_mov_b32 s26, 524288
    s_mov_b32 s27, 0x20000
    s_mov_b32 s71, 0
    v_mov_b32 v250, 157956
    v_mov_b32 v251, 0
    ds_write_b32 v250, v251
    v_lshrrev_b32 v11, 1, v2
    v_xor_b32 v11, v11, v3
    v_lshlrev_b32 v11, 4, v11
    v_lshlrev_b32 v12, 7, v2
    v_add_u32 v4, v11, v12
    v_xor_b32 v5, 64, v4
    v_lshrrev_b32 v11, 2, v2
    v_lshlrev_b32 v12, 3, v3
    v_add_u32 v12, v12, v11
    v_and_b32 v14, 3, v1
    v_lshlrev_b32 v14, 3, v14
    v_and_b32 v13, 1, v3
    v_lshlrev_b32 v12, 7, v12
    v_lshrrev_b32 v11, 1, v11
    v_lshlrev_b32 v13, 1, v13
    v_or_b32 v11, v11, v13
    v_xor_b32 v11, s30, v11
    v_lshlrev_b32 v11, 5, v11
    v_add_u32 v12, v12, v11
    v_add_u32 v12, v12, v14
    v_add_u32 v6, 49152, v12
    v_and_b32 v11, 1, v2
    v_cmp_eq_u32 s[48:49], 1, v11
    v_and_b32 v12, 2, v2
    v_cmp_eq_u32 s[50:51], 2, v12
    v_lshrrev_b32 v12, 2, v2
    v_cmp_eq_u32 s[52:53], v12, v3
    v_cmp_eq_u32 s[54:55], 0, v2
    v_lshlrev_b32 v13, 2, v3
    v_add_u32 v13, v13, v11
    v_cmp_le_u32 s[56:57], v13, v2
    v_add_u32 v13, 2, v13
    v_cmp_le_u32 s[58:59], v13, v2
    v_mov_b32 v16, 0xffff
    v_mov_b32 v17, 0xffff0000
    v_cndmask_b32 v16, v16, v17, s[48:49]
    v_mov_b32 v17, 0
    v_cndmask_b32 v160, v17, v16, s[56:57]
    v_cndmask_b32 v161, v16, v17, s[56:57]
    v_cndmask_b32 v162, v17, v16, s[58:59]
    v_cndmask_b32 v163, v16, v17, s[58:59]
    v_lshlrev_b32 v11, 2, v2
    v_lshlrev_b32 v12, 4, v3
    v_add_u32 v164, 147712, v11
    v_add_u32 v166, 147712, v12
    v_mov_b32 v174, 0xbb000000
    v_mov_b32 v175, 0x3b000000
    s_mul_i32 s35, s30, 192
    s_add_u32 s35, s35, 148352
    v_add_u32 v168, s35, v12
    s_add_u32 s35, s35, 128
    v_add_u32 v169, s35, v11
    v_mul_u32_u24 v13, 144, v2
    v_lshlrev_b32 v14, 3, v3
    v_add_u32 v13, v13, v14
    s_lshl_b32 s35, s30, 5
    s_add_u32 s35, s35, 0
    v_add_u32 v167, s35, v13
    s_mov_b32 s61, 0x3eb8aa3b
    s_mov_b32 s62, 0xbb000000
    s_mov_b32 s63, 0x3b000000
    v_mov_b32 v173, 0x3727c5ac
    v_mov_b32 v20, 0x3f803f80
    v_mov_b32 v21, 0x3f803f80
    v_mov_b32 v22, 0x3f803f80
    v_mov_b32 v23, 0x3f803f80
    v_mov_b32 v24, 0
    v_mov_b32 v25, 0
    v_mov_b32 v26, 0
    v_mov_b32 v27, 0
    v_mov_b32 v28, 0
    v_mov_b32 v29, 0
    v_mov_b32 v30, 0
    v_mov_b32 v31, 0
    v_mov_b32 v32, 0
    v_mov_b32 v33, 0
    v_mov_b32 v34, 0
    v_mov_b32 v35, 0
    v_mov_b32 v36, 0
    v_mov_b32 v37, 0
    v_mov_b32 v38, 0
    v_mov_b32 v39, 0
    v_mov_b32 v40, 0
    v_mov_b32 v41, 0
    v_mov_b32 v42, 0
    v_mov_b32 v43, 0
    v_mov_b32 v44, 0
    v_mov_b32 v45, 0
    v_mov_b32 v46, 0
    v_mov_b32 v47, 0
    v_mov_b32 v48, 0
    v_mov_b32 v49, 0
    v_mov_b32 v50, 0
    v_mov_b32 v51, 0
    v_mov_b32 v52, 0
    v_mov_b32 v53, 0
    v_mov_b32 v54, 0
    v_mov_b32 v55, 0
    v_mov_b32 v56, 0
    v_mov_b32 v57, 0
    v_mov_b32 v58, 0
    v_mov_b32 v59, 0
    v_mov_b32 v60, 0
    v_mov_b32 v61, 0
    v_mov_b32 v62, 0
    v_mov_b32 v63, 0
    v_mov_b32 v64, 0
    v_mov_b32 v65, 0
    v_mov_b32 v66, 0
    v_mov_b32 v67, 0
    v_mov_b32 v68, 0
    v_mov_b32 v69, 0
    v_mov_b32 v70, 0
    v_mov_b32 v71, 0
    v_mov_b32 v72, 0
    v_mov_b32 v73, 0
    v_mov_b32 v74, 0
    v_mov_b32 v75, 0
    v_mov_b32 v76, 0
    v_mov_b32 v77, 0
    v_mov_b32 v78, 0
    v_mov_b32 v79, 0
    v_mov_b32 v80, 0
    v_mov_b32 v81, 0
    v_mov_b32 v82, 0
    v_mov_b32 v83, 0
    v_mov_b32 v84, 0
    v_mov_b32 v85, 0
    v_mov_b32 v86, 0
    v_mov_b32 v87, 0
    v_mov_b32 v88, 0
    v_mov_b32 v89, 0
    v_mov_b32 v90, 0
    v_mov_b32 v91, 0
    v_mov_b32 v92, 0
    v_mov_b32 v93, 0
    v_mov_b32 v94, 0
    v_mov_b32 v95, 0
    s_cmp_lg_u32 s28, 0
    s_cbranch_scc1 A1L0_NOONES
    v_lshlrev_b32 v11, 4, v1
    s_mov_b64 exec, 0xff
    ds_write_b128 v11, v[20:23] offset:0
    ds_write_b128 v11, v[20:23] offset:10240
    ds_write_b128 v11, v[20:23] offset:20480
    ds_write_b128 v11, v[20:23] offset:30720
    s_mov_b64 exec, -1
A1L0_NOONES:
    s_cmp_lg_u32 s28, 3
    s_cbranch_scc1 PK_NOZ
    s_add_u32 s20, s8, 16384
    s_addc_u32 s21, s9, 0
    s_mov_b32 s22, 32768
    s_mov_b32 s23, 0x20000
    v_lshrrev_b32 v11, 3, v1
    v_lshlrev_b32 v11, 13, v11
    v_and_b32 v12, 7, v1
    v_lshlrev_b32 v12, 2, v12
    v_add_u32 v11, v11, v12
    s_lshl_b32 s35, s31, 8
    s_lshl_b32 s36, s32, 5
    s_add_u32 s35, s35, s36
    v_mov_b32 v12, 0
    s_mov_b64 exec, 0xffffffff
    s_mov_b32 exec_hi, 0
    buffer_store_dword v12, v11, s[20:23], s35 offen sc1
    s_mov_b64 exec, -1
PK_NOZ:
    s_cmp_lg_u32 s28, 2
    s_cbranch_scc1 PK_NOPF
    s_getpc_b64 s[36:37]
PK_PC:
    s_lshr_b32 s38, s2, 3
    v_lshlrev_b32 v11, 5, v1
    v_add_u32 v11, s38, v11
    v_lshlrev_b32 v11, 7, v11
    s_mov_b32 s38, PK_END-PK_PC
    v_cmp_gt_u32 vcc, s38, v11
    s_nop 0
    s_and_saveexec_b64 s[42:43], vcc
    s_cbranch_execz PK_PF0
    global_load_dword v254, v11, s[36:37]
PK_PF0:
    s_mov_b64 exec, s[42:43]
PK_NOPF:
    v_lshrrev_b32 v13, 3, v1
    s_lshl_b32 s35, s28, 3
    v_add_u32 v13, s35, v13
    v_and_b32 v14, 7, v1
    v_lshlrev_b32 v14, 4, v14
    v_mul_u32_u24 v15, 144, v13
    v_add_u32 v15, v15, v14
    v_add_u32 v170, 0, v15
    v_lshlrev_b32 v13, 10, v13
    v_add_u32 v171, v13, v14
    s_lshl_b32 s36, s31, 16
    s_lshl_b32 s35, s32, 7
    s_add_u32 s36, s36, s35
    s_add_u32 s20, s8, 4718592
    s_addc_u32 s21, s9, 0
    s_mov_b32 s22, 2097152
    s_mov_b32 s23, 0x20000
    s_cmp_eq_u32 s28, 1
    s_cbranch_scc1 A1L0_V1
    s_cmp_eq_u32 s28, 2
    s_cbranch_scc1 A1L0_V2
    s_cmp_eq_u32 s28, 3
    s_cbranch_scc1 A1L0_V3
A1L0_V0:
    v_mov_b32 v8, v4
    v_mov_b32 v9, v5
    v_mov_b32 v10, v6
    s_mov_b32 s38, 1
    s_mov_b32 s39, 0
    s_waitcnt lgkmcnt(0)
    s_barrier
    ds_read_b64_tr_b16 v[100:101], v10 offset:8192
    ds_read_b64_tr_b16 v[102:103], v10 offset:8704
    ds_read_b128 v[108:111], v8 offset:0
    ds_read_b64_tr_b16 v[104:105], v10 offset:16384
    ds_read_b64_tr_b16 v[106:107], v10 offset:16896
    ds_read_b128 v[112:115], v8 offset:2048
    ds_read_b64_tr_b16 v[96:97], v10 offset:0
    ds_read_b64_tr_b16 v[98:99], v10 offset:512
    ds_read_b128 v[116:119], v8 offset:4096
    ds_read_b128 v[120:123], v8 offset:6144
    ds_read_b128 v[124:127], v8 offset:8192
A1L0_LOOP0:
    s_waitcnt lgkmcnt(0)
    v_mfma_f32_16x16x32_bf16 v[40:43], v[100:103], v[108:111], v[40:43]
    s_mul_i32 s43, s38, 10240
    s_mul_i32 s44, s38, 24576
    v_mfma_f32_16x16x32_bf16 v[60:63], v[108:111], v[104:107], v[60:63]
    v_add_u32 v14, s43, v4
    v_mfma_f32_16x16x32_bf16 v[92:95], v[96:99], v[108:111], v[92:95]
    v_add_u32 v15, s43, v5
    v_add_u32 v16, s44, v6
    v_mfma_f32_16x16x32_bf16 v[88:91], v[20:23], v[108:111], v[88:91]
    s_add_u32 s38, s38, 1
    v_mfma_f32_16x16x32_bf16 v[44:47], v[100:103], v[112:115], v[44:47]
    s_and_b32 s38, s38, 3
    ds_read_b64_tr_b16 v[132:133], v10 offset:12288
    v_mfma_f32_16x16x32_bf16 v[64:67], v[112:115], v[104:107], v[64:67]
    ds_read_b64_tr_b16 v[134:135], v10 offset:12800
    v_mfma_f32_16x16x32_bf16 v[24:27], v[96:99], v[112:115], v[24:27]
    ds_read_b128 v[140:143], v9 offset:0
    ds_read_b64_tr_b16 v[136:137], v10 offset:20480
    v_mfma_f32_16x16x32_bf16 v[80:83], v[20:23], v[112:115], v[80:83]
    ds_read_b64_tr_b16 v[138:139], v10 offset:20992
    v_mfma_f32_16x16x32_bf16 v[84:87], v[112:115], v[112:115], v[84:87]
    ds_read_b128 v[144:147], v9 offset:2048
    ds_read_b64_tr_b16 v[128:129], v10 offset:4096
    v_mfma_f32_16x16x32_bf16 v[48:51], v[100:103], v[116:119], v[48:51]
    ds_read_b64_tr_b16 v[130:131], v10 offset:4608
    v_mfma_f32_16x16x32_bf16 v[68:71], v[116:119], v[104:107], v[68:71]
    ds_read_b128 v[148:151], v9 offset:4096
    ds_read_b128 v[152:155], v9 offset:6144
    v_mfma_f32_16x16x32_bf16 v[28:31], v[96:99], v[116:119], v[28:31]
    ds_read_b128 v[156:159], v9 offset:8192
    v_mfma_f32_16x16x32_bf16 v[52:55], v[100:103], v[120:123], v[52:55]
    v_mfma_f32_16x16x32_bf16 v[72:75], v[120:123], v[104:107], v[72:75]
    v_mfma_f32_16x16x32_bf16 v[32:35], v[96:99], v[120:123], v[32:35]
    v_mfma_f32_16x16x32_bf16 v[56:59], v[100:103], v[124:127], v[56:59]
    v_mfma_f32_16x16x32_bf16 v[76:79], v[124:127], v[104:107], v[76:79]
    v_mfma_f32_16x16x32_bf16 v[36:39], v[96:99], v[124:127], v[36:39]
    s_waitcnt lgkmcnt(0)
    s_barrier
    v_mfma_f32_16x16x32_bf16 v[40:43], v[132:135], v[140:143], v[40:43]
    ds_read_b64_tr_b16 v[100:101], v16 offset:8192
    ds_read_b64_tr_b16 v[102:103], v16 offset:8704
    v_mfma_f32_16x16x32_bf16 v[60:63], v[140:143], v[136:139], v[60:63]
    ds_read_b128 v[108:111], v14 offset:0
    v_mfma_f32_16x16x32_bf16 v[92:95], v[128:131], v[140:143], v[92:95]
    ds_read_b64_tr_b16 v[104:105], v16 offset:16384
    ds_read_b64_tr_b16 v[106:107], v16 offset:16896
    v_mfma_f32_16x16x32_bf16 v[88:91], v[20:23], v[140:143], v[88:91]
    ds_read_b128 v[112:115], v14 offset:2048
    v_mfma_f32_16x16x32_bf16 v[44:47], v[132:135], v[144:147], v[44:47]
    ds_read_b64_tr_b16 v[96:97], v16 offset:0
    ds_read_b64_tr_b16 v[98:99], v16 offset:512
    v_mfma_f32_16x16x32_bf16 v[64:67], v[144:147], v[136:139], v[64:67]
    ds_read_b128 v[116:119], v14 offset:4096
    v_mfma_f32_16x16x32_bf16 v[24:27], v[128:131], v[144:147], v[24:27]
    ds_read_b128 v[120:123], v14 offset:6144
    ds_read_b128 v[124:127], v14 offset:8192
    v_mfma_f32_16x16x32_bf16 v[80:83], v[20:23], v[144:147], v[80:83]
    v_mov_b32 v8, v14
    v_mfma_f32_16x16x32_bf16 v[84:87], v[144:147], v[144:147], v[84:87]
    v_mov_b32 v9, v15
    v_mov_b32 v10, v16
    v_mfma_f32_16x16x32_bf16 v[48:51], v[132:135], v[148:151], v[48:51]
    v_mfma_f32_16x16x32_bf16 v[68:71], v[148:151], v[136:139], v[68:71]
    v_mfma_f32_16x16x32_bf16 v[28:31], v[128:131], v[148:151], v[28:31]
    v_mfma_f32_16x16x32_bf16 v[52:55], v[132:135], v[152:155], v[52:55]
    v_mfma_f32_16x16x32_bf16 v[72:75], v[152:155], v[136:139], v[72:75]
    v_mfma_f32_16x16x32_bf16 v[32:35], v[128:131], v[152:155], v[32:35]
    v_mfma_f32_16x16x32_bf16 v[56:59], v[132:135], v[156:159], v[56:59]
    v_mfma_f32_16x16x32_bf16 v[76:79], v[156:159], v[136:139], v[76:79]
    v_mfma_f32_16x16x32_bf16 v[36:39], v[128:131], v[156:159], v[36:39]
    s_add_u32 s39, s39, 1
    s_cmp_lt_u32 s39, 7
    s_cbranch_scc1 A1L0_LOOP0
    s_waitcnt lgkmcnt(8)
    v_mfma_f32_16x16x32_bf16 v[40:43], v[100:103], v[108:111], v[40:43]
    ds_read_b64_tr_b16 v[132:133], v10 offset:12288
    ds_read_b64_tr_b16 v[134:135], v10 offset:12800
    s_waitcnt lgkmcnt(8)
    v_mfma_f32_16x16x32_bf16 v[60:63], v[108:111], v[104:107], v[60:63]
    ds_read_b128 v[140:143], v9 offset:0
    s_waitcnt lgkmcnt(6)
    v_mfma_f32_16x16x32_bf16 v[92:95], v[96:99], v[108:111], v[92:95]
    ds_read_b64_tr_b16 v[136:137], v10 offset:20480
    ds_read_b64_tr_b16 v[138:139], v10 offset:20992
    v_mfma_f32_16x16x32_bf16 v[88:91], v[20:23], v[108:111], v[88:91]
    ds_read_b128 v[144:147], v9 offset:2048
    v_mfma_f32_16x16x32_bf16 v[44:47], v[100:103], v[112:115], v[44:47]
    ds_read_b64_tr_b16 v[128:129], v10 offset:4096
    ds_read_b64_tr_b16 v[130:131], v10 offset:4608
    v_mfma_f32_16x16x32_bf16 v[64:67], v[112:115], v[104:107], v[64:67]
    ds_read_b128 v[148:151], v9 offset:4096
    v_mfma_f32_16x16x32_bf16 v[24:27], v[96:99], v[112:115], v[24:27]
    ds_read_b128 v[152:155], v9 offset:6144
    ds_read_b128 v[156:159], v9 offset:8192
    v_mfma_f32_16x16x32_bf16 v[80:83], v[20:23], v[112:115], v[80:83]
    v_mfma_f32_16x16x32_bf16 v[84:87], v[112:115], v[112:115], v[84:87]
    s_waitcnt lgkmcnt(13)
    v_mfma_f32_16x16x32_bf16 v[48:51], v[100:103], v[116:119], v[48:51]
    v_mfma_f32_16x16x32_bf16 v[68:71], v[116:119], v[104:107], v[68:71]
    v_mfma_f32_16x16x32_bf16 v[28:31], v[96:99], v[116:119], v[28:31]
    s_waitcnt lgkmcnt(12)
    v_mfma_f32_16x16x32_bf16 v[52:55], v[100:103], v[120:123], v[52:55]
    v_mfma_f32_16x16x32_bf16 v[72:75], v[120:123], v[104:107], v[72:75]
    v_mfma_f32_16x16x32_bf16 v[32:35], v[96:99], v[120:123], v[32:35]
    s_waitcnt lgkmcnt(11)
    v_mfma_f32_16x16x32_bf16 v[56:59], v[100:103], v[124:127], v[56:59]
    v_mfma_f32_16x16x32_bf16 v[76:79], v[124:127], v[104:107], v[76:79]
    v_mfma_f32_16x16x32_bf16 v[36:39], v[96:99], v[124:127], v[36:39]
    s_waitcnt lgkmcnt(8)
    v_mfma_f32_16x16x32_bf16 v[40:43], v[132:135], v[140:143], v[40:43]
    s_waitcnt lgkmcnt(6)
    v_mfma_f32_16x16x32_bf16 v[60:63], v[140:143], v[136:139], v[60:63]
    s_waitcnt lgkmcnt(3)
    v_mfma_f32_16x16x32_bf16 v[92:95], v[128:131], v[140:143], v[92:95]
    v_mfma_f32_16x16x32_bf16 v[88:91], v[20:23], v[140:143], v[88:91]
    v_mfma_f32_16x16x32_bf16 v[44:47], v[132:135], v[144:147], v[44:47]
    v_mfma_f32_16x16x32_bf16 v[64:67], v[144:147], v[136:139], v[64:67]
    v_mfma_f32_16x16x32_bf16 v[24:27], v[128:131], v[144:147], v[24:27]
    v_mfma_f32_16x16x32_bf16 v[80:83], v[20:23], v[144:147], v[80:83]
    v_mfma_f32_16x16x32_bf16 v[84:87], v[144:147], v[144:147], v[84:87]
    s_waitcnt lgkmcnt(2)
    v_mfma_f32_16x16x32_bf16 v[48:51], v[132:135], v[148:151], v[48:51]
    v_mfma_f32_16x16x32_bf16 v[68:71], v[148:151], v[136:139], v[68:71]
    v_mfma_f32_16x16x32_bf16 v[28:31], v[128:131], v[148:151], v[28:31]
    s_waitcnt lgkmcnt(1)
    v_mfma_f32_16x16x32_bf16 v[52:55], v[132:135], v[152:155], v[52:55]
    v_mfma_f32_16x16x32_bf16 v[72:75], v[152:155], v[136:139], v[72:75]
    v_mfma_f32_16x16x32_bf16 v[32:35], v[128:131], v[152:155], v[32:35]
    s_waitcnt lgkmcnt(0)
    v_mfma_f32_16x16x32_bf16 v[56:59], v[132:135], v[156:159], v[56:59]
    v_mfma_f32_16x16x32_bf16 v[76:79], v[156:159], v[136:139], v[76:79]
    v_mfma_f32_16x16x32_bf16 v[36:39], v[128:131], v[156:159], v[36:39]
    s_nop 7
    v_cndmask_b32 v12, v84, v85, s[48:49]
    v_cndmask_b32 v13, v86, v87, s[48:49]
    v_mul_f32 v14, s62, v80
    v_cndmask_b32 v12, v12, v13, s[50:51]
    v_cndmask_b32 v12, 0, v12, s[52:53]
    v_mov_b32 v13, v12
    s_nop 1
    v_permlane16_swap_b32 v12, v13
    v_add_f32 v12, v12, v13
    v_mov_b32 v13, v12
    s_nop 1
    v_permlane32_swap_b32 v12, v13
    v_add_f32 v12, v12, v13
    v_fma_f32 v12, v12, s63, v173
    v_fma_f32 v12, -v14, v14, v12
    v_max_f32 v12, v173, v12
    v_rsq_f32 v12, v12
    s_mov_b64 exec, 0xffff
    ds_write_b32 v164, v14 offset:128
    ds_write_b32 v164, v12 offset:192
    s_mov_b64 exec, -1
    s_mov_b64 exec, 0xffff
    ds_write_b32 v164, v88 offset:0
    s_mov_b64 exec, -1
    s_waitcnt lgkmcnt(0)
    s_barrier
    s_branch A1L0_EP
A1L0_V1:
    v_mov_b32 v8, v4
    v_mov_b32 v9, v5
    v_mov_b32 v10, v6
    s_mov_b32 s38, 1
    s_mov_b32 s39, 0
    s_waitcnt lgkmcnt(0)
    s_barrier
    ds_read_b64_tr_b16 v[100:101], v10 offset:8192
    ds_read_b64_tr_b16 v[102:103], v10 offset:8704
    ds_read_b128 v[108:111], v8 offset:0
    ds_read_b64_tr_b16 v[104:105], v10 offset:16384
    ds_read_b64_tr_b16 v[106:107], v10 offset:16896
    ds_read_b128 v[112:115], v8 offset:2048
    ds_read_b64_tr_b16 v[96:97], v10 offset:0
    ds_read_b64_tr_b16 v[98:99], v10 offset:512
    ds_read_b128 v[116:119], v8 offset:4096
    ds_read_b128 v[120:123], v8 offset:6144
    ds_read_b128 v[124:127], v8 offset:8192
A1L0_LOOP1:
    s_waitcnt lgkmcnt(0)
    v_mfma_f32_16x16x32_bf16 v[40:43], v[100:103], v[108:111], v[40:43]
    s_mul_i32 s43, s38, 10240
    s_mul_i32 s44, s38, 24576
    v_mfma_f32_16x16x32_bf16 v[60:63], v[108:111], v[104:107], v[60:63]
    v_add_u32 v14, s43, v4
    v_mfma_f32_16x16x32_bf16 v[92:95], v[96:99], v[108:111], v[92:95]
    v_add_u32 v15, s43, v5
    v_add_u32 v16, s44, v6
    v_mfma_f32_16x16x32_bf16 v[88:91], v[108:111], v[108:111], v[88:91]
    s_add_u32 s38, s38, 1
    v_mfma_f32_16x16x32_bf16 v[44:47], v[100:103], v[112:115], v[44:47]
    s_and_b32 s38, s38, 3
    ds_read_b64_tr_b16 v[132:133], v10 offset:12288
    v_mfma_f32_16x16x32_bf16 v[64:67], v[112:115], v[104:107], v[64:67]
    ds_read_b64_tr_b16 v[134:135], v10 offset:12800
    v_mfma_f32_16x16x32_bf16 v[24:27], v[96:99], v[112:115], v[24:27]
    ds_read_b128 v[140:143], v9 offset:0
    ds_read_b64_tr_b16 v[136:137], v10 offset:20480
    v_mfma_f32_16x16x32_bf16 v[48:51], v[100:103], v[116:119], v[48:51]
    ds_read_b64_tr_b16 v[138:139], v10 offset:20992
    v_mfma_f32_16x16x32_bf16 v[68:71], v[116:119], v[104:107], v[68:71]
    ds_read_b128 v[144:147], v9 offset:2048
    ds_read_b64_tr_b16 v[128:129], v10 offset:4096
    v_mfma_f32_16x16x32_bf16 v[28:31], v[96:99], v[116:119], v[28:31]
    ds_read_b64_tr_b16 v[130:131], v10 offset:4608
    v_mfma_f32_16x16x32_bf16 v[80:83], v[20:23], v[116:119], v[80:83]
    ds_read_b128 v[148:151], v9 offset:4096
    ds_read_b128 v[152:155], v9 offset:6144
    v_mfma_f32_16x16x32_bf16 v[84:87], v[116:119], v[116:119], v[84:87]
    ds_read_b128 v[156:159], v9 offset:8192
    v_mfma_f32_16x16x32_bf16 v[52:55], v[100:103], v[120:123], v[52:55]
    v_mfma_f32_16x16x32_bf16 v[72:75], v[120:123], v[104:107], v[72:75]
    v_mfma_f32_16x16x32_bf16 v[32:35], v[96:99], v[120:123], v[32:35]
    v_mfma_f32_16x16x32_bf16 v[56:59], v[100:103], v[124:127], v[56:59]
    v_mfma_f32_16x16x32_bf16 v[76:79], v[124:127], v[104:107], v[76:79]
    v_mfma_f32_16x16x32_bf16 v[36:39], v[96:99], v[124:127], v[36:39]
    s_waitcnt lgkmcnt(0)
    s_barrier
    v_mfma_f32_16x16x32_bf16 v[40:43], v[132:135], v[140:143], v[40:43]
    ds_read_b64_tr_b16 v[100:101], v16 offset:8192
    ds_read_b64_tr_b16 v[102:103], v16 offset:8704
    v_mfma_f32_16x16x32_bf16 v[60:63], v[140:143], v[136:139], v[60:63]
    ds_read_b128 v[108:111], v14 offset:0
    v_mfma_f32_16x16x32_bf16 v[92:95], v[128:131], v[140:143], v[92:95]
    ds_read_b64_tr_b16 v[104:105], v16 offset:16384
    ds_read_b64_tr_b16 v[106:107], v16 offset:16896
    v_mfma_f32_16x16x32_bf16 v[88:91], v[140:143], v[140:143], v[88:91]
    ds_read_b128 v[112:115], v14 offset:2048
    v_mfma_f32_16x16x32_bf16 v[44:47], v[132:135], v[144:147], v[44:47]
    ds_read_b64_tr_b16 v[96:97], v16 offset:0
    ds_read_b64_tr_b16 v[98:99], v16 offset:512
    v_mfma_f32_16x16x32_bf16 v[64:67], v[144:147], v[136:139], v[64:67]
    ds_read_b128 v[116:119], v14 offset:4096
    v_mfma_f32_16x16x32_bf16 v[24:27], v[128:131], v[144:147], v[24:27]
    ds_read_b128 v[120:123], v14 offset:6144
    ds_read_b128 v[124:127], v14 offset:8192
    v_mfma_f32_16x16x32_bf16 v[48:51], v[132:135], v[148:151], v[48:51]
    v_mov_b32 v8, v14
    v_mfma_f32_16x16x32_bf16 v[68:71], v[148:151], v[136:139], v[68:71]
    v_mov_b32 v9, v15
    v_mov_b32 v10, v16
    v_mfma_f32_16x16x32_bf16 v[28:31], v[128:131], v[148:151], v[28:31]
    v_mfma_f32_16x16x32_bf16 v[80:83], v[20:23], v[148:151], v[80:83]
    v_mfma_f32_16x16x32_bf16 v[84:87], v[148:151], v[148:151], v[84:87]
    v_mfma_f32_16x16x32_bf16 v[52:55], v[132:135], v[152:155], v[52:55]
    v_mfma_f32_16x16x32_bf16 v[72:75], v[152:155], v[136:139], v[72:75]
    v_mfma_f32_16x16x32_bf16 v[32:35], v[128:131], v[152:155], v[32:35]
    v_mfma_f32_16x16x32_bf16 v[56:59], v[132:135], v[156:159], v[56:59]
    v_mfma_f32_16x16x32_bf16 v[76:79], v[156:159], v[136:139], v[76:79]
    v_mfma_f32_16x16x32_bf16 v[36:39], v[128:131], v[156:159], v[36:39]
    s_add_u32 s39, s39, 1
    s_cmp_lt_u32 s39, 7
    s_cbranch_scc1 A1L0_LOOP1
    s_waitcnt lgkmcnt(8)
    v_mfma_f32_16x16x32_bf16 v[40:43], v[100:103], v[108:111], v[40:43]
    ds_read_b64_tr_b16 v[132:133], v10 offset:12288
    ds_read_b64_tr_b16 v[134:135], v10 offset:12800
    s_waitcnt lgkmcnt(8)
    v_mfma_f32_16x16x32_bf16 v[60:63], v[108:111], v[104:107], v[60:63]
    ds_read_b128 v[140:143], v9 offset:0
    s_waitcnt lgkmcnt(6)
    v_mfma_f32_16x16x32_bf16 v[92:95], v[96:99], v[108:111], v[92:95]
    ds_read_b64_tr_b16 v[136:137], v10 offset:20480
    ds_read_b64_tr_b16 v[138:139], v10 offset:20992
    v_mfma_f32_16x16x32_bf16 v[88:91], v[108:111], v[108:111], v[88:91]
    ds_read_b128 v[144:147], v9 offset:2048
    v_mfma_f32_16x16x32_bf16 v[44:47], v[100:103], v[112:115], v[44:47]
    ds_read_b64_tr_b16 v[128:129], v10 offset:4096
    ds_read_b64_tr_b16 v[130:131], v10 offset:4608
    v_mfma_f32_16x16x32_bf16 v[64:67], v[112:115], v[104:107], v[64:67]
    ds_read_b128 v[148:151], v9 offset:4096
    v_mfma_f32_16x16x32_bf16 v[24:27], v[96:99], v[112:115], v[24:27]
    ds_read_b128 v[152:155], v9 offset:6144
    ds_read_b128 v[156:159], v9 offset:8192
    s_waitcnt lgkmcnt(13)
    v_mfma_f32_16x16x32_bf16 v[48:51], v[100:103], v[116:119], v[48:51]
    v_mfma_f32_16x16x32_bf16 v[68:71], v[116:119], v[104:107], v[68:71]
    v_mfma_f32_16x16x32_bf16 v[28:31], v[96:99], v[116:119], v[28:31]
    v_mfma_f32_16x16x32_bf16 v[80:83], v[20:23], v[116:119], v[80:83]
    v_mfma_f32_16x16x32_bf16 v[84:87], v[116:119], v[116:119], v[84:87]
    s_waitcnt lgkmcnt(12)
    v_mfma_f32_16x16x32_bf16 v[52:55], v[100:103], v[120:123], v[52:55]
    v_mfma_f32_16x16x32_bf16 v[72:75], v[120:123], v[104:107], v[72:75]
    v_mfma_f32_16x16x32_bf16 v[32:35], v[96:99], v[120:123], v[32:35]
    s_waitcnt lgkmcnt(11)
    v_mfma_f32_16x16x32_bf16 v[56:59], v[100:103], v[124:127], v[56:59]
    v_mfma_f32_16x16x32_bf16 v[76:79], v[124:127], v[104:107], v[76:79]
    v_mfma_f32_16x16x32_bf16 v[36:39], v[96:99], v[124:127], v[36:39]
    s_waitcnt lgkmcnt(8)
    v_mfma_f32_16x16x32_bf16 v[40:43], v[132:135], v[140:143], v[40:43]
    s_waitcnt lgkmcnt(6)
    v_mfma_f32_16x16x32_bf16 v[60:63], v[140:143], v[136:139], v[60:63]
    s_waitcnt lgkmcnt(3)
    v_mfma_f32_16x16x32_bf16 v[92:95], v[128:131], v[140:143], v[92:95]
    v_mfma_f32_16x16x32_bf16 v[88:91], v[140:143], v[140:143], v[88:91]
    v_mfma_f32_16x16x32_bf16 v[44:47], v[132:135], v[144:147], v[44:47]
    v_mfma_f32_16x16x32_bf16 v[64:67], v[144:147], v[136:139], v[64:67]
    v_mfma_f32_16x16x32_bf16 v[24:27], v[128:131], v[144:147], v[24:27]
    s_waitcnt lgkmcnt(2)
    v_mfma_f32_16x16x32_bf16 v[48:51], v[132:135], v[148:151], v[48:51]
    v_mfma_f32_16x16x32_bf16 v[68:71], v[148:151], v[136:139], v[68:71]
    v_mfma_f32_16x16x32_bf16 v[28:31], v[128:131], v[148:151], v[28:31]
    v_mfma_f32_16x16x32_bf16 v[80:83], v[20:23], v[148:151], v[80:83]
    v_mfma_f32_16x16x32_bf16 v[84:87], v[148:151], v[148:151], v[84:87]
    s_waitcnt lgkmcnt(1)
    v_mfma_f32_16x16x32_bf16 v[52:55], v[132:135], v[152:155], v[52:55]
    v_mfma_f32_16x16x32_bf16 v[72:75], v[152:155], v[136:139], v[72:75]
    v_mfma_f32_16x16x32_bf16 v[32:35], v[128:131], v[152:155], v[32:35]
    s_waitcnt lgkmcnt(0)
    v_mfma_f32_16x16x32_bf16 v[56:59], v[132:135], v[156:159], v[56:59]
    v_mfma_f32_16x16x32_bf16 v[76:79], v[156:159], v[136:139], v[76:79]
    v_mfma_f32_16x16x32_bf16 v[36:39], v[128:131], v[156:159], v[36:39]
    s_nop 7
    v_cndmask_b32 v12, v84, v85, s[48:49]
    v_cndmask_b32 v13, v86, v87, s[48:49]
    v_mul_f32 v14, s62, v80
    v_cndmask_b32 v12, v12, v13, s[50:51]
    v_cndmask_b32 v12, 0, v12, s[52:53]
    v_mov_b32 v13, v12
    s_nop 1
    v_permlane16_swap_b32 v12, v13
    v_add_f32 v12, v12, v13
    v_mov_b32 v13, v12
    s_nop 1
    v_permlane32_swap_b32 v12, v13
    v_add_f32 v12, v12, v13
    v_fma_f32 v12, v12, s63, v173
    v_fma_f32 v12, -v14, v14, v12
    v_max_f32 v12, v173, v12
    v_rsq_f32 v12, v12
    s_mov_b64 exec, 0xffff
    ds_write_b32 v164, v14 offset:256
    ds_write_b32 v164, v12 offset:320
    s_mov_b64 exec, -1
    v_cndmask_b32 v12, v88, v89, s[48:49]
    v_cndmask_b32 v13, v90, v91, s[48:49]
    v_cndmask_b32 v12, v12, v13, s[50:51]
    s_mov_b64 exec, s[52:53]
    ds_write_b32 v164, v12 offset:64
    s_mov_b64 exec, -1
    s_waitcnt lgkmcnt(0)
    s_barrier
    s_branch A1L0_EP
A1L0_V2:
    v_mov_b32 v8, v4
    v_mov_b32 v9, v5
    v_mov_b32 v10, v6
    s_mov_b32 s38, 1
    s_mov_b32 s39, 0
    s_waitcnt lgkmcnt(0)
    s_barrier
    ds_read_b64_tr_b16 v[100:101], v10 offset:8192
    ds_read_b64_tr_b16 v[102:103], v10 offset:8704
    ds_read_b128 v[108:111], v8 offset:0
    ds_read_b64_tr_b16 v[104:105], v10 offset:16384
    ds_read_b64_tr_b16 v[106:107], v10 offset:16896
    ds_read_b128 v[112:115], v8 offset:2048
    ds_read_b64_tr_b16 v[96:97], v10 offset:0
    ds_read_b64_tr_b16 v[98:99], v10 offset:512
    ds_read_b128 v[116:119], v8 offset:4096
    ds_read_b128 v[120:123], v8 offset:6144
    ds_read_b128 v[124:127], v8 offset:8192
A1L0_LOOP2:
    s_waitcnt lgkmcnt(0)
    v_mfma_f32_16x16x32_bf16 v[40:43], v[100:103], v[108:111], v[40:43]
    s_mul_i32 s43, s38, 10240
    s_mul_i32 s44, s38, 24576
    v_mfma_f32_16x16x32_bf16 v[60:63], v[108:111], v[104:107], v[60:63]
    v_add_u32 v14, s43, v4
    v_mfma_f32_16x16x32_bf16 v[92:95], v[96:99], v[108:111], v[92:95]
    v_add_u32 v15, s43, v5
    v_add_u32 v16, s44, v6
    v_mfma_f32_16x16x32_bf16 v[44:47], v[100:103], v[112:115], v[44:47]
    s_add_u32 s38, s38, 1
    v_mfma_f32_16x16x32_bf16 v[64:67], v[112:115], v[104:107], v[64:67]
    s_and_b32 s38, s38, 3
    ds_read_b64_tr_b16 v[132:133], v10 offset:12288
    v_mfma_f32_16x16x32_bf16 v[24:27], v[96:99], v[112:115], v[24:27]
    ds_read_b64_tr_b16 v[134:135], v10 offset:12800
    v_mfma_f32_16x16x32_bf16 v[48:51], v[100:103], v[116:119], v[48:51]
    ds_read_b128 v[140:143], v9 offset:0
    ds_read_b64_tr_b16 v[136:137], v10 offset:20480
    v_mfma_f32_16x16x32_bf16 v[68:71], v[116:119], v[104:107], v[68:71]
    ds_read_b64_tr_b16 v[138:139], v10 offset:20992
    v_mfma_f32_16x16x32_bf16 v[28:31], v[96:99], v[116:119], v[28:31]
    ds_read_b128 v[144:147], v9 offset:2048
    ds_read_b64_tr_b16 v[128:129], v10 offset:4096
    v_mfma_f32_16x16x32_bf16 v[52:55], v[100:103], v[120:123], v[52:55]
    ds_read_b64_tr_b16 v[130:131], v10 offset:4608
    v_mfma_f32_16x16x32_bf16 v[72:75], v[120:123], v[104:107], v[72:75]
    ds_read_b128 v[148:151], v9 offset:4096
    ds_read_b128 v[152:155], v9 offset:6144
    v_mfma_f32_16x16x32_bf16 v[32:35], v[96:99], v[120:123], v[32:35]
    ds_read_b128 v[156:159], v9 offset:8192
    v_mfma_f32_16x16x32_bf16 v[80:83], v[20:23], v[120:123], v[80:83]
    v_mfma_f32_16x16x32_bf16 v[84:87], v[120:123], v[120:123], v[84:87]
    v_mfma_f32_16x16x32_bf16 v[56:59], v[100:103], v[124:127], v[56:59]
    v_mfma_f32_16x16x32_bf16 v[76:79], v[124:127], v[104:107], v[76:79]
    v_mfma_f32_16x16x32_bf16 v[36:39], v[96:99], v[124:127], v[36:39]
    s_waitcnt lgkmcnt(0)
    s_barrier
    v_mfma_f32_16x16x32_bf16 v[40:43], v[132:135], v[140:143], v[40:43]
    ds_read_b64_tr_b16 v[100:101], v16 offset:8192
    ds_read_b64_tr_b16 v[102:103], v16 offset:8704
    v_mfma_f32_16x16x32_bf16 v[60:63], v[140:143], v[136:139], v[60:63]
    ds_read_b128 v[108:111], v14 offset:0
    v_mfma_f32_16x16x32_bf16 v[92:95], v[128:131], v[140:143], v[92:95]
    ds_read_b64_tr_b16 v[104:105], v16 offset:16384
    ds_read_b64_tr_b16 v[106:107], v16 offset:16896
    v_mfma_f32_16x16x32_bf16 v[44:47], v[132:135], v[144:147], v[44:47]
    ds_read_b128 v[112:115], v14 offset:2048
    v_mfma_f32_16x16x32_bf16 v[64:67], v[144:147], v[136:139], v[64:67]
    ds_read_b64_tr_b16 v[96:97], v16 offset:0
    ds_read_b64_tr_b16 v[98:99], v16 offset:512
    v_mfma_f32_16x16x32_bf16 v[24:27], v[128:131], v[144:147], v[24:27]
    ds_read_b128 v[116:119], v14 offset:4096
    v_mfma_f32_16x16x32_bf16 v[48:51], v[132:135], v[148:151], v[48:51]
    ds_read_b128 v[120:123], v14 offset:6144
    ds_read_b128 v[124:127], v14 offset:8192
    v_mfma_f32_16x16x32_bf16 v[68:71], v[148:151], v[136:139], v[68:71]
    v_mov_b32 v8, v14
    v_mfma_f32_16x16x32_bf16 v[28:31], v[128:131], v[148:151], v[28:31]
    v_mov_b32 v9, v15
    v_mov_b32 v10, v16
    v_mfma_f32_16x16x32_bf16 v[52:55], v[132:135], v[152:155], v[52:55]
    v_mfma_f32_16x16x32_bf16 v[72:75], v[152:155], v[136:139], v[72:75]
    v_mfma_f32_16x16x32_bf16 v[32:35], v[128:131], v[152:155], v[32:35]
    v_mfma_f32_16x16x32_bf16 v[80:83], v[20:23], v[152:155], v[80:83]
    v_mfma_f32_16x16x32_bf16 v[84:87], v[152:155], v[152:155], v[84:87]
    v_mfma_f32_16x16x32_bf16 v[56:59], v[132:135], v[156:159], v[56:59]
    v_mfma_f32_16x16x32_bf16 v[76:79], v[156:159], v[136:139], v[76:79]
    v_mfma_f32_16x16x32_bf16 v[36:39], v[128:131], v[156:159], v[36:39]
    s_add_u32 s39, s39, 1
    s_cmp_lt_u32 s39, 7
    s_cbranch_scc1 A1L0_LOOP2
    s_waitcnt lgkmcnt(8)
    v_mfma_f32_16x16x32_bf16 v[40:43], v[100:103], v[108:111], v[40:43]
    ds_read_b64_tr_b16 v[132:133], v10 offset:12288
    ds_read_b64_tr_b16 v[134:135], v10 offset:12800
    s_waitcnt lgkmcnt(8)
    v_mfma_f32_16x16x32_bf16 v[60:63], v[108:111], v[104:107], v[60:63]
    ds_read_b128 v[140:143], v9 offset:0
    s_waitcnt lgkmcnt(6)
    v_mfma_f32_16x16x32_bf16 v[92:95], v[96:99], v[108:111], v[92:95]
    ds_read_b64_tr_b16 v[136:137], v10 offset:20480
    ds_read_b64_tr_b16 v[138:139], v10 offset:20992
    v_mfma_f32_16x16x32_bf16 v[44:47], v[100:103], v[112:115], v[44:47]
    ds_read_b128 v[144:147], v9 offset:2048
    v_mfma_f32_16x16x32_bf16 v[64:67], v[112:115], v[104:107], v[64:67]
    ds_read_b64_tr_b16 v[128:129], v10 offset:4096
    ds_read_b64_tr_b16 v[130:131], v10 offset:4608
    v_mfma_f32_16x16x32_bf16 v[24:27], v[96:99], v[112:115], v[24:27]
    ds_read_b128 v[148:151], v9 offset:4096
    s_waitcnt lgkmcnt(11)
    v_mfma_f32_16x16x32_bf16 v[48:51], v[100:103], v[116:119], v[48:51]
    ds_read_b128 v[152:155], v9 offset:6144
    ds_read_b128 v[156:159], v9 offset:8192
    v_mfma_f32_16x16x32_bf16 v[68:71], v[116:119], v[104:107], v[68:71]
    v_mfma_f32_16x16x32_bf16 v[28:31], v[96:99], v[116:119], v[28:31]
    s_waitcnt lgkmcnt(12)
    v_mfma_f32_16x16x32_bf16 v[52:55], v[100:103], v[120:123], v[52:55]
    v_mfma_f32_16x16x32_bf16 v[72:75], v[120:123], v[104:107], v[72:75]
    v_mfma_f32_16x16x32_bf16 v[32:35], v[96:99], v[120:123], v[32:35]
    v_mfma_f32_16x16x32_bf16 v[80:83], v[20:23], v[120:123], v[80:83]
    v_mfma_f32_16x16x32_bf16 v[84:87], v[120:123], v[120:123], v[84:87]
    s_waitcnt lgkmcnt(11)
    v_mfma_f32_16x16x32_bf16 v[56:59], v[100:103], v[124:127], v[56:59]
    v_mfma_f32_16x16x32_bf16 v[76:79], v[124:127], v[104:107], v[76:79]
    v_mfma_f32_16x16x32_bf16 v[36:39], v[96:99], v[124:127], v[36:39]
    s_waitcnt lgkmcnt(8)
    v_mfma_f32_16x16x32_bf16 v[40:43], v[132:135], v[140:143], v[40:43]
    s_waitcnt lgkmcnt(6)
    v_mfma_f32_16x16x32_bf16 v[60:63], v[140:143], v[136:139], v[60:63]
    s_waitcnt lgkmcnt(3)
    v_mfma_f32_16x16x32_bf16 v[92:95], v[128:131], v[140:143], v[92:95]
    v_mfma_f32_16x16x32_bf16 v[44:47], v[132:135], v[144:147], v[44:47]
    v_mfma_f32_16x16x32_bf16 v[64:67], v[144:147], v[136:139], v[64:67]
    v_mfma_f32_16x16x32_bf16 v[24:27], v[128:131], v[144:147], v[24:27]
    s_waitcnt lgkmcnt(2)
    v_mfma_f32_16x16x32_bf16 v[48:51], v[132:135], v[148:151], v[48:51]
    v_mfma_f32_16x16x32_bf16 v[68:71], v[148:151], v[136:139], v[68:71]
    v_mfma_f32_16x16x32_bf16 v[28:31], v[128:131], v[148:151], v[28:31]
    s_waitcnt lgkmcnt(1)
    v_mfma_f32_16x16x32_bf16 v[52:55], v[132:135], v[152:155], v[52:55]
    v_mfma_f32_16x16x32_bf16 v[72:75], v[152:155], v[136:139], v[72:75]
    v_mfma_f32_16x16x32_bf16 v[32:35], v[128:131], v[152:155], v[32:35]
    v_mfma_f32_16x16x32_bf16 v[80:83], v[20:23], v[152:155], v[80:83]
    v_mfma_f32_16x16x32_bf16 v[84:87], v[152:155], v[152:155], v[84:87]
    s_waitcnt lgkmcnt(0)
    v_mfma_f32_16x16x32_bf16 v[56:59], v[132:135], v[156:159], v[56:59]
    v_mfma_f32_16x16x32_bf16 v[76:79], v[156:159], v[136:139], v[76:79]
    v_mfma_f32_16x16x32_bf16 v[36:39], v[128:131], v[156:159], v[36:39]
    s_nop 7
    v_cndmask_b32 v12, v84, v85, s[48:49]
    v_cndmask_b32 v13, v86, v87, s[48:49]
    v_mul_f32 v14, s62, v80
    v_cndmask_b32 v12, v12, v13, s[50:51]
    v_cndmask_b32 v12, 0, v12, s[52:53]
    v_mov_b32 v13, v12
    s_nop 1
    v_permlane16_swap_b32 v12, v13
    v_add_f32 v12, v12, v13
    v_mov_b32 v13, v12
    s_nop 1
    v_permlane32_swap_b32 v12, v13
    v_add_f32 v12, v12, v13
    v_fma_f32 v12, v12, s63, v173
    v_fma_f32 v12, -v14, v14, v12
    v_max_f32 v12, v173, v12
    v_rsq_f32 v12, v12
    s_mov_b64 exec, 0xffff
    ds_write_b32 v164, v14 offset:384
    ds_write_b32 v164, v12 offset:448
    s_mov_b64 exec, -1
    s_waitcnt lgkmcnt(0)
    s_barrier
    s_branch A1L0_EP
A1L0_V3:
    v_mov_b32 v8, v4
    v_mov_b32 v9, v5
    v_mov_b32 v10, v6
    s_mov_b32 s38, 1
    s_mov_b32 s39, 0
    s_waitcnt lgkmcnt(0)
    s_barrier
    ds_read_b64_tr_b16 v[100:101], v10 offset:8192
    ds_read_b64_tr_b16 v[102:103], v10 offset:8704
    ds_read_b128 v[108:111], v8 offset:0
    ds_read_b64_tr_b16 v[104:105], v10 offset:16384
    ds_read_b64_tr_b16 v[106:107], v10 offset:16896
    ds_read_b128 v[112:115], v8 offset:2048
    ds_read_b64_tr_b16 v[96:97], v10 offset:0
    ds_read_b64_tr_b16 v[98:99], v10 offset:512
    ds_read_b128 v[116:119], v8 offset:4096
    ds_read_b128 v[120:123], v8 offset:6144
    ds_read_b128 v[124:127], v8 offset:8192
A1L0_LOOP3:
    s_waitcnt lgkmcnt(0)
    v_mfma_f32_16x16x32_bf16 v[40:43], v[100:103], v[108:111], v[40:43]
    s_mul_i32 s43, s38, 10240
    s_mul_i32 s44, s38, 24576
    v_mfma_f32_16x16x32_bf16 v[60:63], v[108:111], v[104:107], v[60:63]
    v_add_u32 v14, s43, v4
    v_mfma_f32_16x16x32_bf16 v[92:95], v[96:99], v[108:111], v[92:95]
    v_add_u32 v15, s43, v5
    v_add_u32 v16, s44, v6
    v_mfma_f32_16x16x32_bf16 v[44:47], v[100:103], v[112:115], v[44:47]
    s_add_u32 s38, s38, 1
    v_mfma_f32_16x16x32_bf16 v[64:67], v[112:115], v[104:107], v[64:67]
    s_and_b32 s38, s38, 3
    ds_read_b64_tr_b16 v[132:133], v10 offset:12288
    v_mfma_f32_16x16x32_bf16 v[24:27], v[96:99], v[112:115], v[24:27]
    ds_read_b64_tr_b16 v[134:135], v10 offset:12800
    v_mfma_f32_16x16x32_bf16 v[48:51], v[100:103], v[116:119], v[48:51]
    ds_read_b128 v[140:143], v9 offset:0
    ds_read_b64_tr_b16 v[136:137], v10 offset:20480
    v_mfma_f32_16x16x32_bf16 v[68:71], v[116:119], v[104:107], v[68:71]
    ds_read_b64_tr_b16 v[138:139], v10 offset:20992
    v_mfma_f32_16x16x32_bf16 v[28:31], v[96:99], v[116:119], v[28:31]
    ds_read_b128 v[144:147], v9 offset:2048
    ds_read_b64_tr_b16 v[128:129], v10 offset:4096
    v_mfma_f32_16x16x32_bf16 v[52:55], v[100:103], v[120:123], v[52:55]
    ds_read_b64_tr_b16 v[130:131], v10 offset:4608
    v_mfma_f32_16x16x32_bf16 v[72:75], v[120:123], v[104:107], v[72:75]
    ds_read_b128 v[148:151], v9 offset:4096
    ds_read_b128 v[152:155], v9 offset:6144
    v_mfma_f32_16x16x32_bf16 v[32:35], v[96:99], v[120:123], v[32:35]
    ds_read_b128 v[156:159], v9 offset:8192
    v_mfma_f32_16x16x32_bf16 v[56:59], v[100:103], v[124:127], v[56:59]
    v_mfma_f32_16x16x32_bf16 v[76:79], v[124:127], v[104:107], v[76:79]
    v_mfma_f32_16x16x32_bf16 v[36:39], v[96:99], v[124:127], v[36:39]
    v_mfma_f32_16x16x32_bf16 v[80:83], v[20:23], v[124:127], v[80:83]
    v_mfma_f32_16x16x32_bf16 v[84:87], v[124:127], v[124:127], v[84:87]
    s_waitcnt lgkmcnt(0)
    s_barrier
    v_mfma_f32_16x16x32_bf16 v[40:43], v[132:135], v[140:143], v[40:43]
    ds_read_b64_tr_b16 v[100:101], v16 offset:8192
    ds_read_b64_tr_b16 v[102:103], v16 offset:8704
    v_mfma_f32_16x16x32_bf16 v[60:63], v[140:143], v[136:139], v[60:63]
    ds_read_b128 v[108:111], v14 offset:0
    v_mfma_f32_16x16x32_bf16 v[92:95], v[128:131], v[140:143], v[92:95]
    ds_read_b64_tr_b16 v[104:105], v16 offset:16384
    ds_read_b64_tr_b16 v[106:107], v16 offset:16896
    v_mfma_f32_16x16x32_bf16 v[44:47], v[132:135], v[144:147], v[44:47]
    ds_read_b128 v[112:115], v14 offset:2048
    v_mfma_f32_16x16x32_bf16 v[64:67], v[144:147], v[136:139], v[64:67]
    ds_read_b64_tr_b16 v[96:97], v16 offset:0
    ds_read_b64_tr_b16 v[98:99], v16 offset:512
    v_mfma_f32_16x16x32_bf16 v[24:27], v[128:131], v[144:147], v[24:27]
    ds_read_b128 v[116:119], v14 offset:4096
    v_mfma_f32_16x16x32_bf16 v[48:51], v[132:135], v[148:151], v[48:51]
    ds_read_b128 v[120:123], v14 offset:6144
    ds_read_b128 v[124:127], v14 offset:8192
    v_mfma_f32_16x16x32_bf16 v[68:71], v[148:151], v[136:139], v[68:71]
    v_mov_b32 v8, v14
    v_mfma_f32_16x16x32_bf16 v[28:31], v[128:131], v[148:151], v[28:31]
    v_mov_b32 v9, v15
    v_mov_b32 v10, v16
    v_mfma_f32_16x16x32_bf16 v[52:55], v[132:135], v[152:155], v[52:55]
    v_mfma_f32_16x16x32_bf16 v[72:75], v[152:155], v[136:139], v[72:75]
    v_mfma_f32_16x16x32_bf16 v[32:35], v[128:131], v[152:155], v[32:35]
    v_mfma_f32_16x16x32_bf16 v[56:59], v[132:135], v[156:159], v[56:59]
    v_mfma_f32_16x16x32_bf16 v[76:79], v[156:159], v[136:139], v[76:79]
    v_mfma_f32_16x16x32_bf16 v[36:39], v[128:131], v[156:159], v[36:39]
    v_mfma_f32_16x16x32_bf16 v[80:83], v[20:23], v[156:159], v[80:83]
    v_mfma_f32_16x16x32_bf16 v[84:87], v[156:159], v[156:159], v[84:87]
    s_add_u32 s39, s39, 1
    s_cmp_lt_u32 s39, 7
    s_cbranch_scc1 A1L0_LOOP3
    s_waitcnt lgkmcnt(8)
    v_mfma_f32_16x16x32_bf16 v[40:43], v[100:103], v[108:111], v[40:43]
    ds_read_b64_tr_b16 v[132:133], v10 offset:12288
    ds_read_b64_tr_b16 v[134:135], v10 offset:12800
    s_waitcnt lgkmcnt(8)
    v_mfma_f32_16x16x32_bf16 v[60:63], v[108:111], v[104:107], v[60:63]
    ds_read_b128 v[140:143], v9 offset:0
    s_waitcnt lgkmcnt(6)
    v_mfma_f32_16x16x32_bf16 v[92:95], v[96:99], v[108:111], v[92:95]
    ds_read_b64_tr_b16 v[136:137], v10 offset:20480
    ds_read_b64_tr_b16 v[138:139], v10 offset:20992
    v_mfma_f32_16x16x32_bf16 v[44:47], v[100:103], v[112:115], v[44:47]
    ds_read_b128 v[144:147], v9 offset:2048
    v_mfma_f32_16x16x32_bf16 v[64:67], v[112:115], v[104:107], v[64:67]
    ds_read_b64_tr_b16 v[128:129], v10 offset:4096
    ds_read_b64_tr_b16 v[130:131], v10 offset:4608
    v_mfma_f32_16x16x32_bf16 v[24:27], v[96:99], v[112:115], v[24:27]
    ds_read_b128 v[148:151], v9 offset:4096
    s_waitcnt lgkmcnt(11)
    v_mfma_f32_16x16x32_bf16 v[48:51], v[100:103], v[116:119], v[48:51]
    ds_read_b128 v[152:155], v9 offset:6144
    ds_read_b128 v[156:159], v9 offset:8192
    v_mfma_f32_16x16x32_bf16 v[68:71], v[116:119], v[104:107], v[68:71]
    v_mfma_f32_16x16x32_bf16 v[28:31], v[96:99], v[116:119], v[28:31]
    s_waitcnt lgkmcnt(12)
    v_mfma_f32_16x16x32_bf16 v[52:55], v[100:103], v[120:123], v[52:55]
    v_mfma_f32_16x16x32_bf16 v[72:75], v[120:123], v[104:107], v[72:75]
    v_mfma_f32_16x16x32_bf16 v[32:35], v[96:99], v[120:123], v[32:35]
    s_waitcnt lgkmcnt(11)
    v_mfma_f32_16x16x32_bf16 v[56:59], v[100:103], v[124:127], v[56:59]
    v_mfma_f32_16x16x32_bf16 v[76:79], v[124:127], v[104:107], v[76:79]
    v_mfma_f32_16x16x32_bf16 v[36:39], v[96:99], v[124:127], v[36:39]
    v_mfma_f32_16x16x32_bf16 v[80:83], v[20:23], v[124:127], v[80:83]
    v_mfma_f32_16x16x32_bf16 v[84:87], v[124:127], v[124:127], v[84:87]
    s_waitcnt lgkmcnt(8)
    v_mfma_f32_16x16x32_bf16 v[40:43], v[132:135], v[140:143], v[40:43]
    s_waitcnt lgkmcnt(6)
    v_mfma_f32_16x16x32_bf16 v[60:63], v[140:143], v[136:139], v[60:63]
    s_waitcnt lgkmcnt(3)
    v_mfma_f32_16x16x32_bf16 v[92:95], v[128:131], v[140:143], v[92:95]
    v_mfma_f32_16x16x32_bf16 v[44:47], v[132:135], v[144:147], v[44:47]
    v_mfma_f32_16x16x32_bf16 v[64:67], v[144:147], v[136:139], v[64:67]
    v_mfma_f32_16x16x32_bf16 v[24:27], v[128:131], v[144:147], v[24:27]
    s_waitcnt lgkmcnt(2)
    v_mfma_f32_16x16x32_bf16 v[48:51], v[132:135], v[148:151], v[48:51]
    v_mfma_f32_16x16x32_bf16 v[68:71], v[148:151], v[136:139], v[68:71]
    v_mfma_f32_16x16x32_bf16 v[28:31], v[128:131], v[148:151], v[28:31]
    s_waitcnt lgkmcnt(1)
    v_mfma_f32_16x16x32_bf16 v[52:55], v[132:135], v[152:155], v[52:55]
    v_mfma_f32_16x16x32_bf16 v[72:75], v[152:155], v[136:139], v[72:75]
    v_mfma_f32_16x16x32_bf16 v[32:35], v[128:131], v[152:155], v[32:35]
    s_waitcnt lgkmcnt(0)
    v_mfma_f32_16x16x32_bf16 v[56:59], v[132:135], v[156:159], v[56:59]
    v_mfma_f32_16x16x32_bf16 v[76:79], v[156:159], v[136:139], v[76:79]
    v_mfma_f32_16x16x32_bf16 v[36:39], v[128:131], v[156:159], v[36:39]
    v_mfma_f32_16x16x32_bf16 v[80:83], v[20:23], v[156:159], v[80:83]
    v_mfma_f32_16x16x32_bf16 v[84:87], v[156:159], v[156:159], v[84:87]
    s_nop 7
    v_cndmask_b32 v12, v84, v85, s[48:49]
    v_cndmask_b32 v13, v86, v87, s[48:49]
    v_mul_f32 v14, s62, v80
    v_cndmask_b32 v12, v12, v13, s[50:51]
    v_cndmask_b32 v12, 0, v12, s[52:53]
    v_mov_b32 v13, v12
    s_nop 1
    v_permlane16_swap_b32 v12, v13
    v_add_f32 v12, v12, v13
    v_mov_b32 v13, v12
    s_nop 1
    v_permlane32_swap_b32 v12, v13
    v_add_f32 v12, v12, v13
    v_fma_f32 v12, v12, s63, v173
    v_fma_f32 v12, -v14, v14, v12
    v_max_f32 v12, v173, v12
    v_rsq_f32 v12, v12
    s_mov_b64 exec, 0xffff
    ds_write_b32 v164, v14 offset:512
    ds_write_b32 v164, v12 offset:576
    s_mov_b64 exec, -1
    s_waitcnt lgkmcnt(0)
    s_barrier
    s_branch A1L0_EP
A1L0_EP:
    s_mov_b64 exec, s[54:55]
    ds_write_b128 v168, v[92:95]
    ds_write_b128 v168, v[40:43] offset:64
    s_mov_b64 exec, 0xffff
    ds_write_b32 v169, v60
    s_mov_b64 exec, -1
    ds_read_b32 v96, v164 offset:0
    ds_read_b32 v97, v164 offset:64
    ds_read_b32 v106, v164 offset:128
    ds_read_b32 v107, v164 offset:192
    ds_read_b32 v116, v164 offset:256
    ds_read_b32 v117, v164 offset:320
    ds_read_b32 v126, v164 offset:384
    ds_read_b32 v127, v164 offset:448
    ds_read_b32 v136, v164 offset:512
    ds_read_b32 v137, v164 offset:576
    ds_read_b128 v[98:101], v166 offset:0
    ds_read_b128 v[102:105], v166 offset:64
    ds_read_b128 v[108:111], v166 offset:128
    ds_read_b128 v[112:115], v166 offset:192
    ds_read_b128 v[118:121], v166 offset:256
    ds_read_b128 v[122:125], v166 offset:320
    ds_read_b128 v[128:131], v166 offset:384
    ds_read_b128 v[132:135], v166 offset:448
    ds_read_b128 v[138:141], v166 offset:512
    ds_read_b128 v[142:145], v166 offset:576
    ds_read_b128 v[176:179], v168
    ds_read_b128 v[180:183], v168 offset:64
    ds_read_b32 v184, v169
    s_waitcnt lgkmcnt(14)
    v_mul_f32 v96, s62, v96
    v_fma_f32 v97, v97, s63, v173
    v_fma_f32 v97, -v96, v96, v97
    v_max_f32 v97, v173, v97
    v_rsq_f32 v97, v97
    s_waitcnt lgkmcnt(1)
    v_pk_fma_f32 v[40:41], v[96:97], v[180:181], v[40:41] op_sel:[0,0,0] op_sel_hi:[0,1,1]
    v_pk_fma_f32 v[44:45], v[106:107], v[180:181], v[44:45] op_sel:[0,0,0] op_sel_hi:[0,1,1]
    v_pk_fma_f32 v[48:49], v[116:117], v[180:181], v[48:49] op_sel:[0,0,0] op_sel_hi:[0,1,1]
    v_pk_fma_f32 v[52:53], v[126:127], v[180:181], v[52:53] op_sel:[0,0,0] op_sel_hi:[0,1,1]
    v_pk_fma_f32 v[56:57], v[136:137], v[180:181], v[56:57] op_sel:[0,0,0] op_sel_hi:[0,1,1]
    v_pk_fma_f32 v[24:25], v[106:107], v[176:177], v[24:25] op_sel:[0,0,0] op_sel_hi:[0,1,1]
    v_pk_fma_f32 v[28:29], v[116:117], v[176:177], v[28:29] op_sel:[0,0,0] op_sel_hi:[0,1,1]
    v_pk_fma_f32 v[32:33], v[126:127], v[176:177], v[32:33] op_sel:[0,0,0] op_sel_hi:[0,1,1]
    v_pk_fma_f32 v[36:37], v[136:137], v[176:177], v[36:37] op_sel:[0,0,0] op_sel_hi:[0,1,1]
    v_pk_fma_f32 v[42:43], v[96:97], v[182:183], v[42:43] op_sel:[0,0,0] op_sel_hi:[0,1,1]
    v_pk_fma_f32 v[46:47], v[106:107], v[182:183], v[46:47] op_sel:[0,0,0] op_sel_hi:[0,1,1]
    v_pk_fma_f32 v[50:51], v[116:117], v[182:183], v[50:51] op_sel:[0,0,0] op_sel_hi:[0,1,1]
    v_pk_fma_f32 v[54:55], v[126:127], v[182:183], v[54:55] op_sel:[0,0,0] op_sel_hi:[0,1,1]
    v_pk_fma_f32 v[58:59], v[136:137], v[182:183], v[58:59] op_sel:[0,0,0] op_sel_hi:[0,1,1]
    v_pk_fma_f32 v[26:27], v[106:107], v[178:179], v[26:27] op_sel:[0,0,0] op_sel_hi:[0,1,1]
    v_pk_fma_f32 v[30:31], v[116:117], v[178:179], v[30:31] op_sel:[0,0,0] op_sel_hi:[0,1,1]
    v_pk_fma_f32 v[34:35], v[126:127], v[178:179], v[34:35] op_sel:[0,0,0] op_sel_hi:[0,1,1]
    v_pk_fma_f32 v[38:39], v[136:137], v[178:179], v[38:39] op_sel:[0,0,0] op_sel_hi:[0,1,1]
    v_pk_mul_f32 v[40:41], v[96:97], v[40:41] op_sel:[1,0] op_sel_hi:[1,1]
    v_pk_mul_f32 v[44:45], v[106:107], v[44:45] op_sel:[1,0] op_sel_hi:[1,1]
    v_pk_mul_f32 v[48:49], v[116:117], v[48:49] op_sel:[1,0] op_sel_hi:[1,1]
    v_pk_mul_f32 v[52:53], v[126:127], v[52:53] op_sel:[1,0] op_sel_hi:[1,1]
    v_pk_mul_f32 v[56:57], v[136:137], v[56:57] op_sel:[1,0] op_sel_hi:[1,1]
    v_cvt_pk_bf16_f32 v192, v24, v25
    v_cvt_pk_bf16_f32 v194, v28, v29
    v_cvt_pk_bf16_f32 v196, v32, v33
    v_cvt_pk_bf16_f32 v198, v36, v37
    v_pk_mul_f32 v[42:43], v[96:97], v[42:43] op_sel:[1,0] op_sel_hi:[1,1]
    v_pk_mul_f32 v[46:47], v[106:107], v[46:47] op_sel:[1,0] op_sel_hi:[1,1]
    v_pk_mul_f32 v[50:51], v[116:117], v[50:51] op_sel:[1,0] op_sel_hi:[1,1]
    v_pk_mul_f32 v[54:55], v[126:127], v[54:55] op_sel:[1,0] op_sel_hi:[1,1]
    v_pk_mul_f32 v[58:59], v[136:137], v[58:59] op_sel:[1,0] op_sel_hi:[1,1]
    v_cvt_pk_bf16_f32 v193, v26, v27
    v_cvt_pk_bf16_f32 v195, v30, v31
    v_cvt_pk_bf16_f32 v197, v34, v35
    v_cvt_pk_bf16_f32 v199, v38, v39
    v_cvt_pk_bf16_f32 v200, v40, v41
    v_cvt_pk_bf16_f32 v202, v44, v45
    v_cvt_pk_bf16_f32 v204, v48, v49
    v_cvt_pk_bf16_f32 v206, v52, v53
    v_cvt_pk_bf16_f32 v208, v56, v57
    v_cvt_pk_bf16_f32 v201, v42, v43
    v_cvt_pk_bf16_f32 v203, v46, v47
    v_cvt_pk_bf16_f32 v205, v50, v51
    v_cvt_pk_bf16_f32 v207, v54, v55
    v_cvt_pk_bf16_f32 v209, v58, v59
    v_mul_f32 v245, s61, v107
    v_mul_f32 v246, s61, v117
    v_mul_f32 v247, s61, v127
    v_mul_f32 v248, s61, v137
    v_mfma_f32_16x16x16_bf16 v[24:27], v[202:203], v[192:193], 0
    v_mfma_f32_16x16x16_bf16 v[44:47], v[200:201], v[192:193], 0
    v_mfma_f32_16x16x16_bf16 v[28:31], v[204:205], v[194:195], 0
    v_mfma_f32_16x16x16_bf16 v[48:51], v[202:203], v[194:195], 0
    v_mfma_f32_16x16x16_bf16 v[32:35], v[206:207], v[196:197], 0
    v_mfma_f32_16x16x16_bf16 v[52:55], v[204:205], v[196:197], 0
    v_mfma_f32_16x16x16_bf16 v[36:39], v[208:209], v[198:199], 0
    v_mfma_f32_16x16x16_bf16 v[56:59], v[206:207], v[198:199], 0
    v_pk_mul_f32 v[98:99], v[98:99], v[174:175] op_sel:[0,0] op_sel_hi:[1,0]
    v_pk_mul_f32 v[100:101], v[100:101], v[174:175] op_sel:[0,0] op_sel_hi:[1,0]
    v_pk_fma_f32 v[102:103], v[102:103], v[174:175], v[172:173] op_sel:[0,1,1] op_sel_hi:[1,1,1]
    v_pk_fma_f32 v[104:105], v[104:105], v[174:175], v[172:173] op_sel:[0,1,1] op_sel_hi:[1,1,1]
    v_pk_fma_f32 v[102:103], v[98:99], v[98:99], v[102:103] neg_lo:[1,0,0] neg_hi:[1,0,0]
    v_pk_fma_f32 v[104:105], v[100:101], v[100:101], v[104:105] neg_lo:[1,0,0] neg_hi:[1,0,0]
    v_max_f32 v102, v173, v102
    v_max_f32 v103, v173, v103
    v_max_f32 v104, v173, v104
    v_max_f32 v105, v173, v105
    v_rsq_f32 v102, v102
    v_rsq_f32 v103, v103
    v_rsq_f32 v104, v104
    v_rsq_f32 v105, v105
    s_waitcnt lgkmcnt(0)
    v_pk_fma_f32 v[60:61], v[98:99], v[184:185], v[60:61] op_sel:[0,0,0] op_sel_hi:[1,0,1]
    v_pk_fma_f32 v[64:65], v[108:109], v[184:185], v[64:65] op_sel:[0,0,0] op_sel_hi:[1,0,1]
    v_pk_fma_f32 v[68:69], v[118:119], v[184:185], v[68:69] op_sel:[0,0,0] op_sel_hi:[1,0,1]
    v_pk_fma_f32 v[72:73], v[128:129], v[184:185], v[72:73] op_sel:[0,0,0] op_sel_hi:[1,0,1]
    v_pk_fma_f32 v[76:77], v[138:139], v[184:185], v[76:77] op_sel:[0,0,0] op_sel_hi:[1,0,1]
    v_pk_fma_f32 v[62:63], v[100:101], v[184:185], v[62:63] op_sel:[0,0,0] op_sel_hi:[1,0,1]
    v_pk_fma_f32 v[66:67], v[110:111], v[184:185], v[66:67] op_sel:[0,0,0] op_sel_hi:[1,0,1]
    v_pk_fma_f32 v[70:71], v[120:121], v[184:185], v[70:71] op_sel:[0,0,0] op_sel_hi:[1,0,1]
    v_pk_fma_f32 v[74:75], v[130:131], v[184:185], v[74:75] op_sel:[0,0,0] op_sel_hi:[1,0,1]
    v_pk_fma_f32 v[78:79], v[140:141], v[184:185], v[78:79] op_sel:[0,0,0] op_sel_hi:[1,0,1]
    v_pk_mul_f32 v[60:61], v[102:103], v[60:61]
    v_pk_mul_f32 v[64:65], v[112:113], v[64:65]
    v_pk_mul_f32 v[68:69], v[122:123], v[68:69]
    v_pk_mul_f32 v[72:73], v[132:133], v[72:73]
    v_pk_mul_f32 v[76:77], v[142:143], v[76:77]
    v_pk_mul_f32 v[62:63], v[104:105], v[62:63]
    v_pk_mul_f32 v[66:67], v[114:115], v[66:67]
    v_pk_mul_f32 v[70:71], v[124:125], v[70:71]
    v_pk_mul_f32 v[74:75], v[134:135], v[74:75]
    v_pk_mul_f32 v[78:79], v[144:145], v[78:79]
    v_cvt_pk_bf16_f32 v210, v60, v61
    v_cvt_pk_bf16_f32 v212, v64, v65
    v_cvt_pk_bf16_f32 v214, v68, v69
    v_cvt_pk_bf16_f32 v216, v72, v73
    v_cvt_pk_bf16_f32 v218, v76, v77
    v_cvt_pk_bf16_f32 v211, v62, v63
    v_cvt_pk_bf16_f32 v213, v66, v67
    v_cvt_pk_bf16_f32 v215, v70, v71
    v_cvt_pk_bf16_f32 v217, v74, v75
    v_cvt_pk_bf16_f32 v219, v78, v79
    s_cmp_lg_u32 s31, 0
    s_cbranch_scc1 A1L0_NOTFIRST
    v_mov_b32 v44, 0xf149f2ca
    v_mov_b32 v45, 0xf149f2ca
    v_mov_b32 v46, 0xf149f2ca
    v_mov_b32 v47, 0xf149f2ca
A1L0_NOTFIRST:
    v_cndmask_b32 v97, v24, v25, s[48:49]
    v_cndmask_b32 v109, v28, v29, s[48:49]
    v_cndmask_b32 v121, v32, v33, s[48:49]
    v_cndmask_b32 v133, v36, v37, s[48:49]
    v_cndmask_b32 v98, v44, v45, s[48:49]
    v_cndmask_b32 v110, v48, v49, s[48:49]
    v_cndmask_b32 v122, v52, v53, s[48:49]
    v_cndmask_b32 v134, v56, v57, s[48:49]
    v_cndmask_b32 v99, v26, v27, s[48:49]
    v_cndmask_b32 v111, v30, v31, s[48:49]
    v_cndmask_b32 v123, v34, v35, s[48:49]
    v_cndmask_b32 v135, v38, v39, s[48:49]
    v_cndmask_b32 v100, v46, v47, s[48:49]
    v_cndmask_b32 v112, v50, v51, s[48:49]
    v_cndmask_b32 v124, v54, v55, s[48:49]
    v_cndmask_b32 v136, v58, v59, s[48:49]
    v_cndmask_b32 v97, v98, v97, s[56:57]
    v_cndmask_b32 v109, v110, v109, s[56:57]
    v_cndmask_b32 v121, v122, v121, s[56:57]
    v_cndmask_b32 v133, v134, v133, s[56:57]
    v_cndmask_b32 v98, v100, v99, s[58:59]
    v_cndmask_b32 v110, v112, v111, s[58:59]
    v_cndmask_b32 v122, v124, v123, s[58:59]
    v_cndmask_b32 v134, v136, v135, s[58:59]
    v_mul_f32 v97, v97, v245
    v_mul_f32 v109, v109, v246
    v_mul_f32 v121, v121, v247
    v_mul_f32 v133, v133, v248
    v_mul_f32 v98, v98, v245
    v_mul_f32 v110, v110, v246
    v_mul_f32 v122, v122, v247
    v_mul_f32 v134, v134, v248
    v_max_f32 v99, v97, v98
    v_max_f32 v111, v109, v110
    v_max_f32 v123, v121, v122
    v_max_f32 v135, v133, v134
    v_mov_b32 v100, v99
    v_mov_b32 v112, v111
    v_mov_b32 v124, v123
    v_mov_b32 v136, v135
    v_permlane16_swap_b32 v99, v100
    v_permlane16_swap_b32 v111, v112
    v_permlane16_swap_b32 v123, v124
    v_permlane16_swap_b32 v135, v136
    v_max_f32 v99, v99, v100
    v_max_f32 v111, v111, v112
    v_max_f32 v123, v123, v124
    v_max_f32 v135, v135, v136
    v_mov_b32 v100, v99
    v_mov_b32 v112, v111
    v_mov_b32 v124, v123
    v_mov_b32 v136, v135
    v_permlane32_swap_b32 v99, v100
    v_permlane32_swap_b32 v111, v112
    v_permlane32_swap_b32 v123, v124
    v_permlane32_swap_b32 v135, v136
    v_max_f32 v99, v99, v100
    v_max_f32 v111, v111, v112
    v_max_f32 v123, v123, v124
    v_max_f32 v135, v135, v136
    v_sub_f32 v97, v97, v99
    v_sub_f32 v109, v109, v111
    v_sub_f32 v121, v121, v123
    v_sub_f32 v133, v133, v135
    v_sub_f32 v98, v98, v99
    v_sub_f32 v110, v110, v111
    v_sub_f32 v122, v122, v123
    v_sub_f32 v134, v134, v135
    v_exp_f32 v97, v97
    v_exp_f32 v109, v109
    v_exp_f32 v121, v121
    v_exp_f32 v133, v133
    v_exp_f32 v98, v98
    v_exp_f32 v110, v110
    v_exp_f32 v122, v122
    v_exp_f32 v134, v134
    v_cvt_pk_bf16_f32 v97, v97, v97
    v_cvt_pk_bf16_f32 v109, v109, v109
    v_cvt_pk_bf16_f32 v121, v121, v121
    v_cvt_pk_bf16_f32 v133, v133, v133
    v_cvt_pk_bf16_f32 v98, v98, v98
    v_cvt_pk_bf16_f32 v110, v110, v110
    v_cvt_pk_bf16_f32 v122, v122, v122
    v_cvt_pk_bf16_f32 v134, v134, v134
    v_and_b32 v102, v97, v160
    v_and_b32 v114, v109, v160
    v_and_b32 v126, v121, v160
    v_and_b32 v138, v133, v160
    v_and_b32 v103, v98, v162
    v_and_b32 v115, v110, v162
    v_and_b32 v127, v122, v162
    v_and_b32 v139, v134, v162
    v_and_b32 v104, v97, v161
    v_and_b32 v116, v109, v161
    v_and_b32 v128, v121, v161
    v_and_b32 v140, v133, v161
    v_and_b32 v105, v98, v163
    v_and_b32 v117, v110, v163
    v_and_b32 v129, v122, v163
    v_and_b32 v141, v134, v163
    v_mfma_f32_16x16x16_bf16 v[64:67], v[212:213], v[102:103], 0
    v_mfma_f32_16x16x16_bf16 v[68:71], v[214:215], v[114:115], 0
    v_mfma_f32_16x16x16_bf16 v[72:75], v[216:217], v[126:127], 0
    v_mfma_f32_16x16x16_bf16 v[76:79], v[218:219], v[138:139], 0
    v_mfma_f32_16x16x16_bf16 v[144:147], v[20:21], v[102:103], 0
    v_mfma_f32_16x16x16_bf16 v[148:151], v[20:21], v[114:115], 0
    v_mfma_f32_16x16x16_bf16 v[152:155], v[20:21], v[126:127], 0
    v_mfma_f32_16x16x16_bf16 v[156:159], v[20:21], v[138:139], 0
    v_mfma_f32_16x16x16_bf16 v[64:67], v[210:211], v[104:105], v[64:67]
    v_mfma_f32_16x16x16_bf16 v[68:71], v[212:213], v[116:117], v[68:71]
    v_mfma_f32_16x16x16_bf16 v[72:75], v[214:215], v[128:129], v[72:75]
    v_mfma_f32_16x16x16_bf16 v[76:79], v[216:217], v[140:141], v[76:79]
    v_mfma_f32_16x16x16_bf16 v[144:147], v[20:21], v[104:105], v[144:147]
    v_mfma_f32_16x16x16_bf16 v[148:151], v[20:21], v[116:117], v[148:151]
    v_mfma_f32_16x16x16_bf16 v[152:155], v[20:21], v[128:129], v[152:155]
    v_mfma_f32_16x16x16_bf16 v[156:159], v[20:21], v[140:141], v[156:159]
    s_nop 4
    v_rcp_f32 v226, v144
    v_rcp_f32 v228, v148
    v_rcp_f32 v230, v152
    v_rcp_f32 v232, v156
    v_pk_mul_f32 v[64:65], v[226:227], v[64:65] op_sel:[0,0] op_sel_hi:[0,1]
    v_pk_mul_f32 v[68:69], v[228:229], v[68:69] op_sel:[0,0] op_sel_hi:[0,1]
    v_pk_mul_f32 v[72:73], v[230:231], v[72:73] op_sel:[0,0] op_sel_hi:[0,1]
    v_pk_mul_f32 v[76:77], v[232:233], v[76:77] op_sel:[0,0] op_sel_hi:[0,1]
    v_pk_mul_f32 v[66:67], v[226:227], v[66:67] op_sel:[0,0] op_sel_hi:[0,1]
    v_pk_mul_f32 v[70:71], v[228:229], v[70:71] op_sel:[0,0] op_sel_hi:[0,1]
    v_pk_mul_f32 v[74:75], v[230:231], v[74:75] op_sel:[0,0] op_sel_hi:[0,1]
    v_pk_mul_f32 v[78:79], v[232:233], v[78:79] op_sel:[0,0] op_sel_hi:[0,1]
    v_cvt_pk_bf16_f32 v236, v64, v65
    v_cvt_pk_bf16_f32 v238, v68, v69
    v_cvt_pk_bf16_f32 v240, v72, v73
    v_cvt_pk_bf16_f32 v242, v76, v77
    v_cvt_pk_bf16_f32 v237, v66, v67
    v_cvt_pk_bf16_f32 v239, v70, v71
    v_cvt_pk_bf16_f32 v241, v74, v75
    v_cvt_pk_bf16_f32 v243, v78, v79
    ds_write_b64 v167, v[236:237] offset:0
    ds_write_b64 v167, v[238:239] offset:2304
    ds_write_b64 v167, v[240:241] offset:4608
    ds_write_b64 v167, v[242:243] offset:6912
    s_waitcnt vmcnt(0) lgkmcnt(0)
    s_barrier
A1L0_ST:
    ds_read_b128 v[64:67], v170
    s_waitcnt lgkmcnt(0)
    buffer_store_dwordx4 v[64:67], v171, s[20:23], s36 offen sc1
    s_waitcnt lgkmcnt(0)
    s_add_u32 s34, s34, 1
    s_lshl_b32 s82, s31, 3
    s_add_u32 s82, s82, s32
    s_lshl_b32 s82, s82, 7
    s_add_u32 s82, s82, 0
    s_waitcnt vmcnt(0)
    s_barrier
    s_cmp_lg_u32 s28, 0
    s_cbranch_scc1 H1S0
    v_mov_b32 v250, s34
    v_mov_b32 v251, s82
    s_mov_b64 exec, 1
    buffer_store_dword v250, v251, s[72:75], 0 offen sc1
    s_mov_b64 exec, -1
H1S0:
    s_lshl_b32 s81, s31, 6
    v_mov_b32 v4, 0
    v_mov_b32 v5, 0
    v_mov_b32 v6, 0
    v_mov_b32 v7, 0
    v_mov_b32 v22, 0
    v_mov_b32 v23, 0
    s_cmp_lt_u32 s28, 4
    s_cbranch_scc1 A2L0_SC
    v_and_b32 v9, 255, v0
    v_lshrrev_b32 v8, 8, v0
    v_lshlrev_b32 v10, 4, v9
    v_sub_u32 v11, 4094, v10
    v_subrev_u32 v226, 0, v11
    v_subrev_u32 v227, 2, v11
    v_subrev_u32 v228, 4, v11
    v_subrev_u32 v229, 6, v11
    v_subrev_u32 v230, 8, v11
    v_subrev_u32 v231, 10, v11
    v_subrev_u32 v232, 12, v11
    v_subrev_u32 v233, 14, v11
    v_subrev_u32 v234, 16, v11
    v_cvt_f32_i32 v226, v226
    v_cvt_f32_i32 v227, v227
    v_cvt_f32_i32 v228, v228
    v_cvt_f32_i32 v229, v229
    v_cvt_f32_i32 v230, v230
    v_cvt_f32_i32 v231, v231
    v_cvt_f32_i32 v232, v232
    v_cvt_f32_i32 v233, v233
    v_cvt_f32_i32 v234, v234
    v_cvt_pk_bf16_f32 v30, v226, v227
    v_cvt_pk_bf16_f32 v31, v228, v229
    v_cvt_pk_bf16_f32 v32, v230, v231
    v_cvt_pk_bf16_f32 v33, v232, v233
    v_cvt_pk_bf16_f32 v34, v234, v234
    v_lshlrev_b32 v226, 16, v30
    v_and_b32 v227, 0xffff0000, v30
    v_lshlrev_b32 v228, 16, v31
    v_and_b32 v229, 0xffff0000, v31
    v_lshlrev_b32 v230, 16, v32
    v_and_b32 v231, 0xffff0000, v32
    v_lshlrev_b32 v232, 16, v33
    v_and_b32 v233, 0xffff0000, v33
    v_lshlrev_b32 v234, 16, v34
    v_cvt_u32_f32 v226, v226
    v_cvt_u32_f32 v227, v227
    v_cvt_u32_f32 v228, v228
    v_cvt_u32_f32 v229, v229
    v_cvt_u32_f32 v230, v230
    v_cvt_u32_f32 v231, v231
    v_cvt_u32_f32 v232, v232
    v_cvt_u32_f32 v233, v233
    v_cvt_u32_f32 v234, v234
    v_mov_b32 v12, 4100
    v_cmp_eq_u32 vcc, 255, v9
    s_nop 1
    v_cndmask_b32 v234, v234, v12, vcc
    v_mul_u32_u24 v12, 4112, v8
    v_add_u32 v12, 147712, v12
    v_add_u32 v226, v226, v12
    v_add_u32 v227, v227, v12
    v_add_u32 v228, v228, v12
    v_add_u32 v229, v229, v12
    v_add_u32 v230, v230, v12
    v_add_u32 v231, v231, v12
    v_add_u32 v232, v232, v12
    v_add_u32 v233, v233, v12
    v_add_u32 v234, v234, v12
    v_mul_u32_u24 v13, 8320, v8
    v_add_u32 v236, v13, v10
    v_add_u32 v235, 131072, v236
    s_cmp_gt_u32 s28, 2
    s_cselect_b32 s36, 1, 0
    s_mul_i32 s35, s36, 3
    s_sub_u32 s37, s28, s35
    v_mul_u32_u24 v9, 544, v2
    v_lshlrev_b32 v31, 4, v3
    v_add_u32 v9, v9, v31
    s_mov_b32 s38, 122880
    s_cmp_eq_u32 s36, 0
    s_cmov_b32 s38, 17408
    v_add_u32 v239, s38, v9
    s_mov_b32 s38, 0
    s_cmp_eq_u32 s28, 0
    s_cmov_b32 s38, 0
    s_cmp_eq_u32 s28, 1
    s_cmov_b32 s38, 8704
    s_cmp_eq_u32 s28, 2
    s_cmov_b32 s38, 43520
    s_cmp_eq_u32 s28, 3
    s_cmov_b32 s38, 26112
    s_cmp_eq_u32 s28, 4
    s_cmov_b32 s38, 34816
    s_cmp_eq_u32 s28, 5
    s_cmov_b32 s38, 131584
    v_add_u32 v238, s38, v9
    s_mul_i32 s38, s36, 4112
    s_add_u32 s38, s38, 147712
    v_lshlrev_b32 v52, 4, v2
    v_add_u32 v52, s38, v52
    v_lshrrev_b32 v50, 1, v3
    v_lshlrev_b32 v50, 8, v50
    v_and_b32 v51, 1, v3
    v_lshlrev_b32 v51, 3, v51
    v_add_u32 v50, v50, v51
    v_lshlrev_b32 v53, 8, v3
    v_add_u32 v53, 512, v53
    v_lshlrev_b32 v54, 9, v3
    v_lshlrev_b32 v55, 10, v3
    v_add_u32 v55, 2048, v55
    v_cmp_gt_u32 vcc, 32, v1
    s_cmp_eq_u32 s37, 0
    s_cselect_b64 s[40:41], -1, 0
    s_cmp_eq_u32 s37, 1
    s_cselect_b64 s[42:43], -1, 0
    v_add_u32 v56, 0, v53
    v_add_u32 v57, 0, v54
    v_cndmask_b32 v56, v57, v56, vcc
    v_add_u32 v57, 0, v55
    v_cndmask_b32 v56, v57, v56, s[42:43]
    v_add_u32 v57, 0, v50
    v_cndmask_b32 v56, v56, v57, s[40:41]
    v_add_u32 v240, v56, v52
    v_add_u32 v56, 4, v53
    v_add_u32 v57, 8, v54
    v_cndmask_b32 v56, v57, v56, vcc
    v_add_u32 v57, 256, v55
    v_cndmask_b32 v56, v57, v56, s[42:43]
    v_add_u32 v57, 2, v50
    v_cndmask_b32 v56, v56, v57, s[40:41]
    v_add_u32 v241, v56, v52
    v_add_u32 v56, 8, v53
    v_add_u32 v57, 256, v54
    v_cndmask_b32 v56, v57, v56, vcc
    v_add_u32 v57, 512, v55
    v_cndmask_b32 v56, v57, v56, s[42:43]
    v_add_u32 v57, 4, v50
    v_cndmask_b32 v56, v56, v57, s[40:41]
    v_add_u32 v242, v56, v52
    v_add_u32 v56, 12, v53
    v_add_u32 v57, 264, v54
    v_cndmask_b32 v56, v57, v56, vcc
    v_add_u32 v57, 768, v55
    v_cndmask_b32 v56, v57, v56, s[42:43]
    v_add_u32 v57, 6, v50
    v_cndmask_b32 v56, v56, v57, s[40:41]
    v_add_u32 v243, v56, v52
    s_sub_u32 s79, s28, 4
    s_lshl_b32 s35, s79, 4
    v_add_u32 v11, s35, v3
    v_add_u32 v13, s81, v11
    v_lshlrev_b32 v13, 10, v13
    v_xor_b32 v12, v3, v2
    v_lshlrev_b32 v12, 4, v12
    v_add_u32 v4, v13, v12
    v_add_u32 v13, 4096, v13
    v_xor_b32 v12, v3, v2
    v_xor_b32 v12, 4, v12
    v_lshlrev_b32 v12, 4, v12
    v_add_u32 v5, v13, v12
    v_add_u32 v13, 4096, v13
    v_xor_b32 v12, v3, v2
    v_xor_b32 v12, 8, v12
    v_lshlrev_b32 v12, 4, v12
    v_add_u32 v6, v13, v12
    v_add_u32 v13, 4096, v13
    v_xor_b32 v12, v3, v2
    v_xor_b32 v12, 12, v12
    v_lshlrev_b32 v12, 4, v12
    v_add_u32 v7, v13, v12
    s_lshl_b32 s40, s79, 12
    s_add_u32 s12, s8, 4718592
    s_addc_u32 s13, s9, 0
    s_mov_b32 s14, 2097152
    s_mov_b32 s15, 0x20000
    s_branch A2L0_SD
A2L0_SC:
    v_and_b32 v9, 255, v0
    v_lshrrev_b32 v8, 8, v0
    v_lshlrev_b32 v10, 4, v9
    v_sub_u32 v11, 4094, v10
    v_subrev_u32 v226, 0, v11
    v_subrev_u32 v227, 2, v11
    v_subrev_u32 v228, 4, v11
    v_subrev_u32 v229, 6, v11
    v_subrev_u32 v230, 8, v11
    v_subrev_u32 v231, 10, v11
    v_subrev_u32 v232, 12, v11
    v_subrev_u32 v233, 14, v11
    v_subrev_u32 v234, 16, v11
    v_cvt_f32_i32 v226, v226
    v_cvt_f32_i32 v227, v227
    v_cvt_f32_i32 v228, v228
    v_cvt_f32_i32 v229, v229
    v_cvt_f32_i32 v230, v230
    v_cvt_f32_i32 v231, v231
    v_cvt_f32_i32 v232, v232
    v_cvt_f32_i32 v233, v233
    v_cvt_f32_i32 v234, v234
    v_cvt_pk_bf16_f32 v30, v226, v227
    v_cvt_pk_bf16_f32 v31, v228, v229
    v_cvt_pk_bf16_f32 v32, v230, v231
    v_cvt_pk_bf16_f32 v33, v232, v233
    v_cvt_pk_bf16_f32 v34, v234, v234
    v_lshlrev_b32 v226, 16, v30
    v_and_b32 v227, 0xffff0000, v30
    v_lshlrev_b32 v228, 16, v31
    v_and_b32 v229, 0xffff0000, v31
    v_lshlrev_b32 v230, 16, v32
    v_and_b32 v231, 0xffff0000, v32
    v_lshlrev_b32 v232, 16, v33
    v_and_b32 v233, 0xffff0000, v33
    v_lshlrev_b32 v234, 16, v34
    v_cvt_u32_f32 v226, v226
    v_cvt_u32_f32 v227, v227
    v_cvt_u32_f32 v228, v228
    v_cvt_u32_f32 v229, v229
    v_cvt_u32_f32 v230, v230
    v_cvt_u32_f32 v231, v231
    v_cvt_u32_f32 v232, v232
    v_cvt_u32_f32 v233, v233
    v_cvt_u32_f32 v234, v234
    v_mov_b32 v12, 4100
    v_cmp_eq_u32 vcc, 255, v9
    s_nop 1
    v_cndmask_b32 v234, v234, v12, vcc
    v_mul_u32_u24 v12, 4112, v8
    v_add_u32 v12, 147712, v12
    v_add_u32 v226, v226, v12
    v_add_u32 v227, v227, v12
    v_add_u32 v228, v228, v12
    v_add_u32 v229, v229, v12
    v_add_u32 v230, v230, v12
    v_add_u32 v231, v231, v12
    v_add_u32 v232, v232, v12
    v_add_u32 v233, v233, v12
    v_add_u32 v234, v234, v12
    v_mul_u32_u24 v13, 8320, v8
    v_add_u32 v236, v13, v10
    v_add_u32 v235, 131072, v236
    s_cmp_gt_u32 s28, 2
    s_cselect_b32 s36, 1, 0
    s_mul_i32 s35, s36, 3
    s_sub_u32 s37, s28, s35
    v_mul_u32_u24 v9, 544, v2
    v_lshlrev_b32 v31, 4, v3
    v_add_u32 v9, v9, v31
    s_mov_b32 s38, 122880
    s_cmp_eq_u32 s36, 0
    s_cmov_b32 s38, 17408
    v_add_u32 v239, s38, v9
    s_mov_b32 s38, 0
    s_cmp_eq_u32 s28, 0
    s_cmov_b32 s38, 0
    s_cmp_eq_u32 s28, 1
    s_cmov_b32 s38, 8704
    s_cmp_eq_u32 s28, 2
    s_cmov_b32 s38, 43520
    s_cmp_eq_u32 s28, 3
    s_cmov_b32 s38, 26112
    s_cmp_eq_u32 s28, 4
    s_cmov_b32 s38, 34816
    s_cmp_eq_u32 s28, 5
    s_cmov_b32 s38, 131584
    v_add_u32 v238, s38, v9
    s_mul_i32 s38, s36, 4112
    s_add_u32 s38, s38, 147712
    v_lshlrev_b32 v52, 4, v2
    v_add_u32 v52, s38, v52
    v_lshrrev_b32 v50, 1, v3
    v_lshlrev_b32 v50, 8, v50
    v_and_b32 v51, 1, v3
    v_lshlrev_b32 v51, 3, v51
    v_add_u32 v50, v50, v51
    v_lshlrev_b32 v53, 8, v3
    v_add_u32 v53, 512, v53
    v_lshlrev_b32 v54, 9, v3
    v_lshlrev_b32 v55, 10, v3
    v_add_u32 v55, 2048, v55
    v_cmp_gt_u32 vcc, 32, v1
    s_cmp_eq_u32 s37, 0
    s_cselect_b64 s[40:41], -1, 0
    s_cmp_eq_u32 s37, 1
    s_cselect_b64 s[42:43], -1, 0
    v_add_u32 v56, 0, v53
    v_add_u32 v57, 0, v54
    v_cndmask_b32 v56, v57, v56, vcc
    v_add_u32 v57, 0, v55
    v_cndmask_b32 v56, v57, v56, s[42:43]
    v_add_u32 v57, 0, v50
    v_cndmask_b32 v56, v56, v57, s[40:41]
    v_add_u32 v240, v56, v52
    v_add_u32 v56, 4, v53
    v_add_u32 v57, 8, v54
    v_cndmask_b32 v56, v57, v56, vcc
    v_add_u32 v57, 256, v55
    v_cndmask_b32 v56, v57, v56, s[42:43]
    v_add_u32 v57, 2, v50
    v_cndmask_b32 v56, v56, v57, s[40:41]
    v_add_u32 v241, v56, v52
    v_add_u32 v56, 8, v53
    v_add_u32 v57, 256, v54
    v_cndmask_b32 v56, v57, v56, vcc
    v_add_u32 v57, 512, v55
    v_cndmask_b32 v56, v57, v56, s[42:43]
    v_add_u32 v57, 4, v50
    v_cndmask_b32 v56, v56, v57, s[40:41]
    v_add_u32 v242, v56, v52
    v_add_u32 v56, 12, v53
    v_add_u32 v57, 264, v54
    v_cndmask_b32 v56, v57, v56, vcc
    v_add_u32 v57, 768, v55
    v_cndmask_b32 v56, v57, v56, s[42:43]
    v_add_u32 v57, 6, v50
    v_cndmask_b32 v56, v56, v57, s[40:41]
    v_add_u32 v243, v56, v52
    s_and_b32 s79, s28, 1
    s_lshr_b32 s80, s28, 1
    s_lshl_b32 s35, s79, 5
    s_add_u32 s35, s35, s81
    v_lshlrev_b32 v11, 2, v3
    v_add_u32 v11, s35, v11
    s_lshl_b32 s36, s32, 6
    s_lshl_b32 s37, s80, 5
    s_add_u32 s36, s36, s37
    v_add_u32 v13, s36, v2
    s_mov_b32 s20, s4
    s_mov_b32 s21, s5
    s_mov_b32 s22, 2097152
    s_mov_b32 s23, 0x20000
    v_lshlrev_b32 v12, 10, v11
    v_lshlrev_b32 v14, 1, v13
    v_add_u32 v8, v12, v14
    v_mul_u32_u24 v14, 144, v2
    v_lshlrev_b32 v15, 3, v3
    v_add_u32 v14, v14, v15
    s_mul_i32 s35, s80, 4608
    s_lshl_b32 s36, s79, 6
    s_add_u32 s35, s35, s36
    s_add_u32 s35, s35, 147712
    v_add_u32 v9, s35, v14
    s_lshl_b32 s35, s79, 5
    v_add_u32 v11, s35, v2
    v_lshlrev_b32 v11, 8, v11
    v_xor_b32 v12, v3, v2
    v_lshlrev_b32 v12, 4, v12
    v_add_u32 v16, v11, v12
    v_add_u32 v4, 114688, v16
    v_xor_b32 v12, v3, v2
    v_xor_b32 v12, 4, v12
    v_lshlrev_b32 v12, 4, v12
    v_add_u32 v17, v11, v12
    v_add_u32 v5, 114688, v17
    v_xor_b32 v12, v3, v2
    v_xor_b32 v12, 8, v12
    v_lshlrev_b32 v12, 4, v12
    v_add_u32 v18, v11, v12
    v_add_u32 v6, 114688, v18
    v_xor_b32 v12, v3, v2
    v_xor_b32 v12, 12, v12
    v_lshlrev_b32 v12, 4, v12
    v_add_u32 v19, v11, v12
    v_add_u32 v7, 114688, v19
    v_lshrrev_b32 v11, 2, v2
    v_lshlrev_b32 v12, 3, v3
    v_add_u32 v12, v12, v11
    v_lshlrev_b32 v12, 7, v12
    v_lshrrev_b32 v11, 1, v11
    v_and_b32 v13, 1, v3
    v_lshlrev_b32 v13, 1, v13
    v_or_b32 v11, v11, v13
    s_lshl_b32 s35, s80, 1
    v_xor_b32 v11, s35, v11
    v_lshlrev_b32 v13, 5, v11
    v_and_b32 v14, 3, v1
    v_lshlrev_b32 v14, 3, v14
    v_add_u32 v12, v12, v14
    v_add_u32 v12, 49152, v12
    v_add_u32 v20, v12, v13
    v_xor_b32 v13, 32, v13
    v_add_u32 v21, v12, v13
    v_mov_b32 v24, 0
    v_mov_b32 v25, 0
    v_mov_b32 v26, 0
    v_mov_b32 v27, 0
    v_mov_b32 v28, 0
    v_mov_b32 v29, 0
    v_mov_b32 v30, 0
    v_mov_b32 v31, 0
    v_mov_b32 v32, 0
    v_mov_b32 v33, 0
    v_mov_b32 v34, 0
    v_mov_b32 v35, 0
    v_mov_b32 v36, 0
    v_mov_b32 v37, 0
    v_mov_b32 v38, 0
    v_mov_b32 v39, 0
    v_lshrrev_b32 v14, 3, v1
    s_lshl_b32 s35, s28, 3
    v_add_u32 v14, s35, v14
    v_and_b32 v15, 7, v1
    v_lshlrev_b32 v15, 4, v15
    v_mul_u32_u24 v12, 144, v14
    v_add_u32 v12, v12, v15
    v_add_u32 v22, 147712, v12
    v_lshlrev_b32 v14, 12, v14
    v_add_u32 v23, v14, v15
    s_lshl_b32 s83, s32, 18
    s_lshl_b32 s35, s81, 1
    s_add_u32 s83, s83, s35
A2L0_SD:
    s_cmp_lg_u32 s28, 5
    s_cbranch_scc1 PRM_A0
    s_lshl_b32 s95, s32, 18
PRM_A0:
    s_cmp_lt_u32 s28, 4
    s_cbranch_scc1 H1NW0
    s_waitcnt vmcnt(0) lgkmcnt(0)
H1NW0:
    s_lshl_b32 s82, s31, 10
    s_add_u32 s82, s82, 0
    s_cmp_lg_u32 s28, 0
    s_cbranch_scc1 H1W0_D
    v_lshlrev_b32 v250, 7, v1
    v_add_u32 v250, s82, v250
    s_mov_b64 exec, 0xff
    s_mov_b32 s90, 0
H1W0_P:
    buffer_load_dword v246, v250, s[72:75], 0 offen sc1
    s_waitcnt vmcnt(0)
    v_cmp_eq_u32 vcc, s34, v246
    s_nop 0
    s_cmp_eq_u64 vcc, exec
    s_cbranch_scc1 H1W0_X
    s_sleep 2
    s_add_u32 s90, s90, 1
    s_cmp_lt_u32 s90, 200000
    s_cbranch_scc1 H1W0_P
H1W0_X:
    s_mov_b64 exec, -1
H1W0_D:
    s_barrier
A2L0_BEGIN:
    s_cmp_lt_u32 s28, 4
    s_cbranch_scc1 A2L0_C
    s_add_u32 m0, s40, 0
    s_mov_b32 s44, 0
    buffer_load_dwordx4 v4, s[12:15], s44 offen sc1 lds
    s_add_u32 m0, s40, 1024
    s_mov_b32 s44, 0
    buffer_load_dwordx4 v5, s[12:15], s44 offen sc1 lds
    s_add_u32 m0, s40, 2048
    s_mov_b32 s44, 0
    buffer_load_dwordx4 v6, s[12:15], s44 offen sc1 lds
    s_add_u32 m0, s40, 3072
    s_mov_b32 s44, 0
    buffer_load_dwordx4 v7, s[12:15], s44 offen sc1 lds
    s_add_u32 m0, s40, 16384
    s_mov_b32 s44, 256
    buffer_load_dwordx4 v4, s[12:15], s44 offen sc1 lds
    s_add_u32 m0, s40, 17408
    s_mov_b32 s44, 256
    buffer_load_dwordx4 v5, s[12:15], s44 offen sc1 lds
    s_add_u32 m0, s40, 18432
    s_mov_b32 s44, 256
    buffer_load_dwordx4 v6, s[12:15], s44 offen sc1 lds
    s_add_u32 m0, s40, 19456
    s_mov_b32 s44, 256
    buffer_load_dwordx4 v7, s[12:15], s44 offen sc1 lds
    s_add_u32 m0, s40, 32768
    s_mov_b32 s44, 512
    buffer_load_dwordx4 v4, s[12:15], s44 offen sc1 lds
    s_add_u32 m0, s40, 33792
    s_mov_b32 s44, 512
    buffer_load_dwordx4 v5, s[12:15], s44 offen sc1 lds
    s_add_u32 m0, s40, 34816
    s_mov_b32 s44, 512
    buffer_load_dwordx4 v6, s[12:15], s44 offen sc1 lds
    s_add_u32 m0, s40, 35840
    s_mov_b32 s44, 512
    buffer_load_dwordx4 v7, s[12:15], s44 offen sc1 lds
    s_add_u32 m0, s40, 114688
    s_mov_b32 s44, 768
    buffer_load_dwordx4 v4, s[12:15], s44 offen sc1 lds
    s_add_u32 m0, s40, 115712
    s_mov_b32 s44, 768
    buffer_load_dwordx4 v5, s[12:15], s44 offen sc1 lds
    s_add_u32 m0, s40, 116736
    s_mov_b32 s44, 768
    buffer_load_dwordx4 v6, s[12:15], s44 offen sc1 lds
    s_add_u32 m0, s40, 117760
    s_mov_b32 s44, 768
    buffer_load_dwordx4 v7, s[12:15], s44 offen sc1 lds
    s_mov_b32 s36, 0x3fb8aa3b
    s_mov_b32 s37, 0x3e22f983
    v_mul_f32 v14, s36, v190
    v_mul_f32 v10, s36, v186
    v_exp_f32 v14, v14
    v_exp_f32 v10, v10
    s_nop 0
    v_cvt_pk_bf16_f32 v15, v14, v10
    v_lshlrev_b32 v14, 16, v15
    v_and_b32 v10, 0xffff0000, v15
    v_mul_f32 v10, v10, v14
    v_mul_f32 v11, v187, v14
    v_add_f32 v14, v14, v14
    v_mul_f32 v16, v188, v14
    v_mul_f32 v17, v189, v14
    v_mul_f32 v10, s36, v10
    v_mul_f32 v11, s37, v11
    v_mul_f32 v30, 0x3f800000, v10
    v_mul_f32 v32, 0x40000000, v10
    v_mul_f32 v34, 0x41000000, v10
    v_mul_f32 v36, 0x43000000, v10
    v_mul_f32 v38, 0x44800000, v10
    v_mul_f32 v31, 0x3f800000, v11
    v_mul_f32 v33, 0x40000000, v11
    v_mul_f32 v35, 0x41000000, v11
    v_mul_f32 v37, 0x43000000, v11
    v_mul_f32 v39, 0x44800000, v11
    v_exp_f32 v30, -v30
    v_exp_f32 v32, -v32
    s_waitcnt vmcnt(12)
    s_barrier
    v_exp_f32 v34, -v34
    v_exp_f32 v36, -v36
    v_exp_f32 v38, -v38
    v_fract_f32 v31, v31
    v_fract_f32 v33, v33
    v_fract_f32 v35, v35
    v_fract_f32 v37, v37
    v_fract_f32 v39, v39
    v_cos_f32 v20, v31
    v_cos_f32 v22, v33
    v_cos_f32 v24, v35
    v_cos_f32 v26, v37
    v_cos_f32 v28, v39
    v_sin_f32 v21, v31
    v_sin_f32 v23, v33
    v_sin_f32 v25, v35
    v_sin_f32 v27, v37
    v_sin_f32 v29, v39
    v_mul_f32 v20, v20, v30
    v_mul_f32 v22, v22, v32
    v_mul_f32 v24, v24, v34
    v_mul_f32 v26, v26, v36
    v_mul_f32 v28, v28, v38
    v_mul_f32 v21, v21, v30
    v_mul_f32 v23, v23, v32
    v_mul_f32 v25, v25, v34
    v_mul_f32 v27, v27, v36
    v_mul_f32 v29, v29, v38
    v_pk_mul_f32 v[42:43], v[24:25], v[24:25] op_sel:[0,0] op_sel_hi:[0,1]
    v_pk_fma_f32 v[40:41], v[24:25], v[24:25], v[42:43] op_sel:[1,1,0] op_sel_hi:[1,0,1] neg_lo:[1,0,0]
    v_mov_b32 v137, 0x3f80
    v_cvt_pk_bf16_f32 v138, v24, v25
    s_waitcnt vmcnt(8)
    s_barrier
    v_pk_mul_f32 v[60:61], v[16:17], v[28:29] op_sel:[0,0] op_sel_hi:[0,1]
    v_cvt_pk_bf16_f32 v96, v16, -v17
    v_pk_mul_f32 v[88:89], v[20:21], v[22:23] op_sel:[0,0] op_sel_hi:[0,1]
    v_cvt_pk_bf16_f32 v139, v40, v41
    v_pk_mul_f32 v[54:55], v[24:25], v[40:41] op_sel:[0,0] op_sel_hi:[0,1]
    v_pk_fma_f32 v[56:57], v[16:17], v[28:29], v[60:61] op_sel:[1,1,0] op_sel_hi:[1,0,1] neg_lo:[1,0,0]
    v_pk_mul_f32 v[62:63], v[16:17], v[26:27] op_sel:[0,0] op_sel_hi:[0,1]
    v_pk_fma_f32 v[78:79], v[20:21], v[22:23], v[88:89] op_sel:[1,1,0] op_sel_hi:[1,0,1] neg_lo:[1,0,0]
    v_pk_mul_f32 v[48:49], v[40:41], v[40:41] op_sel:[0,0] op_sel_hi:[0,1]
    v_pk_fma_f32 v[50:51], v[24:25], v[40:41], v[54:55] op_sel:[1,1,0] op_sel_hi:[1,0,1] neg_lo:[1,0,0]
    v_cvt_pk_bf16_f32 v128, v56, -v57
    v_pk_fma_f32 v[64:65], v[16:17], v[26:27], v[62:63] op_sel:[1,1,0] op_sel_hi:[1,0,1] neg_lo:[1,0,0]
    v_pk_mul_f32 v[88:89], v[22:23], v[22:23] op_sel:[0,0] op_sel_hi:[0,1]
    v_pk_fma_f32 v[44:45], v[40:41], v[40:41], v[48:49] op_sel:[1,1,0] op_sel_hi:[1,0,1] neg_lo:[1,0,0]
    v_cvt_pk_bf16_f32 v140, v50, v51
    v_pk_mul_f32 v[60:61], v[56:57], v[26:27] op_sel:[0,0] op_sel_hi:[0,1]
    v_cvt_pk_bf16_f32 v104, v64, -v65
    v_pk_fma_f32 v[80:81], v[22:23], v[22:23], v[88:89] op_sel:[1,1,0] op_sel_hi:[1,0,1] neg_lo:[1,0,0]
    v_cvt_pk_bf16_f32 v141, v44, v45
    v_pk_mul_f32 v[54:55], v[50:51], v[40:41] op_sel:[0,0] op_sel_hi:[0,1]
    v_pk_fma_f32 v[58:59], v[56:57], v[26:27], v[60:61] op_sel:[1,1,0] op_sel_hi:[1,0,1] neg_lo:[1,0,0]
    v_pk_mul_f32 v[62:63], v[64:65], v[26:27] op_sel:[0,0] op_sel_hi:[0,1]
    v_pk_mul_f32 v[88:89], v[78:79], v[22:23] op_sel:[0,0] op_sel_hi:[0,1]
    v_pk_mul_f32 v[48:49], v[44:45], v[40:41] op_sel:[0,0] op_sel_hi:[0,1]
    v_pk_fma_f32 v[52:53], v[50:51], v[40:41], v[54:55] op_sel:[1,1,0] op_sel_hi:[1,0,1] neg_lo:[1,0,0]
    v_cvt_pk_bf16_f32 v129, v58, -v59
    v_pk_fma_f32 v[66:67], v[64:65], v[26:27], v[62:63] op_sel:[1,1,0] op_sel_hi:[1,0,1] neg_lo:[1,0,0]
    v_pk_fma_f32 v[82:83], v[78:79], v[22:23], v[88:89] op_sel:[1,1,0] op_sel_hi:[1,0,1] neg_lo:[1,0,0]
    v_pk_fma_f32 v[46:47], v[44:45], v[40:41], v[48:49] op_sel:[1,1,0] op_sel_hi:[1,0,1] neg_lo:[1,0,0]
    v_cvt_pk_bf16_f32 v142, v52, v53
    v_pk_mul_f32 v[60:61], v[58:59], v[26:27] op_sel:[0,0] op_sel_hi:[0,1]
    v_cvt_pk_bf16_f32 v112, v66, -v67
    s_waitcnt vmcnt(4)
    s_barrier
    v_pk_mul_f32 v[88:89], v[80:81], v[22:23] op_sel:[0,0] op_sel_hi:[0,1]
    v_cvt_pk_bf16_f32 v143, v46, v47
    v_pk_mul_f32 v[54:55], v[52:53], v[40:41] op_sel:[0,0] op_sel_hi:[0,1]
    v_pk_fma_f32 v[56:57], v[58:59], v[26:27], v[60:61] op_sel:[1,1,0] op_sel_hi:[1,0,1] neg_lo:[1,0,0]
    v_pk_mul_f32 v[62:63], v[66:67], v[26:27] op_sel:[0,0] op_sel_hi:[0,1]
    v_pk_fma_f32 v[84:85], v[80:81], v[22:23], v[88:89] op_sel:[1,1,0] op_sel_hi:[1,0,1] neg_lo:[1,0,0]
    v_pk_mul_f32 v[48:49], v[46:47], v[40:41] op_sel:[0,0] op_sel_hi:[0,1]
    v_pk_fma_f32 v[50:51], v[52:53], v[40:41], v[54:55] op_sel:[1,1,0] op_sel_hi:[1,0,1] neg_lo:[1,0,0]
    v_cvt_pk_bf16_f32 v130, v56, -v57
    v_pk_fma_f32 v[68:69], v[66:67], v[26:27], v[62:63] op_sel:[1,1,0] op_sel_hi:[1,0,1] neg_lo:[1,0,0]
    v_pk_mul_f32 v[88:89], v[82:83], v[22:23] op_sel:[0,0] op_sel_hi:[0,1]
    v_pk_fma_f32 v[44:45], v[46:47], v[40:41], v[48:49] op_sel:[1,1,0] op_sel_hi:[1,0,1] neg_lo:[1,0,0]
    v_cvt_pk_bf16_f32 v144, v50, v51
    v_pk_mul_f32 v[60:61], v[56:57], v[26:27] op_sel:[0,0] op_sel_hi:[0,1]
    v_cvt_pk_bf16_f32 v116, v68, -v69
    v_pk_fma_f32 v[86:87], v[82:83], v[22:23], v[88:89] op_sel:[1,1,0] op_sel_hi:[1,0,1] neg_lo:[1,0,0]
    v_cvt_pk_bf16_f32 v145, v44, v45
    v_pk_mul_f32 v[54:55], v[50:51], v[40:41] op_sel:[0,0] op_sel_hi:[0,1]
    v_pk_fma_f32 v[58:59], v[56:57], v[26:27], v[60:61] op_sel:[1,1,0] op_sel_hi:[1,0,1] neg_lo:[1,0,0]
    v_pk_mul_f32 v[62:63], v[68:69], v[26:27] op_sel:[0,0] op_sel_hi:[0,1]
    v_pk_mul_f32 v[48:49], v[44:45], v[40:41] op_sel:[0,0] op_sel_hi:[0,1]
    v_pk_fma_f32 v[52:53], v[50:51], v[40:41], v[54:55] op_sel:[1,1,0] op_sel_hi:[1,0,1] neg_lo:[1,0,0]
    v_cvt_pk_bf16_f32 v131, v58, -v59
    v_pk_fma_f32 v[70:71], v[68:69], v[26:27], v[62:63] op_sel:[1,1,0] op_sel_hi:[1,0,1] neg_lo:[1,0,0]
    v_pk_fma_f32 v[46:47], v[44:45], v[40:41], v[48:49] op_sel:[1,1,0] op_sel_hi:[1,0,1] neg_lo:[1,0,0]
    v_cvt_pk_bf16_f32 v146, v52, v53
    v_pk_mul_f32 v[60:61], v[58:59], v[26:27] op_sel:[0,0] op_sel_hi:[0,1]
    v_cvt_pk_bf16_f32 v120, v70, -v71
    v_cvt_pk_bf16_f32 v147, v46, v47
    v_pk_mul_f32 v[54:55], v[52:53], v[40:41] op_sel:[0,0] op_sel_hi:[0,1]
    v_pk_fma_f32 v[56:57], v[58:59], v[26:27], v[60:61] op_sel:[1,1,0] op_sel_hi:[1,0,1] neg_lo:[1,0,0]
    v_pk_mul_f32 v[62:63], v[70:71], v[26:27] op_sel:[0,0] op_sel_hi:[0,1]
    s_waitcnt vmcnt(0)
    s_barrier
    v_pk_mul_f32 v[48:49], v[46:47], v[40:41] op_sel:[0,0] op_sel_hi:[0,1]
    v_pk_fma_f32 v[50:51], v[52:53], v[40:41], v[54:55] op_sel:[1,1,0] op_sel_hi:[1,0,1] neg_lo:[1,0,0]
    v_cvt_pk_bf16_f32 v132, v56, -v57
    v_pk_fma_f32 v[72:73], v[70:71], v[26:27], v[62:63] op_sel:[1,1,0] op_sel_hi:[1,0,1] neg_lo:[1,0,0]
    v_pk_fma_f32 v[44:45], v[46:47], v[40:41], v[48:49] op_sel:[1,1,0] op_sel_hi:[1,0,1] neg_lo:[1,0,0]
    v_cvt_pk_bf16_f32 v148, v50, v51
    v_pk_mul_f32 v[60:61], v[56:57], v[26:27] op_sel:[0,0] op_sel_hi:[0,1]
    v_cvt_pk_bf16_f32 v122, v72, -v73
    v_cvt_pk_bf16_f32 v149, v44, v45
    v_pk_mul_f32 v[54:55], v[50:51], v[40:41] op_sel:[0,0] op_sel_hi:[0,1]
    v_pk_fma_f32 v[58:59], v[56:57], v[26:27], v[60:61] op_sel:[1,1,0] op_sel_hi:[1,0,1] neg_lo:[1,0,0]
    v_pk_mul_f32 v[62:63], v[72:73], v[26:27] op_sel:[0,0] op_sel_hi:[0,1]
    v_pk_mul_f32 v[48:49], v[44:45], v[40:41] op_sel:[0,0] op_sel_hi:[0,1]
    v_pk_fma_f32 v[52:53], v[50:51], v[40:41], v[54:55] op_sel:[1,1,0] op_sel_hi:[1,0,1] neg_lo:[1,0,0]
    v_cvt_pk_bf16_f32 v133, v58, -v59
    v_pk_fma_f32 v[74:75], v[72:73], v[26:27], v[62:63] op_sel:[1,1,0] op_sel_hi:[1,0,1] neg_lo:[1,0,0]
    v_pk_fma_f32 v[46:47], v[44:45], v[40:41], v[48:49] op_sel:[1,1,0] op_sel_hi:[1,0,1] neg_lo:[1,0,0]
    v_cvt_pk_bf16_f32 v150, v52, v53
    v_pk_mul_f32 v[60:61], v[58:59], v[26:27] op_sel:[0,0] op_sel_hi:[0,1]
    v_cvt_pk_bf16_f32 v124, v74, -v75
    v_cvt_pk_bf16_f32 v151, v46, v47
    v_pk_mul_f32 v[54:55], v[52:53], v[40:41] op_sel:[0,0] op_sel_hi:[0,1]
    v_pk_fma_f32 v[56:57], v[58:59], v[26:27], v[60:61] op_sel:[1,1,0] op_sel_hi:[1,0,1] neg_lo:[1,0,0]
    v_pk_mul_f32 v[62:63], v[74:75], v[26:27] op_sel:[0,0] op_sel_hi:[0,1]
    v_pk_fma_f32 v[50:51], v[52:53], v[40:41], v[54:55] op_sel:[1,1,0] op_sel_hi:[1,0,1] neg_lo:[1,0,0]
    v_cvt_pk_bf16_f32 v134, v56, -v57
    v_pk_fma_f32 v[76:77], v[74:75], v[26:27], v[62:63] op_sel:[1,1,0] op_sel_hi:[1,0,1] neg_lo:[1,0,0]
    v_cvt_pk_bf16_f32 v152, v50, v51
    v_pk_mul_f32 v[60:61], v[56:57], v[26:27] op_sel:[0,0] op_sel_hi:[0,1]
    v_cvt_pk_bf16_f32 v126, v76, -v77
    v_pk_fma_f32 v[58:59], v[56:57], v[26:27], v[60:61] op_sel:[1,1,0] op_sel_hi:[1,0,1] neg_lo:[1,0,0]
    v_cvt_pk_bf16_f32 v135, v58, -v59
    v_pk_mul_f32 v[60:61], v[58:59], v[26:27] op_sel:[0,0] op_sel_hi:[0,1]
    v_pk_fma_f32 v[56:57], v[58:59], v[26:27], v[60:61] op_sel:[1,1,0] op_sel_hi:[1,0,1] neg_lo:[1,0,0]
    v_cvt_pk_bf16_f32 v136, v56, -v57
    v_pk_mul_f32 v[42:43], v[16:17], v[20:21] op_sel:[0,0] op_sel_hi:[0,1]
    v_pk_mul_f32 v[46:47], v[16:17], v[22:23] op_sel:[0,0] op_sel_hi:[0,1]
    v_pk_mul_f32 v[50:51], v[16:17], v[78:79] op_sel:[0,0] op_sel_hi:[0,1]
    v_pk_mul_f32 v[54:55], v[16:17], v[80:81] op_sel:[0,0] op_sel_hi:[0,1]
    v_pk_mul_f32 v[58:59], v[16:17], v[82:83] op_sel:[0,0] op_sel_hi:[0,1]
    v_pk_fma_f32 v[40:41], v[16:17], v[20:21], v[42:43] op_sel:[1,1,0] op_sel_hi:[1,0,1] neg_lo:[1,0,0]
    v_pk_fma_f32 v[44:45], v[16:17], v[22:23], v[46:47] op_sel:[1,1,0] op_sel_hi:[1,0,1] neg_lo:[1,0,0]
    v_pk_fma_f32 v[48:49], v[16:17], v[78:79], v[50:51] op_sel:[1,1,0] op_sel_hi:[1,0,1] neg_lo:[1,0,0]
    v_pk_fma_f32 v[52:53], v[16:17], v[80:81], v[54:55] op_sel:[1,1,0] op_sel_hi:[1,0,1] neg_lo:[1,0,0]
    v_pk_fma_f32 v[56:57], v[16:17], v[82:83], v[58:59] op_sel:[1,1,0] op_sel_hi:[1,0,1] neg_lo:[1,0,0]
    v_cvt_pk_bf16_f32 v97, v40, -v41
    v_cvt_pk_bf16_f32 v98, v44, -v45
    v_cvt_pk_bf16_f32 v99, v48, -v49
    v_cvt_pk_bf16_f32 v100, v52, -v53
    v_cvt_pk_bf16_f32 v101, v56, -v57
    v_pk_mul_f32 v[42:43], v[16:17], v[84:85] op_sel:[0,0] op_sel_hi:[0,1]
    v_pk_mul_f32 v[46:47], v[16:17], v[86:87] op_sel:[0,0] op_sel_hi:[0,1]
    v_pk_mul_f32 v[50:51], v[64:65], v[20:21] op_sel:[0,0] op_sel_hi:[0,1]
    v_pk_mul_f32 v[54:55], v[64:65], v[22:23] op_sel:[0,0] op_sel_hi:[0,1]
    v_pk_mul_f32 v[58:59], v[64:65], v[78:79] op_sel:[0,0] op_sel_hi:[0,1]
    v_pk_fma_f32 v[40:41], v[16:17], v[84:85], v[42:43] op_sel:[1,1,0] op_sel_hi:[1,0,1] neg_lo:[1,0,0]
    v_pk_fma_f32 v[44:45], v[16:17], v[86:87], v[46:47] op_sel:[1,1,0] op_sel_hi:[1,0,1] neg_lo:[1,0,0]
    v_pk_fma_f32 v[48:49], v[64:65], v[20:21], v[50:51] op_sel:[1,1,0] op_sel_hi:[1,0,1] neg_lo:[1,0,0]
    v_pk_fma_f32 v[52:53], v[64:65], v[22:23], v[54:55] op_sel:[1,1,0] op_sel_hi:[1,0,1] neg_lo:[1,0,0]
    v_pk_fma_f32 v[56:57], v[64:65], v[78:79], v[58:59] op_sel:[1,1,0] op_sel_hi:[1,0,1] neg_lo:[1,0,0]
    v_cvt_pk_bf16_f32 v102, v40, -v41
    v_cvt_pk_bf16_f32 v103, v44, -v45
    v_cvt_pk_bf16_f32 v105, v48, -v49
    v_cvt_pk_bf16_f32 v106, v52, -v53
    v_cvt_pk_bf16_f32 v107, v56, -v57
    v_pk_mul_f32 v[42:43], v[64:65], v[80:81] op_sel:[0,0] op_sel_hi:[0,1]
    v_pk_mul_f32 v[46:47], v[64:65], v[82:83] op_sel:[0,0] op_sel_hi:[0,1]
    v_pk_mul_f32 v[50:51], v[64:65], v[84:85] op_sel:[0,0] op_sel_hi:[0,1]
    v_pk_mul_f32 v[54:55], v[64:65], v[86:87] op_sel:[0,0] op_sel_hi:[0,1]
    v_pk_mul_f32 v[58:59], v[66:67], v[22:23] op_sel:[0,0] op_sel_hi:[0,1]
    v_pk_fma_f32 v[40:41], v[64:65], v[80:81], v[42:43] op_sel:[1,1,0] op_sel_hi:[1,0,1] neg_lo:[1,0,0]
    v_pk_fma_f32 v[44:45], v[64:65], v[82:83], v[46:47] op_sel:[1,1,0] op_sel_hi:[1,0,1] neg_lo:[1,0,0]
    v_pk_fma_f32 v[48:49], v[64:65], v[84:85], v[50:51] op_sel:[1,1,0] op_sel_hi:[1,0,1] neg_lo:[1,0,0]
    v_pk_fma_f32 v[52:53], v[64:65], v[86:87], v[54:55] op_sel:[1,1,0] op_sel_hi:[1,0,1] neg_lo:[1,0,0]
    v_pk_fma_f32 v[56:57], v[66:67], v[22:23], v[58:59] op_sel:[1,1,0] op_sel_hi:[1,0,1] neg_lo:[1,0,0]
    v_cvt_pk_bf16_f32 v108, v40, -v41
    v_cvt_pk_bf16_f32 v109, v44, -v45
    v_cvt_pk_bf16_f32 v110, v48, -v49
    v_cvt_pk_bf16_f32 v111, v52, -v53
    v_cvt_pk_bf16_f32 v113, v56, -v57
    v_pk_mul_f32 v[42:43], v[66:67], v[80:81] op_sel:[0,0] op_sel_hi:[0,1]
    v_pk_mul_f32 v[46:47], v[66:67], v[84:85] op_sel:[0,0] op_sel_hi:[0,1]
    v_pk_mul_f32 v[50:51], v[68:69], v[22:23] op_sel:[0,0] op_sel_hi:[0,1]
    v_pk_mul_f32 v[54:55], v[68:69], v[80:81] op_sel:[0,0] op_sel_hi:[0,1]
    v_pk_mul_f32 v[58:59], v[68:69], v[84:85] op_sel:[0,0] op_sel_hi:[0,1]
    v_pk_fma_f32 v[40:41], v[66:67], v[80:81], v[42:43] op_sel:[1,1,0] op_sel_hi:[1,0,1] neg_lo:[1,0,0]
    v_pk_fma_f32 v[44:45], v[66:67], v[84:85], v[46:47] op_sel:[1,1,0] op_sel_hi:[1,0,1] neg_lo:[1,0,0]
    v_pk_fma_f32 v[48:49], v[68:69], v[22:23], v[50:51] op_sel:[1,1,0] op_sel_hi:[1,0,1] neg_lo:[1,0,0]
    v_pk_fma_f32 v[52:53], v[68:69], v[80:81], v[54:55] op_sel:[1,1,0] op_sel_hi:[1,0,1] neg_lo:[1,0,0]
    v_pk_fma_f32 v[56:57], v[68:69], v[84:85], v[58:59] op_sel:[1,1,0] op_sel_hi:[1,0,1] neg_lo:[1,0,0]
    v_cvt_pk_bf16_f32 v114, v40, -v41
    v_cvt_pk_bf16_f32 v115, v44, -v45
    v_cvt_pk_bf16_f32 v117, v48, -v49
    v_cvt_pk_bf16_f32 v118, v52, -v53
    v_cvt_pk_bf16_f32 v119, v56, -v57
    v_pk_mul_f32 v[42:43], v[70:71], v[80:81] op_sel:[0,0] op_sel_hi:[0,1]
    v_pk_mul_f32 v[46:47], v[72:73], v[80:81] op_sel:[0,0] op_sel_hi:[0,1]
    v_pk_mul_f32 v[50:51], v[74:75], v[80:81] op_sel:[0,0] op_sel_hi:[0,1]
    v_pk_mul_f32 v[54:55], v[76:77], v[80:81] op_sel:[0,0] op_sel_hi:[0,1]
    v_pk_fma_f32 v[40:41], v[70:71], v[80:81], v[42:43] op_sel:[1,1,0] op_sel_hi:[1,0,1] neg_lo:[1,0,0]
    v_pk_fma_f32 v[44:45], v[72:73], v[80:81], v[46:47] op_sel:[1,1,0] op_sel_hi:[1,0,1] neg_lo:[1,0,0]
    v_pk_fma_f32 v[48:49], v[74:75], v[80:81], v[50:51] op_sel:[1,1,0] op_sel_hi:[1,0,1] neg_lo:[1,0,0]
    v_pk_fma_f32 v[52:53], v[76:77], v[80:81], v[54:55] op_sel:[1,1,0] op_sel_hi:[1,0,1] neg_lo:[1,0,0]
    v_cvt_pk_bf16_f32 v121, v40, -v41
    v_cvt_pk_bf16_f32 v123, v44, -v45
    v_cvt_pk_bf16_f32 v125, v48, -v49
    v_cvt_pk_bf16_f32 v127, v52, -v53
    v_lshrrev_b32 v14, 3, v1
    s_lshl_b32 s35, s28, 3
    v_add_u32 v14, s35, v14
    v_and_b32 v15, 7, v1
    v_lshlrev_b32 v15, 4, v15
    v_mul_u32_u24 v12, 144, v14
    v_add_u32 v12, v12, v15
    v_add_u32 v22, 147712, v12
    v_lshlrev_b32 v14, 12, v14
    v_add_u32 v23, v14, v15
    s_lshl_b32 s83, s32, 18
    s_lshl_b32 s35, s81, 1
    s_add_u32 s83, s83, s35
    s_barrier
    s_branch A2L0_ST
A2L0_C:
    s_mov_b32 s44, 16384
    buffer_load_short_d16_hi v64, v8, s[20:23], 0 offen offset:0
    buffer_load_short_d16_hi v65, v8, s[20:23], 0 offen offset:1024
    buffer_load_short_d16_hi v66, v8, s[20:23], 0 offen offset:2048
    buffer_load_short_d16_hi v67, v8, s[20:23], 0 offen offset:3072
    buffer_load_short_d16_hi v68, v8, s[20:23], 0 offen offset:32
    buffer_load_short_d16_hi v69, v8, s[20:23], 0 offen offset:1056
    buffer_load_short_d16_hi v70, v8, s[20:23], 0 offen offset:2080
    buffer_load_short_d16_hi v71, v8, s[20:23], 0 offen offset:3104
    buffer_load_short_d16_hi v72, v8, s[20:23], s44 offen offset:0
    buffer_load_short_d16_hi v73, v8, s[20:23], s44 offen offset:1024
    buffer_load_short_d16_hi v74, v8, s[20:23], s44 offen offset:2048
    buffer_load_short_d16_hi v75, v8, s[20:23], s44 offen offset:3072
    buffer_load_short_d16_hi v76, v8, s[20:23], s44 offen offset:32
    buffer_load_short_d16_hi v77, v8, s[20:23], s44 offen offset:1056
    buffer_load_short_d16_hi v78, v8, s[20:23], s44 offen offset:2080
    buffer_load_short_d16_hi v79, v8, s[20:23], s44 offen offset:3104
    ds_read_b64_tr_b16 v[48:49], v20 offset:0
    ds_read_b64_tr_b16 v[50:51], v20 offset:512
    ds_read_b64_tr_b16 v[52:53], v21 offset:0
    ds_read_b64_tr_b16 v[54:55], v21 offset:512
    s_barrier
    ds_read_b128 v[40:43], v16 offset:0
    ds_read_b128 v[44:47], v16 offset:4096
    s_waitcnt lgkmcnt(1)
    v_mfma_f32_16x16x32_bf16 v[24:27], v[40:43], v[48:51], v[24:27]
    ds_read_b128 v[88:91], v17 offset:0
    ds_read_b128 v[92:95], v17 offset:4096
    v_mfma_f32_16x16x32_bf16 v[28:31], v[40:43], v[52:55], v[28:31]
    ds_read_b64_tr_b16 v[96:97], v20 offset:4096
    ds_read_b64_tr_b16 v[98:99], v20 offset:4608
    s_waitcnt lgkmcnt(4)
    v_mfma_f32_16x16x32_bf16 v[32:35], v[44:47], v[48:51], v[32:35]
    ds_read_b64_tr_b16 v[100:101], v21 offset:4096
    ds_read_b64_tr_b16 v[102:103], v21 offset:4608
    v_mfma_f32_16x16x32_bf16 v[36:39], v[44:47], v[52:55], v[36:39]
    s_waitcnt lgkmcnt(2)
    v_mfma_f32_16x16x32_bf16 v[24:27], v[88:91], v[96:99], v[24:27]
    ds_read_b128 v[40:43], v18 offset:0
    ds_read_b128 v[44:47], v18 offset:4096
    s_waitcnt lgkmcnt(2)
    v_mfma_f32_16x16x32_bf16 v[28:31], v[88:91], v[100:103], v[28:31]
    ds_read_b64_tr_b16 v[48:49], v20 offset:8192
    ds_read_b64_tr_b16 v[50:51], v20 offset:8704
    v_mfma_f32_16x16x32_bf16 v[32:35], v[92:95], v[96:99], v[32:35]
    ds_read_b64_tr_b16 v[52:53], v21 offset:8192
    ds_read_b64_tr_b16 v[54:55], v21 offset:8704
    v_mfma_f32_16x16x32_bf16 v[36:39], v[92:95], v[100:103], v[36:39]
    s_waitcnt lgkmcnt(2)
    v_mfma_f32_16x16x32_bf16 v[24:27], v[40:43], v[48:51], v[24:27]
    ds_read_b128 v[88:91], v19 offset:0
    ds_read_b128 v[92:95], v19 offset:4096
    s_waitcnt lgkmcnt(2)
    v_mfma_f32_16x16x32_bf16 v[28:31], v[40:43], v[52:55], v[28:31]
    ds_read_b64_tr_b16 v[96:97], v20 offset:12288
    ds_read_b64_tr_b16 v[98:99], v20 offset:12800
    v_mfma_f32_16x16x32_bf16 v[32:35], v[44:47], v[48:51], v[32:35]
    ds_read_b64_tr_b16 v[100:101], v21 offset:12288
    ds_read_b64_tr_b16 v[102:103], v21 offset:12800
    v_mfma_f32_16x16x32_bf16 v[36:39], v[44:47], v[52:55], v[36:39]
    s_waitcnt lgkmcnt(2)
    v_mfma_f32_16x16x32_bf16 v[24:27], v[88:91], v[96:99], v[24:27]
    ds_read_b64_tr_b16 v[48:49], v20 offset:16384
    ds_read_b64_tr_b16 v[50:51], v20 offset:16896
    s_waitcnt lgkmcnt(2)
    v_mfma_f32_16x16x32_bf16 v[28:31], v[88:91], v[100:103], v[28:31]
    ds_read_b64_tr_b16 v[52:53], v21 offset:16384
    ds_read_b64_tr_b16 v[54:55], v21 offset:16896
    v_mfma_f32_16x16x32_bf16 v[32:35], v[92:95], v[96:99], v[32:35]
    v_mfma_f32_16x16x32_bf16 v[36:39], v[92:95], v[100:103], v[36:39]
    s_barrier
    ds_read_b128 v[40:43], v16 offset:16384
    ds_read_b128 v[44:47], v16 offset:20480
    s_waitcnt lgkmcnt(1)
    v_mfma_f32_16x16x32_bf16 v[24:27], v[40:43], v[48:51], v[24:27]
    ds_read_b128 v[88:91], v17 offset:16384
    ds_read_b128 v[92:95], v17 offset:20480
    v_mfma_f32_16x16x32_bf16 v[28:31], v[40:43], v[52:55], v[28:31]
    ds_read_b64_tr_b16 v[96:97], v20 offset:20480
    ds_read_b64_tr_b16 v[98:99], v20 offset:20992
    s_waitcnt lgkmcnt(4)
    v_mfma_f32_16x16x32_bf16 v[32:35], v[44:47], v[48:51], v[32:35]
    ds_read_b64_tr_b16 v[100:101], v21 offset:20480
    ds_read_b64_tr_b16 v[102:103], v21 offset:20992
    v_mfma_f32_16x16x32_bf16 v[36:39], v[44:47], v[52:55], v[36:39]
    s_waitcnt lgkmcnt(2)
    v_mfma_f32_16x16x32_bf16 v[24:27], v[88:91], v[96:99], v[24:27]
    ds_read_b128 v[40:43], v18 offset:16384
    ds_read_b128 v[44:47], v18 offset:20480
    s_waitcnt lgkmcnt(2)
    v_mfma_f32_16x16x32_bf16 v[28:31], v[88:91], v[100:103], v[28:31]
    ds_read_b64_tr_b16 v[48:49], v20 offset:24576
    ds_read_b64_tr_b16 v[50:51], v20 offset:25088
    v_mfma_f32_16x16x32_bf16 v[32:35], v[92:95], v[96:99], v[32:35]
    ds_read_b64_tr_b16 v[52:53], v21 offset:24576
    ds_read_b64_tr_b16 v[54:55], v21 offset:25088
    v_mfma_f32_16x16x32_bf16 v[36:39], v[92:95], v[100:103], v[36:39]
    s_waitcnt lgkmcnt(2)
    v_mfma_f32_16x16x32_bf16 v[24:27], v[40:43], v[48:51], v[24:27]
    ds_read_b128 v[88:91], v19 offset:16384
    ds_read_b128 v[92:95], v19 offset:20480
    s_waitcnt lgkmcnt(2)
    v_mfma_f32_16x16x32_bf16 v[28:31], v[40:43], v[52:55], v[28:31]
    ds_read_b64_tr_b16 v[96:97], v20 offset:28672
    ds_read_b64_tr_b16 v[98:99], v20 offset:29184
    v_mfma_f32_16x16x32_bf16 v[32:35], v[44:47], v[48:51], v[32:35]
    ds_read_b64_tr_b16 v[100:101], v21 offset:28672
    ds_read_b64_tr_b16 v[102:103], v21 offset:29184
    v_mfma_f32_16x16x32_bf16 v[36:39], v[44:47], v[52:55], v[36:39]
    s_waitcnt lgkmcnt(2)
    v_mfma_f32_16x16x32_bf16 v[24:27], v[88:91], v[96:99], v[24:27]
    ds_read_b64_tr_b16 v[48:49], v20 offset:32768
    ds_read_b64_tr_b16 v[50:51], v20 offset:33280
    s_waitcnt lgkmcnt(2)
    v_mfma_f32_16x16x32_bf16 v[28:31], v[88:91], v[100:103], v[28:31]
    ds_read_b64_tr_b16 v[52:53], v21 offset:32768
    ds_read_b64_tr_b16 v[54:55], v21 offset:33280
    v_mfma_f32_16x16x32_bf16 v[32:35], v[92:95], v[96:99], v[32:35]
    v_mfma_f32_16x16x32_bf16 v[36:39], v[92:95], v[100:103], v[36:39]
    s_barrier
    ds_read_b128 v[40:43], v16 offset:32768
    ds_read_b128 v[44:47], v16 offset:36864
    s_waitcnt lgkmcnt(1)
    v_mfma_f32_16x16x32_bf16 v[24:27], v[40:43], v[48:51], v[24:27]
    ds_read_b128 v[88:91], v17 offset:32768
    ds_read_b128 v[92:95], v17 offset:36864
    v_mfma_f32_16x16x32_bf16 v[28:31], v[40:43], v[52:55], v[28:31]
    ds_read_b64_tr_b16 v[96:97], v20 offset:36864
    ds_read_b64_tr_b16 v[98:99], v20 offset:37376
    s_waitcnt lgkmcnt(4)
    v_mfma_f32_16x16x32_bf16 v[32:35], v[44:47], v[48:51], v[32:35]
    ds_read_b64_tr_b16 v[100:101], v21 offset:36864
    ds_read_b64_tr_b16 v[102:103], v21 offset:37376
    v_mfma_f32_16x16x32_bf16 v[36:39], v[44:47], v[52:55], v[36:39]
    s_waitcnt lgkmcnt(2)
    v_mfma_f32_16x16x32_bf16 v[24:27], v[88:91], v[96:99], v[24:27]
    ds_read_b128 v[40:43], v18 offset:32768
    ds_read_b128 v[44:47], v18 offset:36864
    s_waitcnt lgkmcnt(2)
    v_mfma_f32_16x16x32_bf16 v[28:31], v[88:91], v[100:103], v[28:31]
    ds_read_b64_tr_b16 v[48:49], v20 offset:40960
    ds_read_b64_tr_b16 v[50:51], v20 offset:41472
    v_mfma_f32_16x16x32_bf16 v[32:35], v[92:95], v[96:99], v[32:35]
    ds_read_b64_tr_b16 v[52:53], v21 offset:40960
    ds_read_b64_tr_b16 v[54:55], v21 offset:41472
    v_mfma_f32_16x16x32_bf16 v[36:39], v[92:95], v[100:103], v[36:39]
    s_waitcnt lgkmcnt(2)
    v_mfma_f32_16x16x32_bf16 v[24:27], v[40:43], v[48:51], v[24:27]
    ds_read_b128 v[88:91], v19 offset:32768
    ds_read_b128 v[92:95], v19 offset:36864
    s_waitcnt lgkmcnt(2)
    v_mfma_f32_16x16x32_bf16 v[28:31], v[40:43], v[52:55], v[28:31]
    ds_read_b64_tr_b16 v[96:97], v20 offset:45056
    ds_read_b64_tr_b16 v[98:99], v20 offset:45568
    v_mfma_f32_16x16x32_bf16 v[32:35], v[44:47], v[48:51], v[32:35]
    ds_read_b64_tr_b16 v[100:101], v21 offset:45056
    ds_read_b64_tr_b16 v[102:103], v21 offset:45568
    v_mfma_f32_16x16x32_bf16 v[36:39], v[44:47], v[52:55], v[36:39]
    s_waitcnt lgkmcnt(2)
    v_mfma_f32_16x16x32_bf16 v[24:27], v[88:91], v[96:99], v[24:27]
    ds_read_b64_tr_b16 v[48:49], v20 offset:49152
    ds_read_b64_tr_b16 v[50:51], v20 offset:49664
    s_waitcnt lgkmcnt(2)
    v_mfma_f32_16x16x32_bf16 v[28:31], v[88:91], v[100:103], v[28:31]
    ds_read_b64_tr_b16 v[52:53], v21 offset:49152
    ds_read_b64_tr_b16 v[54:55], v21 offset:49664
    v_mfma_f32_16x16x32_bf16 v[32:35], v[92:95], v[96:99], v[32:35]
    v_mfma_f32_16x16x32_bf16 v[36:39], v[92:95], v[100:103], v[36:39]
    s_barrier
    ds_read_b128 v[40:43], v4 offset:0
    ds_read_b128 v[44:47], v4 offset:4096
    s_waitcnt lgkmcnt(1)
    v_mfma_f32_16x16x32_bf16 v[24:27], v[40:43], v[48:51], v[24:27]
    ds_read_b128 v[88:91], v5 offset:0
    ds_read_b128 v[92:95], v5 offset:4096
    v_mfma_f32_16x16x32_bf16 v[28:31], v[40:43], v[52:55], v[28:31]
    ds_read_b64_tr_b16 v[96:97], v20 offset:53248
    ds_read_b64_tr_b16 v[98:99], v20 offset:53760
    s_waitcnt lgkmcnt(4)
    v_mfma_f32_16x16x32_bf16 v[32:35], v[44:47], v[48:51], v[32:35]
    ds_read_b64_tr_b16 v[100:101], v21 offset:53248
    ds_read_b64_tr_b16 v[102:103], v21 offset:53760
    v_mfma_f32_16x16x32_bf16 v[36:39], v[44:47], v[52:55], v[36:39]
    s_waitcnt lgkmcnt(2)
    v_mfma_f32_16x16x32_bf16 v[24:27], v[88:91], v[96:99], v[24:27]
    ds_read_b128 v[40:43], v6 offset:0
    ds_read_b128 v[44:47], v6 offset:4096
    s_waitcnt lgkmcnt(2)
    v_mfma_f32_16x16x32_bf16 v[28:31], v[88:91], v[100:103], v[28:31]
    ds_read_b64_tr_b16 v[48:49], v20 offset:57344
    ds_read_b64_tr_b16 v[50:51], v20 offset:57856
    v_mfma_f32_16x16x32_bf16 v[32:35], v[92:95], v[96:99], v[32:35]
    ds_read_b64_tr_b16 v[52:53], v21 offset:57344
    ds_read_b64_tr_b16 v[54:55], v21 offset:57856
    v_mfma_f32_16x16x32_bf16 v[36:39], v[92:95], v[100:103], v[36:39]
    s_waitcnt lgkmcnt(2)
    v_mfma_f32_16x16x32_bf16 v[24:27], v[40:43], v[48:51], v[24:27]
    ds_read_b128 v[88:91], v7 offset:0
    ds_read_b128 v[92:95], v7 offset:4096
    s_waitcnt lgkmcnt(2)
    v_mfma_f32_16x16x32_bf16 v[28:31], v[40:43], v[52:55], v[28:31]
    ds_read_b64_tr_b16 v[96:97], v20 offset:61440
    ds_read_b64_tr_b16 v[98:99], v20 offset:61952
    v_mfma_f32_16x16x32_bf16 v[32:35], v[44:47], v[48:51], v[32:35]
    ds_read_b64_tr_b16 v[100:101], v21 offset:61440
    ds_read_b64_tr_b16 v[102:103], v21 offset:61952
    v_mfma_f32_16x16x32_bf16 v[36:39], v[44:47], v[52:55], v[36:39]
    s_waitcnt lgkmcnt(2)
    v_mfma_f32_16x16x32_bf16 v[24:27], v[88:91], v[96:99], v[24:27]
    s_waitcnt lgkmcnt(0)
    v_mfma_f32_16x16x32_bf16 v[28:31], v[88:91], v[100:103], v[28:31]
    v_mfma_f32_16x16x32_bf16 v[32:35], v[92:95], v[96:99], v[32:35]
    v_mfma_f32_16x16x32_bf16 v[36:39], v[92:95], v[100:103], v[36:39]
    s_waitcnt vmcnt(0)
    s_add_u32 s16, s8, 16384
    s_addc_u32 s17, s9, 0
    s_mov_b32 s18, 16384
    s_mov_b32 s19, 0x20000
    s_nop 3
    v_pk_add_f32 v[24:25], v[24:25], v[64:65]
    v_pk_add_f32 v[26:27], v[26:27], v[66:67]
    v_pk_add_f32 v[28:29], v[28:29], v[68:69]
    v_pk_add_f32 v[30:31], v[30:31], v[70:71]
    v_pk_add_f32 v[32:33], v[32:33], v[72:73]
    v_pk_add_f32 v[34:35], v[34:35], v[74:75]
    v_pk_add_f32 v[36:37], v[36:37], v[76:77]
    v_pk_add_f32 v[38:39], v[38:39], v[78:79]
    v_cvt_pk_bf16_f32 v40, v24, v25
    v_cvt_pk_bf16_f32 v41, v26, v27
    ds_write_b64 v9, v[40:41] offset:0
    v_cvt_pk_bf16_f32 v42, v28, v29
    v_cvt_pk_bf16_f32 v43, v30, v31
    ds_write_b64 v9, v[42:43] offset:2304
    v_cvt_pk_bf16_f32 v44, v32, v33
    v_cvt_pk_bf16_f32 v45, v34, v35
    ds_write_b64 v9, v[44:45] offset:32
    v_cvt_pk_bf16_f32 v46, v36, v37
    v_cvt_pk_bf16_f32 v47, v38, v39
    ds_write_b64 v9, v[46:47] offset:2336
    v_pk_add_f32 v[48:49], v[24:25], v[28:29]
    v_pk_mul_f32 v[52:53], v[24:25], v[24:25]
    v_pk_add_f32 v[50:51], v[26:27], v[30:31]
    v_pk_mul_f32 v[54:55], v[26:27], v[26:27]
    v_pk_fma_f32 v[52:53], v[28:29], v[28:29], v[52:53]
    v_pk_fma_f32 v[54:55], v[30:31], v[30:31], v[54:55]
    v_pk_add_f32 v[56:57], v[32:33], v[36:37]
    v_pk_mul_f32 v[60:61], v[32:33], v[32:33]
    v_pk_add_f32 v[58:59], v[34:35], v[38:39]
    v_pk_mul_f32 v[62:63], v[34:35], v[34:35]
    v_pk_fma_f32 v[60:61], v[36:37], v[36:37], v[60:61]
    v_pk_fma_f32 v[62:63], v[38:39], v[38:39], v[62:63]
    v_add_f32_dpp v48, v48, v48 row_ror:8 row_mask:0xf bank_mask:0xf
    v_add_f32_dpp v49, v49, v49 row_ror:8 row_mask:0xf bank_mask:0xf
    v_add_f32_dpp v50, v50, v50 row_ror:8 row_mask:0xf bank_mask:0xf
    v_add_f32_dpp v51, v51, v51 row_ror:8 row_mask:0xf bank_mask:0xf
    v_add_f32_dpp v52, v52, v52 row_ror:8 row_mask:0xf bank_mask:0xf
    v_add_f32_dpp v53, v53, v53 row_ror:8 row_mask:0xf bank_mask:0xf
    v_add_f32_dpp v54, v54, v54 row_ror:8 row_mask:0xf bank_mask:0xf
    v_add_f32_dpp v55, v55, v55 row_ror:8 row_mask:0xf bank_mask:0xf
    v_add_f32_dpp v56, v56, v56 row_ror:8 row_mask:0xf bank_mask:0xf
    v_add_f32_dpp v57, v57, v57 row_ror:8 row_mask:0xf bank_mask:0xf
    v_add_f32_dpp v58, v58, v58 row_ror:8 row_mask:0xf bank_mask:0xf
    v_add_f32_dpp v59, v59, v59 row_ror:8 row_mask:0xf bank_mask:0xf
    v_add_f32_dpp v60, v60, v60 row_ror:8 row_mask:0xf bank_mask:0xf
    v_add_f32_dpp v61, v61, v61 row_ror:8 row_mask:0xf bank_mask:0xf
    v_add_f32_dpp v62, v62, v62 row_ror:8 row_mask:0xf bank_mask:0xf
    v_add_f32_dpp v63, v63, v63 row_ror:8 row_mask:0xf bank_mask:0xf
    v_add_f32_dpp v48, v48, v48 row_ror:4 row_mask:0xf bank_mask:0xf
    v_add_f32_dpp v49, v49, v49 row_ror:4 row_mask:0xf bank_mask:0xf
    v_add_f32_dpp v50, v50, v50 row_ror:4 row_mask:0xf bank_mask:0xf
    v_add_f32_dpp v51, v51, v51 row_ror:4 row_mask:0xf bank_mask:0xf
    v_add_f32_dpp v52, v52, v52 row_ror:4 row_mask:0xf bank_mask:0xf
    v_add_f32_dpp v53, v53, v53 row_ror:4 row_mask:0xf bank_mask:0xf
    v_add_f32_dpp v54, v54, v54 row_ror:4 row_mask:0xf bank_mask:0xf
    v_add_f32_dpp v55, v55, v55 row_ror:4 row_mask:0xf bank_mask:0xf
    v_add_f32_dpp v56, v56, v56 row_ror:4 row_mask:0xf bank_mask:0xf
    v_add_f32_dpp v57, v57, v57 row_ror:4 row_mask:0xf bank_mask:0xf
    v_add_f32_dpp v58, v58, v58 row_ror:4 row_mask:0xf bank_mask:0xf
    v_add_f32_dpp v59, v59, v59 row_ror:4 row_mask:0xf bank_mask:0xf
    v_add_f32_dpp v60, v60, v60 row_ror:4 row_mask:0xf bank_mask:0xf
    v_add_f32_dpp v61, v61, v61 row_ror:4 row_mask:0xf bank_mask:0xf
    v_add_f32_dpp v62, v62, v62 row_ror:4 row_mask:0xf bank_mask:0xf
    v_add_f32_dpp v63, v63, v63 row_ror:4 row_mask:0xf bank_mask:0xf
    v_add_f32_dpp v48, v48, v48 row_ror:2 row_mask:0xf bank_mask:0xf
    v_add_f32_dpp v49, v49, v49 row_ror:2 row_mask:0xf bank_mask:0xf
    v_add_f32_dpp v50, v50, v50 row_ror:2 row_mask:0xf bank_mask:0xf
    v_add_f32_dpp v51, v51, v51 row_ror:2 row_mask:0xf bank_mask:0xf
    v_add_f32_dpp v52, v52, v52 row_ror:2 row_mask:0xf bank_mask:0xf
    v_add_f32_dpp v53, v53, v53 row_ror:2 row_mask:0xf bank_mask:0xf
    v_add_f32_dpp v54, v54, v54 row_ror:2 row_mask:0xf bank_mask:0xf
    v_add_f32_dpp v55, v55, v55 row_ror:2 row_mask:0xf bank_mask:0xf
    v_add_f32_dpp v56, v56, v56 row_ror:2 row_mask:0xf bank_mask:0xf
    v_add_f32_dpp v57, v57, v57 row_ror:2 row_mask:0xf bank_mask:0xf
    v_add_f32_dpp v58, v58, v58 row_ror:2 row_mask:0xf bank_mask:0xf
    v_add_f32_dpp v59, v59, v59 row_ror:2 row_mask:0xf bank_mask:0xf
    v_add_f32_dpp v60, v60, v60 row_ror:2 row_mask:0xf bank_mask:0xf
    v_add_f32_dpp v61, v61, v61 row_ror:2 row_mask:0xf bank_mask:0xf
    v_add_f32_dpp v62, v62, v62 row_ror:2 row_mask:0xf bank_mask:0xf
    v_add_f32_dpp v63, v63, v63 row_ror:2 row_mask:0xf bank_mask:0xf
    v_add_f32_dpp v48, v48, v48 row_ror:1 row_mask:0xf bank_mask:0xf
    v_add_f32_dpp v49, v49, v49 row_ror:1 row_mask:0xf bank_mask:0xf
    v_add_f32_dpp v50, v50, v50 row_ror:1 row_mask:0xf bank_mask:0xf
    v_add_f32_dpp v51, v51, v51 row_ror:1 row_mask:0xf bank_mask:0xf
    v_add_f32_dpp v52, v52, v52 row_ror:1 row_mask:0xf bank_mask:0xf
    v_add_f32_dpp v53, v53, v53 row_ror:1 row_mask:0xf bank_mask:0xf
    v_add_f32_dpp v54, v54, v54 row_ror:1 row_mask:0xf bank_mask:0xf
    v_add_f32_dpp v55, v55, v55 row_ror:1 row_mask:0xf bank_mask:0xf
    v_add_f32_dpp v56, v56, v56 row_ror:1 row_mask:0xf bank_mask:0xf
    v_add_f32_dpp v57, v57, v57 row_ror:1 row_mask:0xf bank_mask:0xf
    v_add_f32_dpp v58, v58, v58 row_ror:1 row_mask:0xf bank_mask:0xf
    v_add_f32_dpp v59, v59, v59 row_ror:1 row_mask:0xf bank_mask:0xf
    v_add_f32_dpp v60, v60, v60 row_ror:1 row_mask:0xf bank_mask:0xf
    v_add_f32_dpp v61, v61, v61 row_ror:1 row_mask:0xf bank_mask:0xf
    v_add_f32_dpp v62, v62, v62 row_ror:1 row_mask:0xf bank_mask:0xf
    v_add_f32_dpp v63, v63, v63 row_ror:1 row_mask:0xf bank_mask:0xf
    s_lshl_b32 s44, s80, 9
    s_lshl_b32 s45, s79, 7
    s_add_u32 s44, s44, s45
    s_add_u32 s44, s44, 156928
    v_lshlrev_b32 v11, 4, v3
    v_add_u32 v11, s44, v11
    v_cmp_eq_u32 vcc, 0, v2
    s_nop 0
    s_and_saveexec_b64 s[46:47], vcc
    ds_write_b128 v11, v[48:51] offset:0
    ds_write_b128 v11, v[52:55] offset:256
    ds_write_b128 v11, v[56:59] offset:64
    ds_write_b128 v11, v[60:63] offset:320
    s_mov_b64 exec, s[46:47]
    s_waitcnt lgkmcnt(0)
    s_barrier
A2L0_ST:
    ds_read_b128 v[84:87], v22
    s_cmp_gt_u32 s28, 1
    s_cbranch_scc1 A2L0_NOAT
    s_lshl_b32 s44, s28, 8
    s_add_u32 s44, s44, 156928
    v_lshlrev_b32 v11, 2, v1
    v_add_u32 v12, s44, v11
    ds_read_b32 v13, v12
    ds_read_b32 v14, v12 offset:512
    s_lshl_b32 s44, s28, 13
    s_lshl_b32 s45, s81, 2
    s_add_u32 s44, s44, s45
    s_waitcnt lgkmcnt(0)
    v_add_f32 v13, v13, v14
    buffer_atomic_add_f32 v13, v11, s[16:19], s44 offen
A2L0_NOAT:
    s_add_u32 s12, s8, 8912896
    s_addc_u32 s13, s9, 0
    s_mov_b32 s14, 2097152
    s_mov_b32 s15, 0x20000
    s_waitcnt lgkmcnt(0)
    buffer_store_dwordx4 v[84:87], v23, s[12:15], s83 offen sc1
    s_lshl_b32 s82, s2, 7
    s_add_u32 s82, s82, 32768
    s_waitcnt vmcnt(0)
    s_barrier
    s_cmp_lg_u32 s28, 0
    s_cbranch_scc1 H2S0
    v_mov_b32 v250, s34
    v_mov_b32 v251, s82
    s_mov_b64 exec, 1
    buffer_store_dword v250, v251, s[72:75], 0 offen sc1
    s_mov_b64 exec, -1
H2S0:
    v_mov_b32 v16, 0
    v_mov_b32 v17, 0
    v_mov_b32 v18, 0
    v_mov_b32 v19, 0
    s_cmp_gt_u32 s28, 3
    s_cbranch_scc1 KG_WR
    s_and_b32 s79, s28, 1
    s_lshr_b32 s80, s28, 1
    s_and_b32 s80, s80, 1
    v_lshlrev_b32 v4, 3, v0
    v_lshlrev_b32 v5, 4, v0
    s_lshl_b32 s35, s33, 13
    s_add_u32 s36, s35, 4096
    s_mov_b32 s37, 8192
    s_add_u32 s12, s8, 8912896
    s_addc_u32 s13, s9, 0
    s_mov_b32 s14, 2097152
    s_mov_b32 s15, 0x20000
    s_add_u32 s16, s8, 16384
    s_addc_u32 s17, s9, 0
    s_mov_b32 s18, 16384
    s_mov_b32 s19, 0x20000
    v_mov_b32 v36, 0x3b000000
    v_mov_b32 v37, 0x3727c5ac
    v_add_u32 v9, 147712, v4
    v_and_b32 v17, 1, v3
    v_lshlrev_b32 v17, 12, v17
    v_lshlrev_b32 v16, 5, v2
    v_add_u32 v17, v17, v16
    v_lshrrev_b32 v16, 1, v3
    v_lshlrev_b32 v16, 4, v16
    v_add_u32 v17, v17, v16
    s_and_b32 s79, s28, 1
    s_lshr_b32 s80, s28, 1
    s_and_b32 s80, s80, 1
    v_and_b32 v11, 1, v2
    s_lshl_b32 s46, s79, 1
    v_add_u32 v11, s46, v11
    v_mul_u32_u24 v11, 4160, v11
    v_lshrrev_b32 v12, 1, v2
    v_lshlrev_b32 v13, 2, v3
    v_sub_u32 v13, v13, v12
    s_lshl_b32 s46, s80, 6
    s_sub_u32 s46, 967, s46
    v_add_u32 v13, s46, v13
    v_lshlrev_b32 v13, 2, v13
    v_add_u32 v11, v11, v13
    v_add_u32 v11, 131072, v11
    v_subrev_u32 v60, 0, v11
    v_subrev_u32 v61, 512, v11
    v_subrev_u32 v62, 1024, v11
    v_subrev_u32 v63, 1536, v11
    v_subrev_u32 v64, 2048, v11
    v_subrev_u32 v65, 2560, v11
    v_subrev_u32 v66, 3072, v11
    v_subrev_u32 v67, 3584, v11
    v_lshlrev_b32 v12, 5, v2
    v_lshlrev_b32 v13, 4, v3
    v_add_u32 v12, v12, v13
    s_mul_i32 s46, s79, 4608
    s_lshl_b32 s47, s80, 8
    s_sub_u32 s46, s46, s47
    s_add_u32 s46, s46, 32768
    v_add_u32 v68, s46, v12
    v_mov_b32 v72, 0
    v_mov_b32 v73, 0
    v_mov_b32 v74, 0
    v_mov_b32 v75, 0
    v_mov_b32 v76, 0
    v_mov_b32 v77, 0
    v_mov_b32 v78, 0
    v_mov_b32 v79, 0
    v_mov_b32 v80, 0
    v_mov_b32 v81, 0
    v_mov_b32 v82, 0
    v_mov_b32 v83, 0
    v_mov_b32 v84, 0
    v_mov_b32 v85, 0
    v_mov_b32 v86, 0
    v_mov_b32 v87, 0
    v_mov_b32 v88, 0
    v_mov_b32 v89, 0
    v_mov_b32 v90, 0
    v_mov_b32 v91, 0
    v_mov_b32 v92, 0
    v_mov_b32 v93, 0
    v_mov_b32 v94, 0
    v_mov_b32 v95, 0
    v_mov_b32 v96, 0
    v_mov_b32 v97, 0
    v_mov_b32 v98, 0
    v_mov_b32 v99, 0
    v_mov_b32 v100, 0
    v_mov_b32 v101, 0
    v_mov_b32 v102, 0
    v_mov_b32 v103, 0
    s_branch KG_P1END
KG_WR:
    s_and_b32 s35, s28, 3
    s_lshr_b32 s79, s35, 1
    s_and_b32 s80, s35, 1
    s_lshl_b32 s35, s80, 6
    v_add_u32 v11, s35, v1
    v_lshlrev_b32 v11, 2, v11
    s_mov_b32 s36, 26112
    s_cmp_eq_u32 s79, 0
    s_cmov_b32 s36, 0
    v_add_u32 v6, s36, v11
    s_mov_b32 s36, 34816
    s_cmp_eq_u32 s79, 0
    s_cmov_b32 s36, 8704
    v_add_u32 v7, s36, v11
    s_mov_b32 s36, 131584
    s_cmp_eq_u32 s79, 0
    s_cmov_b32 s36, 43520
    v_add_u32 v8, s36, v11
    s_mov_b32 s36, 122880
    s_cmp_eq_u32 s79, 0
    s_cmov_b32 s36, 17408
    v_add_u32 v9, s36, v11
    ds_write2_b32 v6, v96, v97 offset0:0 offset1:136
    ds_write_b32 v6, v98 offset:1088
    ds_write_b32 v6, v99 offset:1632
    ds_write_b32 v6, v100 offset:2176
    ds_write_b32 v6, v101 offset:2720
    ds_write_b32 v6, v102 offset:3264
    ds_write_b32 v6, v103 offset:3808
    ds_write_b32 v6, v104 offset:4352
    ds_write_b32 v6, v105 offset:4896
    ds_write_b32 v6, v106 offset:5440
    ds_write_b32 v6, v107 offset:5984
    ds_write_b32 v6, v108 offset:6528
    ds_write_b32 v6, v109 offset:7072
    ds_write_b32 v6, v110 offset:7616
    ds_write_b32 v6, v111 offset:8160
    ds_write2_b32 v7, v112, v113 offset0:0 offset1:136
    ds_write_b32 v7, v114 offset:1088
    ds_write_b32 v7, v115 offset:1632
    ds_write_b32 v7, v116 offset:2176
    ds_write_b32 v7, v117 offset:2720
    ds_write_b32 v7, v118 offset:3264
    ds_write_b32 v7, v119 offset:3808
    ds_write_b32 v7, v120 offset:4352
    ds_write_b32 v7, v121 offset:4896
    ds_write_b32 v7, v122 offset:5440
    ds_write_b32 v7, v123 offset:5984
    ds_write_b32 v7, v124 offset:6528
    ds_write_b32 v7, v125 offset:7072
    ds_write_b32 v7, v126 offset:7616
    ds_write_b32 v7, v127 offset:8160
    ds_write2_b32 v8, v128, v129 offset0:0 offset1:136
    ds_write_b32 v8, v130 offset:1088
    ds_write_b32 v8, v131 offset:1632
    ds_write_b32 v8, v132 offset:2176
    ds_write_b32 v8, v133 offset:2720
    ds_write_b32 v8, v134 offset:3264
    ds_write_b32 v8, v135 offset:3808
    ds_write_b32 v8, v136 offset:4352
    ds_write2_b32 v9, v137, v138 offset0:0 offset1:136
    ds_write_b32 v9, v139 offset:1088
    ds_write_b32 v9, v140 offset:1632
    ds_write_b32 v9, v141 offset:2176
    ds_write_b32 v9, v142 offset:2720
    ds_write_b32 v9, v143 offset:3264
    ds_write_b32 v9, v144 offset:3808
    ds_write_b32 v9, v145 offset:4352
    ds_write_b32 v9, v146 offset:4896
    ds_write_b32 v9, v147 offset:5440
    ds_write_b32 v9, v148 offset:5984
    ds_write_b32 v9, v149 offset:6528
    ds_write_b32 v9, v150 offset:7072
    ds_write_b32 v9, v151 offset:7616
    ds_write_b32 v9, v152 offset:8160
KG_P1END:
    s_waitcnt lgkmcnt(0)
    v_mov_b32 v136, 0
    v_mov_b32 v137, 0
    v_mov_b32 v138, 0
    v_mov_b32 v139, 0
    s_barrier
    s_cmp_gt_u32 s28, 5
    s_cbranch_scc1 KG_JOIN
    ds_read_b128 v[104:107], v238 offset:0
    ds_read_b128 v[192:195], v239 offset:0
    ds_read_b128 v[108:111], v238 offset:64
    ds_read_b128 v[196:199], v239 offset:64
    ds_read_b128 v[112:115], v238 offset:128
    ds_read_b128 v[200:203], v239 offset:128
    ds_read_b128 v[116:119], v238 offset:192
    ds_read_b128 v[204:207], v239 offset:192
    ds_read_b128 v[120:123], v238 offset:256
    ds_read_b128 v[208:211], v239 offset:256
    ds_read_b128 v[124:127], v238 offset:320
    ds_read_b128 v[212:215], v239 offset:320
    ds_read_b128 v[128:131], v238 offset:384
    ds_read_b128 v[216:219], v239 offset:384
    ds_read_b128 v[132:135], v238 offset:448
    ds_read_b128 v[220:223], v239 offset:448
    s_waitcnt lgkmcnt(14)
    v_mfma_f32_16x16x32_bf16 v[136:139], v[104:107], v[192:195], v[136:139]
    s_waitcnt lgkmcnt(12)
    v_mfma_f32_16x16x32_bf16 v[136:139], v[108:111], v[196:199], v[136:139]
    s_waitcnt lgkmcnt(10)
    v_mfma_f32_16x16x32_bf16 v[136:139], v[112:115], v[200:203], v[136:139]
    s_waitcnt lgkmcnt(8)
    v_mfma_f32_16x16x32_bf16 v[136:139], v[116:119], v[204:207], v[136:139]
    s_waitcnt lgkmcnt(6)
    v_mfma_f32_16x16x32_bf16 v[136:139], v[120:123], v[208:211], v[136:139]
    s_waitcnt lgkmcnt(4)
    v_mfma_f32_16x16x32_bf16 v[136:139], v[124:127], v[212:215], v[136:139]
    s_waitcnt lgkmcnt(2)
    v_mfma_f32_16x16x32_bf16 v[136:139], v[128:131], v[216:219], v[136:139]
    s_waitcnt lgkmcnt(0)
    v_mfma_f32_16x16x32_bf16 v[136:139], v[132:135], v[220:223], v[136:139]
    s_nop 7
    v_cvt_pk_bf16_f32 v140, v136, v136
    v_cvt_pk_bf16_f32 v141, v137, v137
    v_cvt_pk_bf16_f32 v142, v138, v138
    v_cvt_pk_bf16_f32 v143, v139, v139
    s_cmp_eq_u32 s28, 2
    s_cbranch_scc1 KG_T2
    s_cmp_eq_u32 s28, 5
    s_cbranch_scc1 KG_T2
    ds_write_b16 v240, v140
    ds_write_b16 v241, v141
    ds_write_b16 v242, v142
    ds_write_b16 v243, v143
    s_branch KG_JOIN
KG_T2:
    v_cmp_gt_u32 vcc, 32, v1
    s_nop 0
    s_and_saveexec_b64 s[42:43], vcc
    ds_write_b16 v240, v140
    ds_write_b16 v241, v141
    ds_write_b16 v242, v142
    ds_write_b16 v243, v143
    s_mov_b64 exec, s[42:43]
    v_cmp_eq_u32 vcc, 32, v1
    s_nop 0
    s_and_saveexec_b64 s[42:43], vcc
    ds_write_b16 v240, v140
    v_mov_b32 v144, 0
    v_subrev_u32 v145, 4096, v240
    ds_write_b32 v145, v144 offset:4100
    s_mov_b64 exec, s[42:43]
KG_JOIN:
    s_waitcnt lgkmcnt(0)
    s_barrier
    ds_read_u16 v144, v226
    ds_read_u16 v145, v227
    ds_read_u16 v146, v228
    ds_read_u16 v147, v229
    ds_read_u16 v148, v230
    ds_read_u16 v149, v231
    ds_read_u16 v150, v232
    ds_read_u16 v151, v233
    ds_read_u16 v152, v234
    s_waitcnt lgkmcnt(0)
    v_lshl_or_b32 v156, v146, 16, v145
    v_lshl_or_b32 v160, v145, 16, v144
    v_lshl_or_b32 v157, v148, 16, v147
    v_lshl_or_b32 v161, v147, 16, v146
    v_lshl_or_b32 v158, v150, 16, v149
    v_lshl_or_b32 v162, v149, 16, v148
    v_lshl_or_b32 v159, v152, 16, v151
    v_lshl_or_b32 v163, v151, 16, v150
    ds_write_b128 v235, v[156:159]
    ds_write_b128 v235, v[160:163] offset:4160
    v_cmp_gt_u32 vcc, 16, v0
    s_nop 0
    s_and_saveexec_b64 s[42:43], vcc
    v_lshrrev_b32 v164, 2, v0
    v_mul_u32_u24 v164, 4160, v164
    v_and_b32 v165, 3, v0
    v_lshlrev_b32 v165, 4, v165
    v_add_u32 v164, v164, v165
    v_add_u32 v164, 4096, v164
    v_mov_b32 v168, 0
    v_mov_b32 v169, 0
    v_mov_b32 v170, 0
    v_mov_b32 v171, 0
    v_add_u32 v164, 131072, v164
    ds_write_b128 v164, v[168:171]
    s_mov_b64 exec, s[42:43]
    s_waitcnt lgkmcnt(0)
    s_cmp_lt_u32 s28, 4
    s_cbranch_scc1 BS0_SKIP
    s_and_b32 s79, s28, 1
    s_lshr_b32 s80, s28, 1
    s_and_b32 s80, s80, 1
    v_lshlrev_b32 v4, 3, v0
    v_lshlrev_b32 v5, 4, v0
    s_lshl_b32 s35, s33, 13
    s_add_u32 s36, s35, 4096
    s_mov_b32 s37, 8192
    s_add_u32 s12, s8, 8912896
    s_addc_u32 s13, s9, 0
    s_mov_b32 s14, 2097152
    s_mov_b32 s15, 0x20000
    s_add_u32 s16, s8, 16384
    s_addc_u32 s17, s9, 0
    s_mov_b32 s18, 16384
    s_mov_b32 s19, 0x20000
    v_mov_b32 v36, 0x3b000000
    v_mov_b32 v37, 0x3727c5ac
    v_add_u32 v9, 147712, v4
    v_and_b32 v17, 1, v3
    v_lshlrev_b32 v17, 12, v17
    v_lshlrev_b32 v16, 5, v2
    v_add_u32 v17, v17, v16
    v_lshrrev_b32 v16, 1, v3
    v_lshlrev_b32 v16, 4, v16
    v_add_u32 v17, v17, v16
BS0_SKIP:
    s_barrier
    v_cmp_gt_u32 vcc, 64, v0
    s_nop 0
    s_and_saveexec_b64 s[42:43], vcc
    v_lshrrev_b32 v7, 5, v0
    v_mul_u32_u24 v7, 4608, v7
    v_and_b32 v8, 31, v0
    v_lshlrev_b32 v8, 4, v8
    v_add_u32 v7, v7, v8
    v_mov_b32 v44, 0
    v_mov_b32 v45, 0
    v_mov_b32 v46, 0
    v_mov_b32 v47, 0
    ds_write_b128 v7, v[44:47] offset:32768
    v_mov_b32 v7, 157952
    ds_write_b32 v7, v44
    s_mov_b64 exec, s[42:43]
    s_waitcnt lgkmcnt(0)
    s_mov_b32 s82, 32768
    s_cmp_lg_u32 s28, 0
    s_cbranch_scc1 H2W0_D
    v_lshlrev_b32 v250, 7, v1
    v_add_u32 v250, s82, v250
    v_add_u32 v251, 8192, v250
    v_add_u32 v252, 16384, v250
    v_add_u32 v253, 24576, v250
    s_mov_b32 s90, 0
H2W0_P:
    buffer_load_dword v246, v250, s[72:75], 0 offen sc1
    buffer_load_dword v247, v251, s[72:75], 0 offen sc1
    buffer_load_dword v248, v252, s[72:75], 0 offen sc1
    buffer_load_dword v249, v253, s[72:75], 0 offen sc1
    s_waitcnt vmcnt(0)
    v_cmp_eq_u32 vcc, s34, v246
    v_cmp_eq_u32 s[84:85], s34, v247
    v_cmp_eq_u32 s[86:87], s34, v248
    v_cmp_eq_u32 s[88:89], s34, v249
    s_and_b64 s[84:85], s[84:85], s[86:87]
    s_and_b64 vcc, vcc, s[88:89]
    s_and_b64 vcc, vcc, s[84:85]
    s_nop 0
    s_cmp_eq_u64 vcc, exec
    s_cbranch_scc1 H2W0_X
    s_sleep 2
    s_add_u32 s90, s90, 1
    s_cmp_lt_u32 s90, 200000
    s_cbranch_scc1 H2W0_P
H2W0_X:
    s_mov_b64 exec, -1
H2W0_D:
    s_barrier
    buffer_load_dwordx4 v[28:31], v5, s[16:19], 0 offen sc1
    buffer_load_dwordx4 v[32:35], v5, s[16:19], s37 offen sc1
    buffer_load_dwordx2 v[20:21], v4, s[12:15], s35 offen sc1
    buffer_load_dwordx2 v[22:23], v4, s[12:15], s36 offen sc1
    s_waitcnt vmcnt(0)
    v_pk_mul_f32 v[28:29], v[28:29], v[36:37] op_sel:[0,0] op_sel_hi:[1,0]
    v_pk_fma_f32 v[32:33], v[32:33], v[36:37], v[36:37] op_sel:[0,0,1] op_sel_hi:[1,0,1]
    v_pk_mul_f32 v[30:31], v[30:31], v[36:37] op_sel:[0,0] op_sel_hi:[1,0]
    v_pk_fma_f32 v[34:35], v[34:35], v[36:37], v[36:37] op_sel:[0,0,1] op_sel_hi:[1,0,1]
    v_pk_fma_f32 v[32:33], v[28:29], v[28:29], v[32:33] neg_lo:[1,0,0] neg_hi:[1,0,0]
    v_pk_fma_f32 v[34:35], v[30:31], v[30:31], v[34:35] neg_lo:[1,0,0] neg_hi:[1,0,0]
    v_max_f32 v32, v37, v32
    v_max_f32 v33, v37, v33
    v_max_f32 v34, v37, v34
    v_max_f32 v35, v37, v35
    v_rsq_f32 v32, v32
    v_rsq_f32 v33, v33
    v_rsq_f32 v34, v34
    v_rsq_f32 v35, v35
    v_pk_mul_f32 v[40:41], v[28:29], v[32:33]
    v_pk_mul_f32 v[42:43], v[30:31], v[34:35]
    v_lshlrev_b32 v48, 16, v20
    v_and_b32 v49, 0xffff0000, v20
    v_lshlrev_b32 v50, 16, v21
    v_and_b32 v51, 0xffff0000, v21
    v_lshlrev_b32 v52, 16, v22
    v_and_b32 v53, 0xffff0000, v22
    v_lshlrev_b32 v54, 16, v23
    v_and_b32 v55, 0xffff0000, v23
    v_pk_fma_f32 v[48:49], v[48:49], v[32:33], v[40:41] neg_lo:[0,0,1] neg_hi:[0,0,1]
    v_pk_fma_f32 v[50:51], v[50:51], v[34:35], v[42:43] neg_lo:[0,0,1] neg_hi:[0,0,1]
    v_pk_fma_f32 v[52:53], v[52:53], v[32:33], v[40:41] neg_lo:[0,0,1] neg_hi:[0,0,1]
    v_pk_fma_f32 v[54:55], v[54:55], v[34:35], v[42:43] neg_lo:[0,0,1] neg_hi:[0,0,1]
    v_cvt_pk_bf16_f32 v56, v48, v49
    v_cvt_pk_bf16_f32 v57, v50, v51
    v_cvt_pk_bf16_f32 v58, v52, v53
    v_cvt_pk_bf16_f32 v59, v54, v55
    ds_write_b64 v4, v[56:57] offset:33280
    ds_write_b64 v9, v[20:21] offset:0
    ds_write_b64 v4, v[58:59] offset:37888
    ds_write_b64 v9, v[22:23] offset:4096
    s_waitcnt lgkmcnt(0)
    s_barrier
    s_cmp_gt_u32 s28, 3
    s_cbranch_scc1 BL0_IDLE
    ds_read2_b32 v[104:105], v60 offset0:48 offset1:49
    ds_read2_b32 v[106:107], v60 offset0:50 offset1:51
    ds_read_b128 v[136:139], v68 offset:480
    ds_read_b128 v[140:143], v68 offset:992
    ds_read_b128 v[144:147], v68 offset:1504
    ds_read_b128 v[148:151], v68 offset:2016
    ds_read_b128 v[152:155], v68 offset:2528
    ds_read_b128 v[156:159], v68 offset:3040
    ds_read_b128 v[160:163], v68 offset:3552
    ds_read_b128 v[164:167], v68 offset:4064
    ds_read2_b32 v[108:109], v61 offset0:48 offset1:49
    ds_read2_b32 v[110:111], v61 offset0:50 offset1:51
    ds_read2_b32 v[112:113], v62 offset0:48 offset1:49
    ds_read2_b32 v[114:115], v62 offset0:50 offset1:51
    ds_read2_b32 v[116:117], v63 offset0:48 offset1:49
    ds_read2_b32 v[118:119], v63 offset0:50 offset1:51
    ds_read2_b32 v[120:121], v64 offset0:48 offset1:49
    ds_read2_b32 v[122:123], v64 offset0:50 offset1:51
    ds_read2_b32 v[124:125], v65 offset0:48 offset1:49
    ds_read2_b32 v[126:127], v65 offset0:50 offset1:51
    ds_read2_b32 v[128:129], v66 offset0:48 offset1:49
    ds_read2_b32 v[130:131], v66 offset0:50 offset1:51
    ds_read2_b32 v[132:133], v67 offset0:48 offset1:49
    ds_read2_b32 v[134:135], v67 offset0:50 offset1:51
    s_waitcnt lgkmcnt(14)
    v_mfma_f32_16x16x32_bf16 v[72:75], v[104:107], v[136:139], v[72:75]
    ds_read2_b32 v[186:187], v60 offset0:32 offset1:33
    v_mfma_f32_16x16x32_bf16 v[76:79], v[104:107], v[140:143], v[76:79]
    ds_read2_b32 v[188:189], v60 offset0:34 offset1:35
    v_mfma_f32_16x16x32_bf16 v[80:83], v[104:107], v[144:147], v[80:83]
    v_mfma_f32_16x16x32_bf16 v[84:87], v[104:107], v[148:151], v[84:87]
    ds_read_b128 v[218:221], v68 offset:416
    v_mfma_f32_16x16x32_bf16 v[88:91], v[104:107], v[152:155], v[88:91]
    ds_read_b128 v[222:225], v68 offset:928
    v_mfma_f32_16x16x32_bf16 v[92:95], v[104:107], v[156:159], v[92:95]
    v_mfma_f32_16x16x32_bf16 v[96:99], v[104:107], v[160:163], v[96:99]
    ds_read_b128 v[226:229], v68 offset:1440
    v_mfma_f32_16x16x32_bf16 v[100:103], v[104:107], v[164:167], v[100:103]
    ds_read_b128 v[230:233], v68 offset:1952
    s_waitcnt lgkmcnt(14)
    v_mfma_f32_16x16x32_bf16 v[76:79], v[108:111], v[136:139], v[76:79]
    v_mfma_f32_16x16x32_bf16 v[80:83], v[108:111], v[140:143], v[80:83]
    ds_read_b128 v[234:237], v68 offset:2464
    v_mfma_f32_16x16x32_bf16 v[84:87], v[108:111], v[144:147], v[84:87]
    ds_read_b128 v[238:241], v68 offset:2976
    v_mfma_f32_16x16x32_bf16 v[88:91], v[108:111], v[148:151], v[88:91]
    v_mfma_f32_16x16x32_bf16 v[92:95], v[108:111], v[152:155], v[92:95]
    ds_read_b128 v[242:245], v68 offset:3488
    v_mfma_f32_16x16x32_bf16 v[96:99], v[108:111], v[156:159], v[96:99]
    ds_read_b128 v[246:249], v68 offset:4000
    v_mfma_f32_16x16x32_bf16 v[100:103], v[108:111], v[160:163], v[100:103]
    v_mfma_f32_16x16x32_bf16 v[80:83], v[112:115], v[136:139], v[80:83]
    ds_read2_b32 v[190:191], v61 offset0:32 offset1:33
    v_mfma_f32_16x16x32_bf16 v[84:87], v[112:115], v[140:143], v[84:87]
    ds_read2_b32 v[192:193], v61 offset0:34 offset1:35
    v_mfma_f32_16x16x32_bf16 v[88:91], v[112:115], v[144:147], v[88:91]
    v_mfma_f32_16x16x32_bf16 v[92:95], v[112:115], v[148:151], v[92:95]
    ds_read2_b32 v[194:195], v62 offset0:32 offset1:33
    v_mfma_f32_16x16x32_bf16 v[96:99], v[112:115], v[152:155], v[96:99]
    ds_read2_b32 v[196:197], v62 offset0:34 offset1:35
    v_mfma_f32_16x16x32_bf16 v[100:103], v[112:115], v[156:159], v[100:103]
    v_mfma_f32_16x16x32_bf16 v[84:87], v[116:119], v[136:139], v[84:87]
    ds_read2_b32 v[198:199], v63 offset0:32 offset1:33
    v_mfma_f32_16x16x32_bf16 v[88:91], v[116:119], v[140:143], v[88:91]
    ds_read2_b32 v[200:201], v63 offset0:34 offset1:35
    v_mfma_f32_16x16x32_bf16 v[92:95], v[116:119], v[144:147], v[92:95]
    v_mfma_f32_16x16x32_bf16 v[96:99], v[116:119], v[148:151], v[96:99]
    ds_read2_b32 v[202:203], v64 offset0:32 offset1:33
    v_mfma_f32_16x16x32_bf16 v[100:103], v[116:119], v[152:155], v[100:103]
    ds_read2_b32 v[204:205], v64 offset0:34 offset1:35
    s_waitcnt lgkmcnt(14)
    v_mfma_f32_16x16x32_bf16 v[88:91], v[120:123], v[136:139], v[88:91]
    v_mfma_f32_16x16x32_bf16 v[92:95], v[120:123], v[140:143], v[92:95]
    ds_read2_b32 v[206:207], v65 offset0:32 offset1:33
    v_mfma_f32_16x16x32_bf16 v[96:99], v[120:123], v[144:147], v[96:99]
    ds_read2_b32 v[208:209], v65 offset0:34 offset1:35
    v_mfma_f32_16x16x32_bf16 v[100:103], v[120:123], v[148:151], v[100:103]
    v_mfma_f32_16x16x32_bf16 v[92:95], v[124:127], v[136:139], v[92:95]
    ds_read2_b32 v[210:211], v66 offset0:32 offset1:33
    v_mfma_f32_16x16x32_bf16 v[96:99], v[124:127], v[140:143], v[96:99]
    ds_read2_b32 v[212:213], v66 offset0:34 offset1:35
    v_mfma_f32_16x16x32_bf16 v[100:103], v[124:127], v[144:147], v[100:103]
    v_mfma_f32_16x16x32_bf16 v[96:99], v[128:131], v[136:139], v[96:99]
    ds_read2_b32 v[214:215], v67 offset0:32 offset1:33
    v_mfma_f32_16x16x32_bf16 v[100:103], v[128:131], v[140:143], v[100:103]
    ds_read2_b32 v[216:217], v67 offset0:34 offset1:35
    v_mfma_f32_16x16x32_bf16 v[100:103], v[132:135], v[136:139], v[100:103]
    v_mfma_f32_16x16x32_bf16 v[72:75], v[186:189], v[218:221], v[72:75]
    ds_read2_b32 v[104:105], v60 offset0:16 offset1:17
    v_mfma_f32_16x16x32_bf16 v[76:79], v[186:189], v[222:225], v[76:79]
    ds_read2_b32 v[106:107], v60 offset0:18 offset1:19
    s_waitcnt lgkmcnt(14)
    v_mfma_f32_16x16x32_bf16 v[80:83], v[186:189], v[226:229], v[80:83]
    v_mfma_f32_16x16x32_bf16 v[84:87], v[186:189], v[230:233], v[84:87]
    ds_read_b128 v[136:139], v68 offset:352
    v_mfma_f32_16x16x32_bf16 v[88:91], v[186:189], v[234:237], v[88:91]
    ds_read_b128 v[140:143], v68 offset:864
    v_mfma_f32_16x16x32_bf16 v[92:95], v[186:189], v[238:241], v[92:95]
    v_mfma_f32_16x16x32_bf16 v[96:99], v[186:189], v[242:245], v[96:99]
    ds_read_b128 v[144:147], v68 offset:1376
    v_mfma_f32_16x16x32_bf16 v[100:103], v[186:189], v[246:249], v[100:103]
    ds_read_b128 v[148:151], v68 offset:1888
    v_mfma_f32_16x16x32_bf16 v[76:79], v[190:193], v[218:221], v[76:79]
    v_mfma_f32_16x16x32_bf16 v[80:83], v[190:193], v[222:225], v[80:83]
    ds_read_b128 v[152:155], v68 offset:2400
    v_mfma_f32_16x16x32_bf16 v[84:87], v[190:193], v[226:229], v[84:87]
    ds_read_b128 v[156:159], v68 offset:2912
    v_mfma_f32_16x16x32_bf16 v[88:91], v[190:193], v[230:233], v[88:91]
    v_mfma_f32_16x16x32_bf16 v[92:95], v[190:193], v[234:237], v[92:95]
    ds_read_b128 v[160:163], v68 offset:3424
    v_mfma_f32_16x16x32_bf16 v[96:99], v[190:193], v[238:241], v[96:99]
    ds_read_b128 v[164:167], v68 offset:3936
    v_mfma_f32_16x16x32_bf16 v[100:103], v[190:193], v[242:245], v[100:103]
    s_waitcnt lgkmcnt(14)
    v_mfma_f32_16x16x32_bf16 v[80:83], v[194:197], v[218:221], v[80:83]
    ds_read2_b32 v[108:109], v61 offset0:16 offset1:17
    v_mfma_f32_16x16x32_bf16 v[84:87], v[194:197], v[222:225], v[84:87]
    ds_read2_b32 v[110:111], v61 offset0:18 offset1:19
    v_mfma_f32_16x16x32_bf16 v[88:91], v[194:197], v[226:229], v[88:91]
    v_mfma_f32_16x16x32_bf16 v[92:95], v[194:197], v[230:233], v[92:95]
    ds_read2_b32 v[112:113], v62 offset0:16 offset1:17
    v_mfma_f32_16x16x32_bf16 v[96:99], v[194:197], v[234:237], v[96:99]
    ds_read2_b32 v[114:115], v62 offset0:18 offset1:19
    v_mfma_f32_16x16x32_bf16 v[100:103], v[194:197], v[238:241], v[100:103]
    v_mfma_f32_16x16x32_bf16 v[84:87], v[198:201], v[218:221], v[84:87]
    ds_read2_b32 v[116:117], v63 offset0:16 offset1:17
    v_mfma_f32_16x16x32_bf16 v[88:91], v[198:201], v[222:225], v[88:91]
    ds_read2_b32 v[118:119], v63 offset0:18 offset1:19
    v_mfma_f32_16x16x32_bf16 v[92:95], v[198:201], v[226:229], v[92:95]
    v_mfma_f32_16x16x32_bf16 v[96:99], v[198:201], v[230:233], v[96:99]
    ds_read2_b32 v[120:121], v64 offset0:16 offset1:17
    v_mfma_f32_16x16x32_bf16 v[100:103], v[198:201], v[234:237], v[100:103]
    ds_read2_b32 v[122:123], v64 offset0:18 offset1:19
    v_mfma_f32_16x16x32_bf16 v[88:91], v[202:205], v[218:221], v[88:91]
    v_mfma_f32_16x16x32_bf16 v[92:95], v[202:205], v[222:225], v[92:95]
    ds_read2_b32 v[124:125], v65 offset0:16 offset1:17
    v_mfma_f32_16x16x32_bf16 v[96:99], v[202:205], v[226:229], v[96:99]
    ds_read2_b32 v[126:127], v65 offset0:18 offset1:19
    v_mfma_f32_16x16x32_bf16 v[100:103], v[202:205], v[230:233], v[100:103]
    v_mfma_f32_16x16x32_bf16 v[92:95], v[206:209], v[218:221], v[92:95]
    ds_read2_b32 v[128:129], v66 offset0:16 offset1:17
    v_mfma_f32_16x16x32_bf16 v[96:99], v[206:209], v[222:225], v[96:99]
    ds_read2_b32 v[130:131], v66 offset0:18 offset1:19
    v_mfma_f32_16x16x32_bf16 v[100:103], v[206:209], v[226:229], v[100:103]
    s_waitcnt lgkmcnt(14)
    v_mfma_f32_16x16x32_bf16 v[96:99], v[210:213], v[218:221], v[96:99]
    ds_read2_b32 v[132:133], v67 offset0:16 offset1:17
    v_mfma_f32_16x16x32_bf16 v[100:103], v[210:213], v[222:225], v[100:103]
    ds_read2_b32 v[134:135], v67 offset0:18 offset1:19
    v_mfma_f32_16x16x32_bf16 v[100:103], v[214:217], v[218:221], v[100:103]
    v_mfma_f32_16x16x32_bf16 v[72:75], v[104:107], v[136:139], v[72:75]
    ds_read2_b32 v[186:187], v60 offset0:0 offset1:1
    v_mfma_f32_16x16x32_bf16 v[76:79], v[104:107], v[140:143], v[76:79]
    ds_read2_b32 v[188:189], v60 offset0:2 offset1:3
    v_mfma_f32_16x16x32_bf16 v[80:83], v[104:107], v[144:147], v[80:83]
    v_mfma_f32_16x16x32_bf16 v[84:87], v[104:107], v[148:151], v[84:87]
    ds_read_b128 v[218:221], v68 offset:288
    v_mfma_f32_16x16x32_bf16 v[88:91], v[104:107], v[152:155], v[88:91]
    ds_read_b128 v[222:225], v68 offset:800
    v_mfma_f32_16x16x32_bf16 v[92:95], v[104:107], v[156:159], v[92:95]
    s_waitcnt lgkmcnt(14)
    v_mfma_f32_16x16x32_bf16 v[96:99], v[104:107], v[160:163], v[96:99]
    ds_read_b128 v[226:229], v68 offset:1312
    v_mfma_f32_16x16x32_bf16 v[100:103], v[104:107], v[164:167], v[100:103]
    ds_read_b128 v[230:233], v68 offset:1824
    v_mfma_f32_16x16x32_bf16 v[76:79], v[108:111], v[136:139], v[76:79]
    v_mfma_f32_16x16x32_bf16 v[80:83], v[108:111], v[140:143], v[80:83]
    ds_read_b128 v[234:237], v68 offset:2336
    v_mfma_f32_16x16x32_bf16 v[84:87], v[108:111], v[144:147], v[84:87]
    ds_read_b128 v[238:241], v68 offset:2848
    v_mfma_f32_16x16x32_bf16 v[88:91], v[108:111], v[148:151], v[88:91]
    v_mfma_f32_16x16x32_bf16 v[92:95], v[108:111], v[152:155], v[92:95]
    ds_read_b128 v[242:245], v68 offset:3360
    v_mfma_f32_16x16x32_bf16 v[96:99], v[108:111], v[156:159], v[96:99]
    ds_read_b128 v[246:249], v68 offset:3872
    v_mfma_f32_16x16x32_bf16 v[100:103], v[108:111], v[160:163], v[100:103]
    v_mfma_f32_16x16x32_bf16 v[80:83], v[112:115], v[136:139], v[80:83]
    ds_read2_b32 v[190:191], v61 offset0:0 offset1:1
    v_mfma_f32_16x16x32_bf16 v[84:87], v[112:115], v[140:143], v[84:87]
    ds_read2_b32 v[192:193], v61 offset0:2 offset1:3
    v_mfma_f32_16x16x32_bf16 v[88:91], v[112:115], v[144:147], v[88:91]
    v_mfma_f32_16x16x32_bf16 v[92:95], v[112:115], v[148:151], v[92:95]
    ds_read2_b32 v[194:195], v62 offset0:0 offset1:1
    v_mfma_f32_16x16x32_bf16 v[96:99], v[112:115], v[152:155], v[96:99]
    ds_read2_b32 v[196:197], v62 offset0:2 offset1:3
    v_mfma_f32_16x16x32_bf16 v[100:103], v[112:115], v[156:159], v[100:103]
    s_waitcnt lgkmcnt(14)
    v_mfma_f32_16x16x32_bf16 v[84:87], v[116:119], v[136:139], v[84:87]
    ds_read2_b32 v[198:199], v63 offset0:0 offset1:1
    v_mfma_f32_16x16x32_bf16 v[88:91], v[116:119], v[140:143], v[88:91]
    ds_read2_b32 v[200:201], v63 offset0:2 offset1:3
    v_mfma_f32_16x16x32_bf16 v[92:95], v[116:119], v[144:147], v[92:95]
    v_mfma_f32_16x16x32_bf16 v[96:99], v[116:119], v[148:151], v[96:99]
    ds_read2_b32 v[202:203], v64 offset0:0 offset1:1
    v_mfma_f32_16x16x32_bf16 v[100:103], v[116:119], v[152:155], v[100:103]
    ds_read2_b32 v[204:205], v64 offset0:2 offset1:3
    v_mfma_f32_16x16x32_bf16 v[88:91], v[120:123], v[136:139], v[88:91]
    v_mfma_f32_16x16x32_bf16 v[92:95], v[120:123], v[140:143], v[92:95]
    ds_read2_b32 v[206:207], v65 offset0:0 offset1:1
    v_mfma_f32_16x16x32_bf16 v[96:99], v[120:123], v[144:147], v[96:99]
    ds_read2_b32 v[208:209], v65 offset0:2 offset1:3
    v_mfma_f32_16x16x32_bf16 v[100:103], v[120:123], v[148:151], v[100:103]
    v_mfma_f32_16x16x32_bf16 v[92:95], v[124:127], v[136:139], v[92:95]
    ds_read2_b32 v[210:211], v66 offset0:0 offset1:1
    v_mfma_f32_16x16x32_bf16 v[96:99], v[124:127], v[140:143], v[96:99]
    ds_read2_b32 v[212:213], v66 offset0:2 offset1:3
    v_mfma_f32_16x16x32_bf16 v[100:103], v[124:127], v[144:147], v[100:103]
    v_mfma_f32_16x16x32_bf16 v[96:99], v[128:131], v[136:139], v[96:99]
    ds_read2_b32 v[214:215], v67 offset0:0 offset1:1
    v_mfma_f32_16x16x32_bf16 v[100:103], v[128:131], v[140:143], v[100:103]
    ds_read2_b32 v[216:217], v67 offset0:2 offset1:3
    v_mfma_f32_16x16x32_bf16 v[100:103], v[132:135], v[136:139], v[100:103]
    s_waitcnt lgkmcnt(14)
    v_mfma_f32_16x16x32_bf16 v[72:75], v[186:189], v[218:221], v[72:75]
    v_mfma_f32_16x16x32_bf16 v[76:79], v[186:189], v[222:225], v[76:79]
    v_mfma_f32_16x16x32_bf16 v[80:83], v[186:189], v[226:229], v[80:83]
    v_mfma_f32_16x16x32_bf16 v[84:87], v[186:189], v[230:233], v[84:87]
    v_mfma_f32_16x16x32_bf16 v[88:91], v[186:189], v[234:237], v[88:91]
    v_mfma_f32_16x16x32_bf16 v[92:95], v[186:189], v[238:241], v[92:95]
    v_mfma_f32_16x16x32_bf16 v[96:99], v[186:189], v[242:245], v[96:99]
    v_mfma_f32_16x16x32_bf16 v[100:103], v[186:189], v[246:249], v[100:103]
    s_waitcnt lgkmcnt(12)
    v_mfma_f32_16x16x32_bf16 v[76:79], v[190:193], v[218:221], v[76:79]
    v_mfma_f32_16x16x32_bf16 v[80:83], v[190:193], v[222:225], v[80:83]
    v_mfma_f32_16x16x32_bf16 v[84:87], v[190:193], v[226:229], v[84:87]
    v_mfma_f32_16x16x32_bf16 v[88:91], v[190:193], v[230:233], v[88:91]
    v_mfma_f32_16x16x32_bf16 v[92:95], v[190:193], v[234:237], v[92:95]
    v_mfma_f32_16x16x32_bf16 v[96:99], v[190:193], v[238:241], v[96:99]
    v_mfma_f32_16x16x32_bf16 v[100:103], v[190:193], v[242:245], v[100:103]
    s_waitcnt lgkmcnt(10)
    v_mfma_f32_16x16x32_bf16 v[80:83], v[194:197], v[218:221], v[80:83]
    v_mfma_f32_16x16x32_bf16 v[84:87], v[194:197], v[222:225], v[84:87]
    v_mfma_f32_16x16x32_bf16 v[88:91], v[194:197], v[226:229], v[88:91]
    v_mfma_f32_16x16x32_bf16 v[92:95], v[194:197], v[230:233], v[92:95]
    v_mfma_f32_16x16x32_bf16 v[96:99], v[194:197], v[234:237], v[96:99]
    v_mfma_f32_16x16x32_bf16 v[100:103], v[194:197], v[238:241], v[100:103]
    s_waitcnt lgkmcnt(8)
    v_mfma_f32_16x16x32_bf16 v[84:87], v[198:201], v[218:221], v[84:87]
    v_mfma_f32_16x16x32_bf16 v[88:91], v[198:201], v[222:225], v[88:91]
    v_mfma_f32_16x16x32_bf16 v[92:95], v[198:201], v[226:229], v[92:95]
    v_mfma_f32_16x16x32_bf16 v[96:99], v[198:201], v[230:233], v[96:99]
    v_mfma_f32_16x16x32_bf16 v[100:103], v[198:201], v[234:237], v[100:103]
    s_waitcnt lgkmcnt(6)
    v_mfma_f32_16x16x32_bf16 v[88:91], v[202:205], v[218:221], v[88:91]
    v_mfma_f32_16x16x32_bf16 v[92:95], v[202:205], v[222:225], v[92:95]
    v_mfma_f32_16x16x32_bf16 v[96:99], v[202:205], v[226:229], v[96:99]
    v_mfma_f32_16x16x32_bf16 v[100:103], v[202:205], v[230:233], v[100:103]
    s_waitcnt lgkmcnt(4)
    v_mfma_f32_16x16x32_bf16 v[92:95], v[206:209], v[218:221], v[92:95]
    v_mfma_f32_16x16x32_bf16 v[96:99], v[206:209], v[222:225], v[96:99]
    v_mfma_f32_16x16x32_bf16 v[100:103], v[206:209], v[226:229], v[100:103]
    s_waitcnt lgkmcnt(2)
    v_mfma_f32_16x16x32_bf16 v[96:99], v[210:213], v[218:221], v[96:99]
    v_mfma_f32_16x16x32_bf16 v[100:103], v[210:213], v[222:225], v[100:103]
    s_waitcnt lgkmcnt(0)
    v_mfma_f32_16x16x32_bf16 v[100:103], v[214:217], v[218:221], v[100:103]
    s_lshl_b32 s46, s28, 13
    v_lshlrev_b32 v11, 4, v1
    v_add_u32 v12, s46, v11
    s_nop 5
    ds_write_b128 v12, v[72:75] offset:0
    ds_write_b128 v12, v[76:79] offset:1024
    ds_write_b128 v12, v[80:83] offset:2048
    ds_write_b128 v12, v[84:87] offset:3072
    ds_write_b128 v12, v[88:91] offset:4096
    ds_write_b128 v12, v[92:95] offset:5120
    ds_write_b128 v12, v[96:99] offset:6144
    ds_write_b128 v12, v[100:103] offset:7168
    s_branch BL0_SKIPMM
BL0_IDLE:
    v_lshrrev_b32 v11, 3, v1
    v_mul_u32_u24 v14, 3072, v11
    v_and_b32 v15, 1, v3
    v_lshrrev_b32 v13, 1, v1
    v_and_b32 v13, 3, v13
    v_xor_b32 v13, v13, v15
    v_lshlrev_b32 v13, 5, v13
    v_and_b32 v12, 1, v1
    v_lshlrev_b32 v12, 4, v12
    v_add_u32 v14, v14, v12
    s_lshl_b32 s35, s32, 7
    v_add_u32 v14, s35, v14
    v_add_u32 v7, v14, v13
    v_xor_b32 v13, 64, v13
    v_add_u32 v8, v14, v13
    s_sub_u32 s36, s28, 4
    s_mul_i32 s36, s36, 192
    s_lshl_b32 s35, s31, 7
    s_sub_u32 s35, s35, 32
    v_add_u32 v11, s36, v1
    v_mul_u32_u24 v12, 5462, v11
    v_lshrrev_b32 v12, 16, v12
    v_mul_u32_u24 v13, 12, v12
    v_sub_u32 v13, v11, v13
    v_lshrrev_b32 v14, 2, v12
    v_and_b32 v14, 2, v14
    v_sub_u32 v13, v13, v14
    v_med3_i32 v13, v13, 0, 9
    v_lshlrev_b32 v13, 4, v13
    v_lshlrev_b32 v12, 12, v12
    v_add_u32 v12, v12, v13
    v_add_u32 v4, s35, v12
    v_add_u32 v11, s36, v1
    v_add_u32 v11, 64, v11
    v_mul_u32_u24 v12, 5462, v11
    v_lshrrev_b32 v12, 16, v12
    v_mul_u32_u24 v13, 12, v12
    v_sub_u32 v13, v11, v13
    v_lshrrev_b32 v14, 2, v12
    v_and_b32 v14, 2, v14
    v_sub_u32 v13, v13, v14
    v_med3_i32 v13, v13, 0, 9
    v_lshlrev_b32 v13, 4, v13
    v_lshlrev_b32 v12, 12, v12
    v_add_u32 v12, v12, v13
    v_add_u32 v5, s35, v12
    v_add_u32 v11, s36, v1
    v_add_u32 v11, 128, v11
    v_mul_u32_u24 v12, 5462, v11
    v_lshrrev_b32 v12, 16, v12
    v_mul_u32_u24 v13, 12, v12
    v_sub_u32 v13, v11, v13
    v_lshrrev_b32 v14, 2, v12
    v_and_b32 v14, 2, v14
    v_sub_u32 v13, v13, v14
    v_med3_i32 v13, v13, 0, 9
    v_lshlrev_b32 v13, 4, v13
    v_lshlrev_b32 v12, 12, v12
    v_add_u32 v12, v12, v13
    v_add_u32 v6, s35, v12
    s_mov_b32 s16, s6
    s_mov_b32 s17, s7
    s_mov_b32 s18, 1572864
    s_mov_b32 s19, 0x20000
    s_cmp_lg_u32 s28, 4
    s_cbranch_scc1 WP_N0
    s_mov_b32 m0, 49152
    s_mov_b32 s45, 0
    buffer_load_dwordx4 v7, s[16:19], s45 offen lds
    s_mov_b32 m0, 50176
    s_mov_b32 s45, 24576
    buffer_load_dwordx4 v8, s[16:19], s45 offen lds
    s_mov_b32 m0, 57344
    s_mov_b32 s45, 1024
    buffer_load_dwordx4 v7, s[16:19], s45 offen lds
    s_mov_b32 m0, 58368
    s_mov_b32 s45, 25600
    buffer_load_dwordx4 v8, s[16:19], s45 offen lds
    s_mov_b32 m0, 65536
    s_mov_b32 s45, 2048
    buffer_load_dwordx4 v7, s[16:19], s45 offen lds
    s_mov_b32 m0, 66560
    s_mov_b32 s45, 26624
    buffer_load_dwordx4 v8, s[16:19], s45 offen lds
    s_mov_b32 m0, 73728
    s_mov_b32 s45, 196608
    buffer_load_dwordx4 v7, s[16:19], s45 offen lds
    s_mov_b32 m0, 74752
    s_mov_b32 s45, 221184
    buffer_load_dwordx4 v8, s[16:19], s45 offen lds
    s_mov_b32 m0, 81920
    s_mov_b32 s45, 197632
    buffer_load_dwordx4 v7, s[16:19], s45 offen lds
    s_mov_b32 m0, 82944
    s_mov_b32 s45, 222208
    buffer_load_dwordx4 v8, s[16:19], s45 offen lds
    s_mov_b32 m0, 90112
    s_mov_b32 s45, 198656
    buffer_load_dwordx4 v7, s[16:19], s45 offen lds
    s_mov_b32 m0, 91136
    s_mov_b32 s45, 223232
    buffer_load_dwordx4 v8, s[16:19], s45 offen lds
    s_mov_b32 m0, 98304
    s_mov_b32 s45, 393216
    buffer_load_dwordx4 v7, s[16:19], s45 offen lds
    s_mov_b32 m0, 99328
    s_mov_b32 s45, 417792
    buffer_load_dwordx4 v8, s[16:19], s45 offen lds
    s_mov_b32 m0, 106496
    s_mov_b32 s45, 394240
    buffer_load_dwordx4 v7, s[16:19], s45 offen lds
    s_mov_b32 m0, 107520
    s_mov_b32 s45, 418816
    buffer_load_dwordx4 v8, s[16:19], s45 offen lds
    s_mov_b32 m0, 114688
    s_mov_b32 s45, 395264
    buffer_load_dwordx4 v7, s[16:19], s45 offen lds
    s_mov_b32 m0, 115712
    s_mov_b32 s45, 419840
    buffer_load_dwordx4 v8, s[16:19], s45 offen lds
WP_N0:
    s_cmp_lg_u32 s28, 5
    s_cbranch_scc1 WP_N1
    s_mov_b32 m0, 51200
    s_mov_b32 s45, 49152
    buffer_load_dwordx4 v7, s[16:19], s45 offen lds
    s_mov_b32 m0, 52224
    s_mov_b32 s45, 73728
    buffer_load_dwordx4 v8, s[16:19], s45 offen lds
    s_mov_b32 m0, 59392
    s_mov_b32 s45, 50176
    buffer_load_dwordx4 v7, s[16:19], s45 offen lds
    s_mov_b32 m0, 60416
    s_mov_b32 s45, 74752
    buffer_load_dwordx4 v8, s[16:19], s45 offen lds
    s_mov_b32 m0, 67584
    s_mov_b32 s45, 51200
    buffer_load_dwordx4 v7, s[16:19], s45 offen lds
    s_mov_b32 m0, 68608
    s_mov_b32 s45, 75776
    buffer_load_dwordx4 v8, s[16:19], s45 offen lds
    s_mov_b32 m0, 75776
    s_mov_b32 s45, 245760
    buffer_load_dwordx4 v7, s[16:19], s45 offen lds
    s_mov_b32 m0, 76800
    s_mov_b32 s45, 270336
    buffer_load_dwordx4 v8, s[16:19], s45 offen lds
    s_mov_b32 m0, 83968
    s_mov_b32 s45, 246784
    buffer_load_dwordx4 v7, s[16:19], s45 offen lds
    s_mov_b32 m0, 84992
    s_mov_b32 s45, 271360
    buffer_load_dwordx4 v8, s[16:19], s45 offen lds
    s_mov_b32 m0, 92160
    s_mov_b32 s45, 247808
    buffer_load_dwordx4 v7, s[16:19], s45 offen lds
    s_mov_b32 m0, 93184
    s_mov_b32 s45, 272384
    buffer_load_dwordx4 v8, s[16:19], s45 offen lds
    s_mov_b32 m0, 100352
    s_mov_b32 s45, 442368
    buffer_load_dwordx4 v7, s[16:19], s45 offen lds
    s_mov_b32 m0, 101376
    s_mov_b32 s45, 466944
    buffer_load_dwordx4 v8, s[16:19], s45 offen lds
    s_mov_b32 m0, 108544
    s_mov_b32 s45, 443392
    buffer_load_dwordx4 v7, s[16:19], s45 offen lds
    s_mov_b32 m0, 109568
    s_mov_b32 s45, 467968
    buffer_load_dwordx4 v8, s[16:19], s45 offen lds
    s_mov_b32 m0, 116736
    s_mov_b32 s45, 444416
    buffer_load_dwordx4 v7, s[16:19], s45 offen lds
    s_mov_b32 m0, 117760
    s_mov_b32 s45, 468992
    buffer_load_dwordx4 v8, s[16:19], s45 offen lds
WP_N1:
    s_cmp_lg_u32 s28, 6
    s_cbranch_scc1 WP_N2
    s_mov_b32 m0, 53248
    s_mov_b32 s45, 98304
    buffer_load_dwordx4 v7, s[16:19], s45 offen lds
    s_mov_b32 m0, 54272
    s_mov_b32 s45, 122880
    buffer_load_dwordx4 v8, s[16:19], s45 offen lds
    s_mov_b32 m0, 61440
    s_mov_b32 s45, 99328
    buffer_load_dwordx4 v7, s[16:19], s45 offen lds
    s_mov_b32 m0, 62464
    s_mov_b32 s45, 123904
    buffer_load_dwordx4 v8, s[16:19], s45 offen lds
    s_mov_b32 m0, 69632
    s_mov_b32 s45, 100352
    buffer_load_dwordx4 v7, s[16:19], s45 offen lds
    s_mov_b32 m0, 70656
    s_mov_b32 s45, 124928
    buffer_load_dwordx4 v8, s[16:19], s45 offen lds
    s_mov_b32 m0, 77824
    s_mov_b32 s45, 294912
    buffer_load_dwordx4 v7, s[16:19], s45 offen lds
    s_mov_b32 m0, 78848
    s_mov_b32 s45, 319488
    buffer_load_dwordx4 v8, s[16:19], s45 offen lds
    s_mov_b32 m0, 86016
    s_mov_b32 s45, 295936
    buffer_load_dwordx4 v7, s[16:19], s45 offen lds
    s_mov_b32 m0, 87040
    s_mov_b32 s45, 320512
    buffer_load_dwordx4 v8, s[16:19], s45 offen lds
    s_mov_b32 m0, 94208
    s_mov_b32 s45, 296960
    buffer_load_dwordx4 v7, s[16:19], s45 offen lds
    s_mov_b32 m0, 95232
    s_mov_b32 s45, 321536
    buffer_load_dwordx4 v8, s[16:19], s45 offen lds
    s_mov_b32 m0, 102400
    s_mov_b32 s45, 491520
    buffer_load_dwordx4 v7, s[16:19], s45 offen lds
    s_mov_b32 m0, 103424
    s_mov_b32 s45, 516096
    buffer_load_dwordx4 v8, s[16:19], s45 offen lds
    s_mov_b32 m0, 110592
    s_mov_b32 s45, 492544
    buffer_load_dwordx4 v7, s[16:19], s45 offen lds
    s_mov_b32 m0, 111616
    s_mov_b32 s45, 517120
    buffer_load_dwordx4 v8, s[16:19], s45 offen lds
    s_mov_b32 m0, 118784
    s_mov_b32 s45, 493568
    buffer_load_dwordx4 v7, s[16:19], s45 offen lds
    s_mov_b32 m0, 119808
    s_mov_b32 s45, 518144
    buffer_load_dwordx4 v8, s[16:19], s45 offen lds
WP_N2:
    s_cmp_lg_u32 s28, 7
    s_cbranch_scc1 WP_N3
    s_mov_b32 m0, 55296
    s_mov_b32 s45, 147456
    buffer_load_dwordx4 v7, s[16:19], s45 offen lds
    s_mov_b32 m0, 56320
    s_mov_b32 s45, 172032
    buffer_load_dwordx4 v8, s[16:19], s45 offen lds
    s_mov_b32 m0, 63488
    s_mov_b32 s45, 148480
    buffer_load_dwordx4 v7, s[16:19], s45 offen lds
    s_mov_b32 m0, 64512
    s_mov_b32 s45, 173056
    buffer_load_dwordx4 v8, s[16:19], s45 offen lds
    s_mov_b32 m0, 71680
    s_mov_b32 s45, 149504
    buffer_load_dwordx4 v7, s[16:19], s45 offen lds
    s_mov_b32 m0, 72704
    s_mov_b32 s45, 174080
    buffer_load_dwordx4 v8, s[16:19], s45 offen lds
    s_mov_b32 m0, 79872
    s_mov_b32 s45, 344064
    buffer_load_dwordx4 v7, s[16:19], s45 offen lds
    s_mov_b32 m0, 80896
    s_mov_b32 s45, 368640
    buffer_load_dwordx4 v8, s[16:19], s45 offen lds
    s_mov_b32 m0, 88064
    s_mov_b32 s45, 345088
    buffer_load_dwordx4 v7, s[16:19], s45 offen lds
    s_mov_b32 m0, 89088
    s_mov_b32 s45, 369664
    buffer_load_dwordx4 v8, s[16:19], s45 offen lds
    s_mov_b32 m0, 96256
    s_mov_b32 s45, 346112
    buffer_load_dwordx4 v7, s[16:19], s45 offen lds
    s_mov_b32 m0, 97280
    s_mov_b32 s45, 370688
    buffer_load_dwordx4 v8, s[16:19], s45 offen lds
    s_mov_b32 m0, 104448
    s_mov_b32 s45, 540672
    buffer_load_dwordx4 v7, s[16:19], s45 offen lds
    s_mov_b32 m0, 105472
    s_mov_b32 s45, 565248
    buffer_load_dwordx4 v8, s[16:19], s45 offen lds
    s_mov_b32 m0, 112640
    s_mov_b32 s45, 541696
    buffer_load_dwordx4 v7, s[16:19], s45 offen lds
    s_mov_b32 m0, 113664
    s_mov_b32 s45, 566272
    buffer_load_dwordx4 v8, s[16:19], s45 offen lds
    s_mov_b32 m0, 120832
    s_mov_b32 s45, 542720
    buffer_load_dwordx4 v7, s[16:19], s45 offen lds
    s_mov_b32 m0, 121856
    s_mov_b32 s45, 567296
    buffer_load_dwordx4 v8, s[16:19], s45 offen lds
WP_N3:
    s_add_u32 s24, s8, 262144
    s_addc_u32 s25, s9, 0
    s_mov_b32 s26, 4259840
    s_mov_b32 s27, 0x20000
    s_mul_i32 s40, s33, 16640
    s_sub_u32 s41, s28, 4
    s_lshl_b32 s41, s41, 12
    v_lshlrev_b32 v40, 4, v1
    v_add_u32 v41, s41, v40
    v_add_u32 v42, 131072, v41
    ds_read_b128 v[44:47], v42 offset:0
    ds_read_b128 v[48:51], v42 offset:1024
    ds_read_b128 v[52:55], v42 offset:2048
    ds_read_b128 v[56:59], v42 offset:3072
    s_waitcnt lgkmcnt(0)
    buffer_store_dwordx4 v[44:47], v41, s[24:27], s40 offen offset:0 sc1
    buffer_store_dwordx4 v[48:51], v41, s[24:27], s40 offen offset:1024 sc1
    buffer_store_dwordx4 v[52:55], v41, s[24:27], s40 offen offset:2048 sc1
    buffer_store_dwordx4 v[56:59], v41, s[24:27], s40 offen offset:3072 sc1
    s_cmp_lg_u32 s28, 7
    s_cbranch_scc1 KTX_END
    s_mov_b64 exec, 0xffff
    v_add_u32 v42, 147456, v40
    ds_read_b128 v[60:63], v42
    s_add_u32 s40, s40, 16384
    s_waitcnt lgkmcnt(0)
    buffer_store_dwordx4 v[60:63], v40, s[24:27], s40 offen sc1
    s_mov_b64 exec, -1
KTX_END:
    s_lshl_b32 s95, s33, 13
BL0_SKIPMM:
    s_waitcnt lgkmcnt(0)
    s_barrier
    s_cmp_lg_u32 s28, 4
    s_cbranch_scc1 WP3_N0
    s_mov_b32 m0, 122880
    s_mov_b32 s45, 589824
    buffer_load_dwordx4 v7, s[16:19], s45 offen lds
    s_mov_b32 m0, 123904
    s_mov_b32 s45, 614400
    buffer_load_dwordx4 v8, s[16:19], s45 offen lds
    s_mov_b32 m0, 131072
    s_mov_b32 s45, 590848
    buffer_load_dwordx4 v7, s[16:19], s45 offen lds
    s_mov_b32 m0, 132096
    s_mov_b32 s45, 615424
    buffer_load_dwordx4 v8, s[16:19], s45 offen lds
    s_mov_b32 m0, 139264
    s_mov_b32 s45, 591872
    buffer_load_dwordx4 v7, s[16:19], s45 offen lds
    s_mov_b32 m0, 140288
    s_mov_b32 s45, 616448
    buffer_load_dwordx4 v8, s[16:19], s45 offen lds
WP3_N0:
    s_cmp_lg_u32 s28, 5
    s_cbranch_scc1 WP3_N1
    s_mov_b32 m0, 124928
    s_mov_b32 s45, 638976
    buffer_load_dwordx4 v7, s[16:19], s45 offen lds
    s_mov_b32 m0, 125952
    s_mov_b32 s45, 663552
    buffer_load_dwordx4 v8, s[16:19], s45 offen lds
    s_mov_b32 m0, 133120
    s_mov_b32 s45, 640000
    buffer_load_dwordx4 v7, s[16:19], s45 offen lds
    s_mov_b32 m0, 134144
    s_mov_b32 s45, 664576
    buffer_load_dwordx4 v8, s[16:19], s45 offen lds
    s_mov_b32 m0, 141312
    s_mov_b32 s45, 641024
    buffer_load_dwordx4 v7, s[16:19], s45 offen lds
    s_mov_b32 m0, 142336
    s_mov_b32 s45, 665600
    buffer_load_dwordx4 v8, s[16:19], s45 offen lds
WP3_N1:
    s_cmp_lg_u32 s28, 6
    s_cbranch_scc1 WP3_N2
    s_mov_b32 m0, 126976
    s_mov_b32 s45, 688128
    buffer_load_dwordx4 v7, s[16:19], s45 offen lds
    s_mov_b32 m0, 128000
    s_mov_b32 s45, 712704
    buffer_load_dwordx4 v8, s[16:19], s45 offen lds
    s_mov_b32 m0, 135168
    s_mov_b32 s45, 689152
    buffer_load_dwordx4 v7, s[16:19], s45 offen lds
    s_mov_b32 m0, 136192
    s_mov_b32 s45, 713728
    buffer_load_dwordx4 v8, s[16:19], s45 offen lds
    s_mov_b32 m0, 143360
    s_mov_b32 s45, 690176
    buffer_load_dwordx4 v7, s[16:19], s45 offen lds
    s_mov_b32 m0, 144384
    s_mov_b32 s45, 714752
    buffer_load_dwordx4 v8, s[16:19], s45 offen lds
WP3_N2:
    s_cmp_lg_u32 s28, 7
    s_cbranch_scc1 WP3_N3
    s_mov_b32 m0, 129024
    s_mov_b32 s45, 737280
    buffer_load_dwordx4 v7, s[16:19], s45 offen lds
    s_mov_b32 m0, 130048
    s_mov_b32 s45, 761856
    buffer_load_dwordx4 v8, s[16:19], s45 offen lds
    s_mov_b32 m0, 137216
    s_mov_b32 s45, 738304
    buffer_load_dwordx4 v7, s[16:19], s45 offen lds
    s_mov_b32 m0, 138240
    s_mov_b32 s45, 762880
    buffer_load_dwordx4 v8, s[16:19], s45 offen lds
    s_mov_b32 m0, 145408
    s_mov_b32 s45, 739328
    buffer_load_dwordx4 v7, s[16:19], s45 offen lds
    s_mov_b32 m0, 146432
    s_mov_b32 s45, 763904
    buffer_load_dwordx4 v8, s[16:19], s45 offen lds
WP3_N3:
    s_mov_b32 s50, s28
BL0_EPI:
    s_lshl_b32 s46, s50, 10
    v_lshlrev_b32 v11, 4, v1
    v_add_u32 v12, s46, v11
    ds_read_b128 v[104:107], v12 offset:0
    ds_read_b128 v[108:111], v12 offset:8192
    ds_read_b128 v[112:115], v12 offset:16384
    ds_read_b128 v[116:119], v12 offset:24576
    v_lshlrev_b32 v14, 5, v2
    v_lshlrev_b32 v15, 3, v3
    v_add_u32 v14, v14, v15
    s_lshl_b32 s46, s50, 9
    v_add_u32 v14, s46, v14
    v_add_u32 v15, 147712, v14
    ds_read_b64 v[120:121], v14 offset:33280
    ds_read_b64 v[124:125], v15 offset:0
    ds_read_b64 v[122:123], v14 offset:37888
    ds_read_b64 v[126:127], v15 offset:4096
    s_lshl_b32 s48, s68, 16
    s_and_b32 s49, s68, 0xffff0000
    v_mov_b32 v136, s48
    v_mov_b32 v137, s49
    s_add_u32 s12, s8, 11010048
    s_addc_u32 s13, s9, 0
    s_mov_b32 s14, 2097152
    s_mov_b32 s15, 0x20000
    s_lshl_b32 s46, s33, 13
    s_lshl_b32 s47, s50, 9
    s_add_u32 s46, s46, s47
    s_waitcnt lgkmcnt(0)
    v_pk_add_f32 v[104:105], v[104:105], v[112:113]
    v_pk_add_f32 v[106:107], v[106:107], v[114:115]
    v_pk_add_f32 v[108:109], v[108:109], v[116:117]
    v_pk_add_f32 v[110:111], v[110:111], v[118:119]
    v_lshlrev_b32 v140, 16, v120
    v_and_b32 v141, 0xffff0000, v120
    v_lshlrev_b32 v144, 16, v124
    v_and_b32 v145, 0xffff0000, v124
    v_lshlrev_b32 v142, 16, v121
    v_and_b32 v143, 0xffff0000, v121
    v_lshlrev_b32 v146, 16, v125
    v_and_b32 v147, 0xffff0000, v125
    v_lshlrev_b32 v148, 16, v122
    v_and_b32 v149, 0xffff0000, v122
    v_lshlrev_b32 v152, 16, v126
    v_and_b32 v153, 0xffff0000, v126
    v_lshlrev_b32 v150, 16, v123
    v_and_b32 v151, 0xffff0000, v123
    v_lshlrev_b32 v154, 16, v127
    v_and_b32 v155, 0xffff0000, v127
    v_pk_fma_f32 v[104:105], v[140:141], v[136:137], v[104:105] op_sel:[0,0,0] op_sel_hi:[1,0,1]
    v_pk_fma_f32 v[106:107], v[142:143], v[136:137], v[106:107] op_sel:[0,0,0] op_sel_hi:[1,0,1]
    v_pk_fma_f32 v[108:109], v[148:149], v[136:137], v[108:109] op_sel:[0,1,0] op_sel_hi:[1,1,1]
    v_pk_fma_f32 v[110:111], v[150:151], v[136:137], v[110:111] op_sel:[0,1,0] op_sel_hi:[1,1,1]
    v_pk_add_f32 v[104:105], v[104:105], v[144:145]
    v_pk_add_f32 v[106:107], v[106:107], v[146:147]
    v_pk_add_f32 v[108:109], v[108:109], v[152:153]
    v_pk_add_f32 v[110:111], v[110:111], v[154:155]
    v_cvt_pk_bf16_f32 v160, v104, v105
    v_cvt_pk_bf16_f32 v161, v106, v107
    v_cvt_pk_bf16_f32 v162, v108, v109
    v_cvt_pk_bf16_f32 v163, v110, v111
    s_nop 0
    v_permlane16_swap_b32 v160, v162
    v_permlane16_swap_b32 v161, v163
    buffer_store_dwordx4 v[160:163], v17, s[12:15], s46 offen sc1
    s_lshl_b32 s82, s2, 7
    s_add_u32 s82, s82, 65536
    s_waitcnt vmcnt(0)
    s_barrier
    s_cmp_lg_u32 s28, 0
    s_cbranch_scc1 H3S
    v_mov_b32 v250, s34
    v_mov_b32 v251, s82
    s_mov_b64 exec, 1
    buffer_store_dword v250, v251, s[72:75], 0 offen sc1
    s_mov_b64 exec, -1
H3S:
    s_cmp_lt_u32 s28, 4
    s_cbranch_scc1 A1L1_SC
    v_lshrrev_b32 v11, 3, v1
    v_mul_u32_u24 v14, 3072, v11
    v_and_b32 v15, 1, v3
    v_lshrrev_b32 v13, 1, v1
    v_and_b32 v13, 3, v13
    v_xor_b32 v13, v13, v15
    v_lshlrev_b32 v13, 5, v13
    v_and_b32 v12, 1, v1
    v_lshlrev_b32 v12, 4, v12
    v_add_u32 v14, v14, v12
    s_lshl_b32 s35, s32, 7
    v_add_u32 v14, s35, v14
    v_add_u32 v7, v14, v13
    v_xor_b32 v13, 64, v13
    v_add_u32 v8, v14, v13
    s_sub_u32 s36, s28, 4
    s_mul_i32 s36, s36, 192
    s_lshl_b32 s35, s31, 7
    s_sub_u32 s35, s35, 32
    v_add_u32 v11, s36, v1
    v_mul_u32_u24 v12, 5462, v11
    v_lshrrev_b32 v12, 16, v12
    v_mul_u32_u24 v13, 12, v12
    v_sub_u32 v13, v11, v13
    v_lshrrev_b32 v14, 2, v12
    v_and_b32 v14, 2, v14
    v_sub_u32 v13, v13, v14
    v_med3_i32 v13, v13, 0, 9
    v_lshlrev_b32 v13, 4, v13
    v_lshlrev_b32 v12, 12, v12
    v_add_u32 v12, v12, v13
    v_add_u32 v4, s35, v12
    v_add_u32 v11, s36, v1
    v_add_u32 v11, 64, v11
    v_mul_u32_u24 v12, 5462, v11
    v_lshrrev_b32 v12, 16, v12
    v_mul_u32_u24 v13, 12, v12
    v_sub_u32 v13, v11, v13
    v_lshrrev_b32 v14, 2, v12
    v_and_b32 v14, 2, v14
    v_sub_u32 v13, v13, v14
    v_med3_i32 v13, v13, 0, 9
    v_lshlrev_b32 v13, 4, v13
    v_lshlrev_b32 v12, 12, v12
    v_add_u32 v12, v12, v13
    v_add_u32 v5, s35, v12
    v_add_u32 v11, s36, v1
    v_add_u32 v11, 128, v11
    v_mul_u32_u24 v12, 5462, v11
    v_lshrrev_b32 v12, 16, v12
    v_mul_u32_u24 v13, 12, v12
    v_sub_u32 v13, v11, v13
    v_lshrrev_b32 v14, 2, v12
    v_and_b32 v14, 2, v14
    v_sub_u32 v13, v13, v14
    v_med3_i32 v13, v13, 0, 9
    v_lshlrev_b32 v13, 4, v13
    v_lshlrev_b32 v12, 12, v12
    v_add_u32 v12, v12, v13
    v_add_u32 v6, s35, v12
    s_branch A1L1_SD
A1L1_SC:
    v_lshrrev_b32 v11, 2, v2
    v_lshlrev_b32 v12, 3, v3
    v_add_u32 v12, v12, v11
    v_and_b32 v14, 3, v1
    v_lshlrev_b32 v14, 3, v14
    v_and_b32 v13, 1, v3
    v_mul_u32_u24 v15, 192, v12
    v_lshlrev_b32 v16, 5, v13
    v_add_u32 v15, v15, v16
    v_add_u32 v4, v15, v14
    v_lshlrev_b32 v12, 7, v12
    v_lshrrev_b32 v11, 1, v11
    v_lshlrev_b32 v13, 1, v13
    v_or_b32 v11, v11, v13
    v_xor_b32 v11, s30, v11
    v_lshlrev_b32 v11, 5, v11
    v_add_u32 v12, v12, v11
    v_add_u32 v12, v12, v14
    v_add_u32 v6, 49152, v12
    v_and_b32 v11, 1, v2
    v_cmp_eq_u32 s[48:49], 1, v11
    v_and_b32 v12, 2, v2
    v_cmp_eq_u32 s[50:51], 2, v12
    v_lshrrev_b32 v12, 2, v2
    v_cmp_eq_u32 s[52:53], v12, v3
    v_cmp_eq_u32 s[54:55], 0, v2
    v_lshlrev_b32 v13, 2, v3
    v_add_u32 v13, v13, v11
    v_cmp_le_u32 s[56:57], v13, v2
    v_add_u32 v13, 2, v13
    v_cmp_le_u32 s[58:59], v13, v2
    v_mov_b32 v16, 0xffff
    v_mov_b32 v17, 0xffff0000
    v_cndmask_b32 v16, v16, v17, s[48:49]
    v_mov_b32 v17, 0
    v_cndmask_b32 v160, v17, v16, s[56:57]
    v_cndmask_b32 v161, v16, v17, s[56:57]
    v_cndmask_b32 v162, v17, v16, s[58:59]
    v_cndmask_b32 v163, v16, v17, s[58:59]
    v_lshlrev_b32 v11, 2, v2
    v_lshlrev_b32 v12, 4, v3
    v_add_u32 v164, 147712, v11
    v_add_u32 v166, 147712, v12
    v_mov_b32 v174, 0xbb000000
    v_mov_b32 v175, 0x3b000000
    s_mul_i32 s35, s30, 192
    s_add_u32 s35, s35, 148352
    v_add_u32 v168, s35, v12
    s_add_u32 s35, s35, 128
    v_add_u32 v169, s35, v11
    v_mul_u32_u24 v13, 144, v2
    v_lshlrev_b32 v14, 3, v3
    v_add_u32 v13, v13, v14
    s_lshl_b32 s35, s30, 5
    s_add_u32 s35, s35, 0
    v_add_u32 v167, s35, v13
    s_mov_b32 s61, 0x3eb8aa3b
    s_mov_b32 s62, 0xbb000000
    s_mov_b32 s63, 0x3b000000
    v_mov_b32 v173, 0x3727c5ac
    v_mov_b32 v20, 0x3f803f80
    v_mov_b32 v21, 0x3f803f80
    v_mov_b32 v22, 0x3f803f80
    v_mov_b32 v23, 0x3f803f80
    v_mov_b32 v24, 0
    v_mov_b32 v25, 0
    v_mov_b32 v26, 0
    v_mov_b32 v27, 0
    v_mov_b32 v28, 0
    v_mov_b32 v29, 0
    v_mov_b32 v30, 0
    v_mov_b32 v31, 0
    v_mov_b32 v32, 0
    v_mov_b32 v33, 0
    v_mov_b32 v34, 0
    v_mov_b32 v35, 0
    v_mov_b32 v36, 0
    v_mov_b32 v37, 0
    v_mov_b32 v38, 0
    v_mov_b32 v39, 0
    v_mov_b32 v40, 0
    v_mov_b32 v41, 0
    v_mov_b32 v42, 0
    v_mov_b32 v43, 0
    v_mov_b32 v44, 0
    v_mov_b32 v45, 0
    v_mov_b32 v46, 0
    v_mov_b32 v47, 0
    v_mov_b32 v48, 0
    v_mov_b32 v49, 0
    v_mov_b32 v50, 0
    v_mov_b32 v51, 0
    v_mov_b32 v52, 0
    v_mov_b32 v53, 0
    v_mov_b32 v54, 0
    v_mov_b32 v55, 0
    v_mov_b32 v56, 0
    v_mov_b32 v57, 0
    v_mov_b32 v58, 0
    v_mov_b32 v59, 0
    v_mov_b32 v60, 0
    v_mov_b32 v61, 0
    v_mov_b32 v62, 0
    v_mov_b32 v63, 0
    v_mov_b32 v64, 0
    v_mov_b32 v65, 0
    v_mov_b32 v66, 0
    v_mov_b32 v67, 0
    v_mov_b32 v68, 0
    v_mov_b32 v69, 0
    v_mov_b32 v70, 0
    v_mov_b32 v71, 0
    v_mov_b32 v72, 0
    v_mov_b32 v73, 0
    v_mov_b32 v74, 0
    v_mov_b32 v75, 0
    v_mov_b32 v76, 0
    v_mov_b32 v77, 0
    v_mov_b32 v78, 0
    v_mov_b32 v79, 0
    v_mov_b32 v80, 0
    v_mov_b32 v81, 0
    v_mov_b32 v82, 0
    v_mov_b32 v83, 0
    v_mov_b32 v84, 0
    v_mov_b32 v85, 0
    v_mov_b32 v86, 0
    v_mov_b32 v87, 0
    v_mov_b32 v88, 0
    v_mov_b32 v89, 0
    v_mov_b32 v90, 0
    v_mov_b32 v91, 0
    v_mov_b32 v92, 0
    v_mov_b32 v93, 0
    v_mov_b32 v94, 0
    v_mov_b32 v95, 0
A1L1_SD:
    v_lshrrev_b32 v13, 3, v1
    s_lshl_b32 s35, s28, 3
    v_add_u32 v13, s35, v13
    v_and_b32 v14, 7, v1
    v_lshlrev_b32 v14, 4, v14
    v_mul_u32_u24 v15, 144, v13
    v_add_u32 v15, v15, v14
    v_add_u32 v170, 0, v15
    v_lshlrev_b32 v13, 10, v13
    v_add_u32 v171, v13, v14
    s_lshl_b32 s36, s31, 16
    s_lshl_b32 s35, s32, 7
    s_add_u32 s36, s36, s35
    s_add_u32 s20, s8, 6815744
    s_addc_u32 s21, s9, 0
    s_mov_b32 s22, 2097152
    s_mov_b32 s23, 0x20000
    v_lshrrev_b32 v11, 3, v1
    v_lshlrev_b32 v11, 10, v11
    v_and_b32 v12, 1, v3
    v_lshrrev_b32 v13, 1, v1
    v_and_b32 v13, 3, v13
    v_xor_b32 v13, v13, v12
    v_lshlrev_b32 v13, 5, v13
    v_and_b32 v14, 1, v1
    v_lshlrev_b32 v14, 4, v14
    v_add_u32 v11, v11, v14
    s_lshl_b32 s35, s32, 7
    v_add_u32 v11, s35, v11
    v_add_u32 v224, v11, v13
    v_xor_b32 v13, 64, v13
    v_add_u32 v11, 8192, v11
    v_add_u32 v225, v11, v13
    s_mov_b32 s24, s64
    s_mov_b32 s25, s65
    s_mov_b32 s26, 524288
    s_mov_b32 s27, 0x20000
    s_add_u32 s12, s8, 11010048
    s_addc_u32 s13, s9, 0
    s_mov_b32 s14, 2097152
    s_mov_b32 s15, 0x20000
    s_mov_b32 s16, s6
    s_mov_b32 s17, s7
    s_mov_b32 s18, 1572864
    s_mov_b32 s19, 0x20000
    s_mov_b32 s82, 65536
    s_cmp_lg_u32 s28, 0
    s_cbranch_scc1 H3W_D
    s_sleep 8
    v_lshlrev_b32 v250, 7, v1
    v_add_u32 v250, s82, v250
    v_add_u32 v251, 8192, v250
    v_add_u32 v252, 16384, v250
    v_add_u32 v253, 24576, v250
    s_mov_b32 s90, 0
H3W_P:
    buffer_load_dword v246, v250, s[72:75], 0 offen sc1
    buffer_load_dword v247, v251, s[72:75], 0 offen sc1
    buffer_load_dword v248, v252, s[72:75], 0 offen sc1
    buffer_load_dword v249, v253, s[72:75], 0 offen sc1
    s_waitcnt vmcnt(0)
    v_cmp_eq_u32 vcc, s34, v246
    v_cmp_eq_u32 s[84:85], s34, v247
    v_cmp_eq_u32 s[86:87], s34, v248
    v_cmp_eq_u32 s[88:89], s34, v249
    s_and_b64 s[84:85], s[84:85], s[86:87]
    s_and_b64 vcc, vcc, s[88:89]
    s_and_b64 vcc, vcc, s[84:85]
    s_nop 0
    s_cmp_eq_u64 vcc, exec
    s_cbranch_scc1 H3W_X
    s_sleep 2
    s_add_u32 s90, s90, 1
    s_cmp_lt_u32 s90, 200000
    s_cbranch_scc1 H3W_P
H3W_X:
    s_mov_b64 exec, -1
H3W_D:
    s_barrier
A1L1_BEGIN:
    s_cmp_lt_u32 s28, 4
    s_cbranch_scc1 A1L1_C
    s_cmp_eq_u32 s28, 5
    s_cbranch_scc1 A1L1_L1
    s_cmp_eq_u32 s28, 6
    s_cbranch_scc1 A1L1_L2
    s_cmp_eq_u32 s28, 7
    s_cbranch_scc1 A1L1_L3
A1L1_L0:
    s_mov_b32 m0, 0
    s_mov_b32 s44, 0
    buffer_load_dwordx4 v4, s[12:15], s44 offen sc1 lds
    s_mov_b32 m0, 1024
    s_mov_b32 s44, 0
    buffer_load_dwordx4 v5, s[12:15], s44 offen sc1 lds
    s_mov_b32 m0, 2048
    s_mov_b32 s44, 0
    buffer_load_dwordx4 v6, s[12:15], s44 offen sc1 lds
    s_mov_b32 m0, 12288
    s_mov_b32 s44, 262144
    buffer_load_dwordx4 v4, s[12:15], s44 offen sc1 lds
    s_mov_b32 m0, 13312
    s_mov_b32 s44, 262144
    buffer_load_dwordx4 v5, s[12:15], s44 offen sc1 lds
    s_mov_b32 m0, 14336
    s_mov_b32 s44, 262144
    buffer_load_dwordx4 v6, s[12:15], s44 offen sc1 lds
    s_waitcnt vmcnt(3)
    s_barrier
    s_mov_b32 m0, 24576
    s_mov_b32 s44, 524288
    buffer_load_dwordx4 v4, s[12:15], s44 offen sc1 lds
    s_mov_b32 m0, 25600
    s_mov_b32 s44, 524288
    buffer_load_dwordx4 v5, s[12:15], s44 offen sc1 lds
    s_mov_b32 m0, 26624
    s_mov_b32 s44, 524288
    buffer_load_dwordx4 v6, s[12:15], s44 offen sc1 lds
    s_mov_b32 m0, 36864
    s_mov_b32 s44, 786432
    buffer_load_dwordx4 v4, s[12:15], s44 offen sc1 lds
    s_mov_b32 m0, 37888
    s_mov_b32 s44, 786432
    buffer_load_dwordx4 v5, s[12:15], s44 offen sc1 lds
    s_mov_b32 m0, 38912
    s_mov_b32 s44, 786432
    buffer_load_dwordx4 v6, s[12:15], s44 offen sc1 lds
    s_waitcnt vmcnt(6)
    s_barrier
    s_mov_b32 m0, 0
    s_mov_b32 s44, 1048576
    buffer_load_dwordx4 v4, s[12:15], s44 offen sc1 lds
    s_mov_b32 m0, 1024
    s_mov_b32 s44, 1048576
    buffer_load_dwordx4 v5, s[12:15], s44 offen sc1 lds
    s_mov_b32 m0, 2048
    s_mov_b32 s44, 1048576
    buffer_load_dwordx4 v6, s[12:15], s44 offen sc1 lds
    s_mov_b32 m0, 49152
    s_mov_b32 s45, 786432
    buffer_load_dwordx4 v7, s[16:19], s45 offen lds
    s_mov_b32 m0, 50176
    s_mov_b32 s45, 811008
    buffer_load_dwordx4 v8, s[16:19], s45 offen lds
    s_mov_b32 m0, 57344
    s_mov_b32 s45, 787456
    buffer_load_dwordx4 v7, s[16:19], s45 offen lds
    s_mov_b32 m0, 58368
    s_mov_b32 s45, 812032
    buffer_load_dwordx4 v8, s[16:19], s45 offen lds
    s_mov_b32 m0, 65536
    s_mov_b32 s45, 788480
    buffer_load_dwordx4 v7, s[16:19], s45 offen lds
    s_mov_b32 m0, 66560
    s_mov_b32 s45, 813056
    buffer_load_dwordx4 v8, s[16:19], s45 offen lds
    s_waitcnt vmcnt(12)
    s_barrier
    s_mov_b32 m0, 12288
    s_mov_b32 s44, 1310720
    buffer_load_dwordx4 v4, s[12:15], s44 offen sc1 lds
    s_mov_b32 m0, 13312
    s_mov_b32 s44, 1310720
    buffer_load_dwordx4 v5, s[12:15], s44 offen sc1 lds
    s_mov_b32 m0, 14336
    s_mov_b32 s44, 1310720
    buffer_load_dwordx4 v6, s[12:15], s44 offen sc1 lds
    s_mov_b32 m0, 73728
    s_mov_b32 s45, 983040
    buffer_load_dwordx4 v7, s[16:19], s45 offen lds
    s_mov_b32 m0, 74752
    s_mov_b32 s45, 1007616
    buffer_load_dwordx4 v8, s[16:19], s45 offen lds
    s_mov_b32 m0, 81920
    s_mov_b32 s45, 984064
    buffer_load_dwordx4 v7, s[16:19], s45 offen lds
    s_mov_b32 m0, 82944
    s_mov_b32 s45, 1008640
    buffer_load_dwordx4 v8, s[16:19], s45 offen lds
    s_mov_b32 m0, 90112
    s_mov_b32 s45, 985088
    buffer_load_dwordx4 v7, s[16:19], s45 offen lds
    s_mov_b32 m0, 91136
    s_mov_b32 s45, 1009664
    buffer_load_dwordx4 v8, s[16:19], s45 offen lds
    s_waitcnt vmcnt(18)
    s_barrier
    s_mov_b32 m0, 24576
    s_mov_b32 s44, 1572864
    buffer_load_dwordx4 v4, s[12:15], s44 offen sc1 lds
    s_mov_b32 m0, 25600
    s_mov_b32 s44, 1572864
    buffer_load_dwordx4 v5, s[12:15], s44 offen sc1 lds
    s_mov_b32 m0, 26624
    s_mov_b32 s44, 1572864
    buffer_load_dwordx4 v6, s[12:15], s44 offen sc1 lds
    s_mov_b32 m0, 98304
    s_mov_b32 s45, 1179648
    buffer_load_dwordx4 v7, s[16:19], s45 offen lds
    s_mov_b32 m0, 99328
    s_mov_b32 s45, 1204224
    buffer_load_dwordx4 v8, s[16:19], s45 offen lds
    s_mov_b32 m0, 106496
    s_mov_b32 s45, 1180672
    buffer_load_dwordx4 v7, s[16:19], s45 offen lds
    s_mov_b32 m0, 107520
    s_mov_b32 s45, 1205248
    buffer_load_dwordx4 v8, s[16:19], s45 offen lds
    s_mov_b32 m0, 114688
    s_mov_b32 s45, 1181696
    buffer_load_dwordx4 v7, s[16:19], s45 offen lds
    s_mov_b32 m0, 115712
    s_mov_b32 s45, 1206272
    buffer_load_dwordx4 v8, s[16:19], s45 offen lds
    s_waitcnt vmcnt(18)
    s_barrier
    s_mov_b32 m0, 36864
    s_mov_b32 s44, 1835008
    buffer_load_dwordx4 v4, s[12:15], s44 offen sc1 lds
    s_mov_b32 m0, 37888
    s_mov_b32 s44, 1835008
    buffer_load_dwordx4 v5, s[12:15], s44 offen sc1 lds
    s_mov_b32 m0, 38912
    s_mov_b32 s44, 1835008
    buffer_load_dwordx4 v6, s[12:15], s44 offen sc1 lds
    s_mov_b32 m0, 122880
    s_mov_b32 s45, 1376256
    buffer_load_dwordx4 v7, s[16:19], s45 offen lds
    s_mov_b32 m0, 123904
    s_mov_b32 s45, 1400832
    buffer_load_dwordx4 v8, s[16:19], s45 offen lds
    s_mov_b32 m0, 131072
    s_mov_b32 s45, 1377280
    buffer_load_dwordx4 v7, s[16:19], s45 offen lds
    s_mov_b32 m0, 132096
    s_mov_b32 s45, 1401856
    buffer_load_dwordx4 v8, s[16:19], s45 offen lds
    s_mov_b32 m0, 139264
    s_mov_b32 s45, 1378304
    buffer_load_dwordx4 v7, s[16:19], s45 offen lds
    s_mov_b32 m0, 140288
    s_mov_b32 s45, 1402880
    buffer_load_dwordx4 v8, s[16:19], s45 offen lds
    s_waitcnt vmcnt(18)
    s_barrier
    s_waitcnt vmcnt(9)
    s_barrier
    s_waitcnt vmcnt(0)
    s_barrier
    s_barrier
    s_lshl_b32 s95, s31, 16
    s_mov_b32 m0, 49152
    s_mov_b32 s78, 0
    buffer_load_dwordx4 v224, s[24:27], s78 offen lds
    s_mov_b32 m0, 50176
    s_mov_b32 s78, 0
    buffer_load_dwordx4 v225, s[24:27], s78 offen lds
    s_mov_b32 m0, 65536
    s_mov_b32 s78, 131072
    buffer_load_dwordx4 v224, s[24:27], s78 offen lds
    s_mov_b32 m0, 66560
    s_mov_b32 s78, 131072
    buffer_load_dwordx4 v225, s[24:27], s78 offen lds
    s_mov_b32 m0, 81920
    s_mov_b32 s78, 262144
    buffer_load_dwordx4 v224, s[24:27], s78 offen lds
    s_mov_b32 m0, 82944
    s_mov_b32 s78, 262144
    buffer_load_dwordx4 v225, s[24:27], s78 offen lds
    s_mov_b32 m0, 98304
    s_mov_b32 s78, 393216
    buffer_load_dwordx4 v224, s[24:27], s78 offen lds
    s_mov_b32 m0, 99328
    s_mov_b32 s78, 393216
    buffer_load_dwordx4 v225, s[24:27], s78 offen lds
    s_mov_b32 m0, 51200
    s_mov_b32 s78, 16384
    buffer_load_dwordx4 v224, s[24:27], s78 offen lds
    s_mov_b32 m0, 52224
    s_mov_b32 s78, 16384
    buffer_load_dwordx4 v225, s[24:27], s78 offen lds
    s_mov_b32 m0, 67584
    s_mov_b32 s78, 147456
    buffer_load_dwordx4 v224, s[24:27], s78 offen lds
    s_mov_b32 m0, 68608
    s_mov_b32 s78, 147456
    buffer_load_dwordx4 v225, s[24:27], s78 offen lds
    s_mov_b32 m0, 83968
    s_mov_b32 s78, 278528
    buffer_load_dwordx4 v224, s[24:27], s78 offen lds
    s_mov_b32 m0, 84992
    s_mov_b32 s78, 278528
    buffer_load_dwordx4 v225, s[24:27], s78 offen lds
    s_mov_b32 m0, 100352
    s_mov_b32 s78, 409600
    buffer_load_dwordx4 v224, s[24:27], s78 offen lds
    s_mov_b32 m0, 101376
    s_mov_b32 s78, 409600
    buffer_load_dwordx4 v225, s[24:27], s78 offen lds
    s_barrier
    s_branch A1L1_ST
A1L1_L1:
    s_mov_b32 m0, 3072
    s_mov_b32 s44, 0
    buffer_load_dwordx4 v4, s[12:15], s44 offen sc1 lds
    s_mov_b32 m0, 4096
    s_mov_b32 s44, 0
    buffer_load_dwordx4 v5, s[12:15], s44 offen sc1 lds
    s_mov_b32 m0, 5120
    s_mov_b32 s44, 0
    buffer_load_dwordx4 v6, s[12:15], s44 offen sc1 lds
    s_mov_b32 m0, 15360
    s_mov_b32 s44, 262144
    buffer_load_dwordx4 v4, s[12:15], s44 offen sc1 lds
    s_mov_b32 m0, 16384
    s_mov_b32 s44, 262144
    buffer_load_dwordx4 v5, s[12:15], s44 offen sc1 lds
    s_mov_b32 m0, 17408
    s_mov_b32 s44, 262144
    buffer_load_dwordx4 v6, s[12:15], s44 offen sc1 lds
    s_waitcnt vmcnt(3)
    s_barrier
    s_mov_b32 m0, 27648
    s_mov_b32 s44, 524288
    buffer_load_dwordx4 v4, s[12:15], s44 offen sc1 lds
    s_mov_b32 m0, 28672
    s_mov_b32 s44, 524288
    buffer_load_dwordx4 v5, s[12:15], s44 offen sc1 lds
    s_mov_b32 m0, 29696
    s_mov_b32 s44, 524288
    buffer_load_dwordx4 v6, s[12:15], s44 offen sc1 lds
    s_mov_b32 m0, 39936
    s_mov_b32 s44, 786432
    buffer_load_dwordx4 v4, s[12:15], s44 offen sc1 lds
    s_mov_b32 m0, 40960
    s_mov_b32 s44, 786432
    buffer_load_dwordx4 v5, s[12:15], s44 offen sc1 lds
    s_mov_b32 m0, 41984
    s_mov_b32 s44, 786432
    buffer_load_dwordx4 v6, s[12:15], s44 offen sc1 lds
    s_waitcnt vmcnt(6)
    s_barrier
    s_mov_b32 m0, 3072
    s_mov_b32 s44, 1048576
    buffer_load_dwordx4 v4, s[12:15], s44 offen sc1 lds
    s_mov_b32 m0, 4096
    s_mov_b32 s44, 1048576
    buffer_load_dwordx4 v5, s[12:15], s44 offen sc1 lds
    s_mov_b32 m0, 5120
    s_mov_b32 s44, 1048576
    buffer_load_dwordx4 v6, s[12:15], s44 offen sc1 lds
    s_mov_b32 m0, 51200
    s_mov_b32 s45, 835584
    buffer_load_dwordx4 v7, s[16:19], s45 offen lds
    s_mov_b32 m0, 52224
    s_mov_b32 s45, 860160
    buffer_load_dwordx4 v8, s[16:19], s45 offen lds
    s_mov_b32 m0, 59392
    s_mov_b32 s45, 836608
    buffer_load_dwordx4 v7, s[16:19], s45 offen lds
    s_mov_b32 m0, 60416
    s_mov_b32 s45, 861184
    buffer_load_dwordx4 v8, s[16:19], s45 offen lds
    s_mov_b32 m0, 67584
    s_mov_b32 s45, 837632
    buffer_load_dwordx4 v7, s[16:19], s45 offen lds
    s_mov_b32 m0, 68608
    s_mov_b32 s45, 862208
    buffer_load_dwordx4 v8, s[16:19], s45 offen lds
    s_waitcnt vmcnt(12)
    s_barrier
    s_mov_b32 m0, 15360
    s_mov_b32 s44, 1310720
    buffer_load_dwordx4 v4, s[12:15], s44 offen sc1 lds
    s_mov_b32 m0, 16384
    s_mov_b32 s44, 1310720
    buffer_load_dwordx4 v5, s[12:15], s44 offen sc1 lds
    s_mov_b32 m0, 17408
    s_mov_b32 s44, 1310720
    buffer_load_dwordx4 v6, s[12:15], s44 offen sc1 lds
    s_mov_b32 m0, 75776
    s_mov_b32 s45, 1032192
    buffer_load_dwordx4 v7, s[16:19], s45 offen lds
    s_mov_b32 m0, 76800
    s_mov_b32 s45, 1056768
    buffer_load_dwordx4 v8, s[16:19], s45 offen lds
    s_mov_b32 m0, 83968
    s_mov_b32 s45, 1033216
    buffer_load_dwordx4 v7, s[16:19], s45 offen lds
    s_mov_b32 m0, 84992
    s_mov_b32 s45, 1057792
    buffer_load_dwordx4 v8, s[16:19], s45 offen lds
    s_mov_b32 m0, 92160
    s_mov_b32 s45, 1034240
    buffer_load_dwordx4 v7, s[16:19], s45 offen lds
    s_mov_b32 m0, 93184
    s_mov_b32 s45, 1058816
    buffer_load_dwordx4 v8, s[16:19], s45 offen lds
    s_waitcnt vmcnt(18)
    s_barrier
    s_mov_b32 m0, 27648
    s_mov_b32 s44, 1572864
    buffer_load_dwordx4 v4, s[12:15], s44 offen sc1 lds
    s_mov_b32 m0, 28672
    s_mov_b32 s44, 1572864
    buffer_load_dwordx4 v5, s[12:15], s44 offen sc1 lds
    s_mov_b32 m0, 29696
    s_mov_b32 s44, 1572864
    buffer_load_dwordx4 v6, s[12:15], s44 offen sc1 lds
    s_mov_b32 m0, 100352
    s_mov_b32 s45, 1228800
    buffer_load_dwordx4 v7, s[16:19], s45 offen lds
    s_mov_b32 m0, 101376
    s_mov_b32 s45, 1253376
    buffer_load_dwordx4 v8, s[16:19], s45 offen lds
    s_mov_b32 m0, 108544
    s_mov_b32 s45, 1229824
    buffer_load_dwordx4 v7, s[16:19], s45 offen lds
    s_mov_b32 m0, 109568
    s_mov_b32 s45, 1254400
    buffer_load_dwordx4 v8, s[16:19], s45 offen lds
    s_mov_b32 m0, 116736
    s_mov_b32 s45, 1230848
    buffer_load_dwordx4 v7, s[16:19], s45 offen lds
    s_mov_b32 m0, 117760
    s_mov_b32 s45, 1255424
    buffer_load_dwordx4 v8, s[16:19], s45 offen lds
    s_waitcnt vmcnt(18)
    s_barrier
    s_mov_b32 m0, 39936
    s_mov_b32 s44, 1835008
    buffer_load_dwordx4 v4, s[12:15], s44 offen sc1 lds
    s_mov_b32 m0, 40960
    s_mov_b32 s44, 1835008
    buffer_load_dwordx4 v5, s[12:15], s44 offen sc1 lds
    s_mov_b32 m0, 41984
    s_mov_b32 s44, 1835008
    buffer_load_dwordx4 v6, s[12:15], s44 offen sc1 lds
    s_mov_b32 m0, 124928
    s_mov_b32 s45, 1425408
    buffer_load_dwordx4 v7, s[16:19], s45 offen lds
    s_mov_b32 m0, 125952
    s_mov_b32 s45, 1449984
    buffer_load_dwordx4 v8, s[16:19], s45 offen lds
    s_mov_b32 m0, 133120
    s_mov_b32 s45, 1426432
    buffer_load_dwordx4 v7, s[16:19], s45 offen lds
    s_mov_b32 m0, 134144
    s_mov_b32 s45, 1451008
    buffer_load_dwordx4 v8, s[16:19], s45 offen lds
    s_mov_b32 m0, 141312
    s_mov_b32 s45, 1427456
    buffer_load_dwordx4 v7, s[16:19], s45 offen lds
    s_mov_b32 m0, 142336
    s_mov_b32 s45, 1452032
    buffer_load_dwordx4 v8, s[16:19], s45 offen lds
    s_waitcnt vmcnt(18)
    s_barrier
    s_waitcnt vmcnt(9)
    s_barrier
    s_waitcnt vmcnt(0)
    s_barrier
    s_barrier
    s_mov_b32 m0, 53248
    s_mov_b32 s78, 32768
    buffer_load_dwordx4 v224, s[24:27], s78 offen lds
    s_mov_b32 m0, 54272
    s_mov_b32 s78, 32768
    buffer_load_dwordx4 v225, s[24:27], s78 offen lds
    s_mov_b32 m0, 69632
    s_mov_b32 s78, 163840
    buffer_load_dwordx4 v224, s[24:27], s78 offen lds
    s_mov_b32 m0, 70656
    s_mov_b32 s78, 163840
    buffer_load_dwordx4 v225, s[24:27], s78 offen lds
    s_mov_b32 m0, 86016
    s_mov_b32 s78, 294912
    buffer_load_dwordx4 v224, s[24:27], s78 offen lds
    s_mov_b32 m0, 87040
    s_mov_b32 s78, 294912
    buffer_load_dwordx4 v225, s[24:27], s78 offen lds
    s_mov_b32 m0, 102400
    s_mov_b32 s78, 425984
    buffer_load_dwordx4 v224, s[24:27], s78 offen lds
    s_mov_b32 m0, 103424
    s_mov_b32 s78, 425984
    buffer_load_dwordx4 v225, s[24:27], s78 offen lds
    s_mov_b32 m0, 55296
    s_mov_b32 s78, 49152
    buffer_load_dwordx4 v224, s[24:27], s78 offen lds
    s_mov_b32 m0, 56320
    s_mov_b32 s78, 49152
    buffer_load_dwordx4 v225, s[24:27], s78 offen lds
    s_mov_b32 m0, 71680
    s_mov_b32 s78, 180224
    buffer_load_dwordx4 v224, s[24:27], s78 offen lds
    s_mov_b32 m0, 72704
    s_mov_b32 s78, 180224
    buffer_load_dwordx4 v225, s[24:27], s78 offen lds
    s_mov_b32 m0, 88064
    s_mov_b32 s78, 311296
    buffer_load_dwordx4 v224, s[24:27], s78 offen lds
    s_mov_b32 m0, 89088
    s_mov_b32 s78, 311296
    buffer_load_dwordx4 v225, s[24:27], s78 offen lds
    s_mov_b32 m0, 104448
    s_mov_b32 s78, 442368
    buffer_load_dwordx4 v224, s[24:27], s78 offen lds
    s_mov_b32 m0, 105472
    s_mov_b32 s78, 442368
    buffer_load_dwordx4 v225, s[24:27], s78 offen lds
    s_barrier
    s_branch A1L1_ST
A1L1_L2:
    s_mov_b32 m0, 6144
    s_mov_b32 s44, 0
    buffer_load_dwordx4 v4, s[12:15], s44 offen sc1 lds
    s_mov_b32 m0, 7168
    s_mov_b32 s44, 0
    buffer_load_dwordx4 v5, s[12:15], s44 offen sc1 lds
    s_mov_b32 m0, 8192
    s_mov_b32 s44, 0
    buffer_load_dwordx4 v6, s[12:15], s44 offen sc1 lds
    s_mov_b32 m0, 18432
    s_mov_b32 s44, 262144
    buffer_load_dwordx4 v4, s[12:15], s44 offen sc1 lds
    s_mov_b32 m0, 19456
    s_mov_b32 s44, 262144
    buffer_load_dwordx4 v5, s[12:15], s44 offen sc1 lds
    s_mov_b32 m0, 20480
    s_mov_b32 s44, 262144
    buffer_load_dwordx4 v6, s[12:15], s44 offen sc1 lds
    s_waitcnt vmcnt(3)
    s_barrier
    s_mov_b32 m0, 30720
    s_mov_b32 s44, 524288
    buffer_load_dwordx4 v4, s[12:15], s44 offen sc1 lds
    s_mov_b32 m0, 31744
    s_mov_b32 s44, 524288
    buffer_load_dwordx4 v5, s[12:15], s44 offen sc1 lds
    s_mov_b32 m0, 32768
    s_mov_b32 s44, 524288
    buffer_load_dwordx4 v6, s[12:15], s44 offen sc1 lds
    s_mov_b32 m0, 43008
    s_mov_b32 s44, 786432
    buffer_load_dwordx4 v4, s[12:15], s44 offen sc1 lds
    s_mov_b32 m0, 44032
    s_mov_b32 s44, 786432
    buffer_load_dwordx4 v5, s[12:15], s44 offen sc1 lds
    s_mov_b32 m0, 45056
    s_mov_b32 s44, 786432
    buffer_load_dwordx4 v6, s[12:15], s44 offen sc1 lds
    s_waitcnt vmcnt(6)
    s_barrier
    s_mov_b32 m0, 6144
    s_mov_b32 s44, 1048576
    buffer_load_dwordx4 v4, s[12:15], s44 offen sc1 lds
    s_mov_b32 m0, 7168
    s_mov_b32 s44, 1048576
    buffer_load_dwordx4 v5, s[12:15], s44 offen sc1 lds
    s_mov_b32 m0, 8192
    s_mov_b32 s44, 1048576
    buffer_load_dwordx4 v6, s[12:15], s44 offen sc1 lds
    s_mov_b32 m0, 53248
    s_mov_b32 s45, 884736
    buffer_load_dwordx4 v7, s[16:19], s45 offen lds
    s_mov_b32 m0, 54272
    s_mov_b32 s45, 909312
    buffer_load_dwordx4 v8, s[16:19], s45 offen lds
    s_mov_b32 m0, 61440
    s_mov_b32 s45, 885760
    buffer_load_dwordx4 v7, s[16:19], s45 offen lds
    s_mov_b32 m0, 62464
    s_mov_b32 s45, 910336
    buffer_load_dwordx4 v8, s[16:19], s45 offen lds
    s_mov_b32 m0, 69632
    s_mov_b32 s45, 886784
    buffer_load_dwordx4 v7, s[16:19], s45 offen lds
    s_mov_b32 m0, 70656
    s_mov_b32 s45, 911360
    buffer_load_dwordx4 v8, s[16:19], s45 offen lds
    s_waitcnt vmcnt(12)
    s_barrier
    s_mov_b32 m0, 18432
    s_mov_b32 s44, 1310720
    buffer_load_dwordx4 v4, s[12:15], s44 offen sc1 lds
    s_mov_b32 m0, 19456
    s_mov_b32 s44, 1310720
    buffer_load_dwordx4 v5, s[12:15], s44 offen sc1 lds
    s_mov_b32 m0, 20480
    s_mov_b32 s44, 1310720
    buffer_load_dwordx4 v6, s[12:15], s44 offen sc1 lds
    s_mov_b32 m0, 77824
    s_mov_b32 s45, 1081344
    buffer_load_dwordx4 v7, s[16:19], s45 offen lds
    s_mov_b32 m0, 78848
    s_mov_b32 s45, 1105920
    buffer_load_dwordx4 v8, s[16:19], s45 offen lds
    s_mov_b32 m0, 86016
    s_mov_b32 s45, 1082368
    buffer_load_dwordx4 v7, s[16:19], s45 offen lds
    s_mov_b32 m0, 87040
    s_mov_b32 s45, 1106944
    buffer_load_dwordx4 v8, s[16:19], s45 offen lds
    s_mov_b32 m0, 94208
    s_mov_b32 s45, 1083392
    buffer_load_dwordx4 v7, s[16:19], s45 offen lds
    s_mov_b32 m0, 95232
    s_mov_b32 s45, 1107968
    buffer_load_dwordx4 v8, s[16:19], s45 offen lds
    s_waitcnt vmcnt(18)
    s_barrier
    s_mov_b32 m0, 30720
    s_mov_b32 s44, 1572864
    buffer_load_dwordx4 v4, s[12:15], s44 offen sc1 lds
    s_mov_b32 m0, 31744
    s_mov_b32 s44, 1572864
    buffer_load_dwordx4 v5, s[12:15], s44 offen sc1 lds
    s_mov_b32 m0, 32768
    s_mov_b32 s44, 1572864
    buffer_load_dwordx4 v6, s[12:15], s44 offen sc1 lds
    s_mov_b32 m0, 102400
    s_mov_b32 s45, 1277952
    buffer_load_dwordx4 v7, s[16:19], s45 offen lds
    s_mov_b32 m0, 103424
    s_mov_b32 s45, 1302528
    buffer_load_dwordx4 v8, s[16:19], s45 offen lds
    s_mov_b32 m0, 110592
    s_mov_b32 s45, 1278976
    buffer_load_dwordx4 v7, s[16:19], s45 offen lds
    s_mov_b32 m0, 111616
    s_mov_b32 s45, 1303552
    buffer_load_dwordx4 v8, s[16:19], s45 offen lds
    s_mov_b32 m0, 118784
    s_mov_b32 s45, 1280000
    buffer_load_dwordx4 v7, s[16:19], s45 offen lds
    s_mov_b32 m0, 119808
    s_mov_b32 s45, 1304576
    buffer_load_dwordx4 v8, s[16:19], s45 offen lds
    s_waitcnt vmcnt(18)
    s_barrier
    s_mov_b32 m0, 43008
    s_mov_b32 s44, 1835008
    buffer_load_dwordx4 v4, s[12:15], s44 offen sc1 lds
    s_mov_b32 m0, 44032
    s_mov_b32 s44, 1835008
    buffer_load_dwordx4 v5, s[12:15], s44 offen sc1 lds
    s_mov_b32 m0, 45056
    s_mov_b32 s44, 1835008
    buffer_load_dwordx4 v6, s[12:15], s44 offen sc1 lds
    s_mov_b32 m0, 126976
    s_mov_b32 s45, 1474560
    buffer_load_dwordx4 v7, s[16:19], s45 offen lds
    s_mov_b32 m0, 128000
    s_mov_b32 s45, 1499136
    buffer_load_dwordx4 v8, s[16:19], s45 offen lds
    s_mov_b32 m0, 135168
    s_mov_b32 s45, 1475584
    buffer_load_dwordx4 v7, s[16:19], s45 offen lds
    s_mov_b32 m0, 136192
    s_mov_b32 s45, 1500160
    buffer_load_dwordx4 v8, s[16:19], s45 offen lds
    s_mov_b32 m0, 143360
    s_mov_b32 s45, 1476608
    buffer_load_dwordx4 v7, s[16:19], s45 offen lds
    s_mov_b32 m0, 144384
    s_mov_b32 s45, 1501184
    buffer_load_dwordx4 v8, s[16:19], s45 offen lds
    s_waitcnt vmcnt(18)
    s_barrier
    s_waitcnt vmcnt(9)
    s_barrier
    s_waitcnt vmcnt(0)
    s_barrier
    s_barrier
    s_mov_b32 m0, 57344
    s_mov_b32 s78, 65536
    buffer_load_dwordx4 v224, s[24:27], s78 offen lds
    s_mov_b32 m0, 58368
    s_mov_b32 s78, 65536
    buffer_load_dwordx4 v225, s[24:27], s78 offen lds
    s_mov_b32 m0, 73728
    s_mov_b32 s78, 196608
    buffer_load_dwordx4 v224, s[24:27], s78 offen lds
    s_mov_b32 m0, 74752
    s_mov_b32 s78, 196608
    buffer_load_dwordx4 v225, s[24:27], s78 offen lds
    s_mov_b32 m0, 90112
    s_mov_b32 s78, 327680
    buffer_load_dwordx4 v224, s[24:27], s78 offen lds
    s_mov_b32 m0, 91136
    s_mov_b32 s78, 327680
    buffer_load_dwordx4 v225, s[24:27], s78 offen lds
    s_mov_b32 m0, 106496
    s_mov_b32 s78, 458752
    buffer_load_dwordx4 v224, s[24:27], s78 offen lds
    s_mov_b32 m0, 107520
    s_mov_b32 s78, 458752
    buffer_load_dwordx4 v225, s[24:27], s78 offen lds
    s_mov_b32 m0, 59392
    s_mov_b32 s78, 81920
    buffer_load_dwordx4 v224, s[24:27], s78 offen lds
    s_mov_b32 m0, 60416
    s_mov_b32 s78, 81920
    buffer_load_dwordx4 v225, s[24:27], s78 offen lds
    s_mov_b32 m0, 75776
    s_mov_b32 s78, 212992
    buffer_load_dwordx4 v224, s[24:27], s78 offen lds
    s_mov_b32 m0, 76800
    s_mov_b32 s78, 212992
    buffer_load_dwordx4 v225, s[24:27], s78 offen lds
    s_mov_b32 m0, 92160
    s_mov_b32 s78, 344064
    buffer_load_dwordx4 v224, s[24:27], s78 offen lds
    s_mov_b32 m0, 93184
    s_mov_b32 s78, 344064
    buffer_load_dwordx4 v225, s[24:27], s78 offen lds
    s_mov_b32 m0, 108544
    s_mov_b32 s78, 475136
    buffer_load_dwordx4 v224, s[24:27], s78 offen lds
    s_mov_b32 m0, 109568
    s_mov_b32 s78, 475136
    buffer_load_dwordx4 v225, s[24:27], s78 offen lds
    s_barrier
    s_branch A1L1_ST
A1L1_L3:
    s_mov_b32 m0, 9216
    s_mov_b32 s44, 0
    buffer_load_dwordx4 v4, s[12:15], s44 offen sc1 lds
    s_mov_b32 m0, 10240
    s_mov_b32 s44, 0
    buffer_load_dwordx4 v5, s[12:15], s44 offen sc1 lds
    s_mov_b32 m0, 11264
    s_mov_b32 s44, 0
    buffer_load_dwordx4 v6, s[12:15], s44 offen sc1 lds
    s_mov_b32 m0, 21504
    s_mov_b32 s44, 262144
    buffer_load_dwordx4 v4, s[12:15], s44 offen sc1 lds
    s_mov_b32 m0, 22528
    s_mov_b32 s44, 262144
    buffer_load_dwordx4 v5, s[12:15], s44 offen sc1 lds
    s_mov_b32 m0, 23552
    s_mov_b32 s44, 262144
    buffer_load_dwordx4 v6, s[12:15], s44 offen sc1 lds
    s_waitcnt vmcnt(3)
    s_barrier
    s_mov_b32 m0, 33792
    s_mov_b32 s44, 524288
    buffer_load_dwordx4 v4, s[12:15], s44 offen sc1 lds
    s_mov_b32 m0, 34816
    s_mov_b32 s44, 524288
    buffer_load_dwordx4 v5, s[12:15], s44 offen sc1 lds
    s_mov_b32 m0, 35840
    s_mov_b32 s44, 524288
    buffer_load_dwordx4 v6, s[12:15], s44 offen sc1 lds
    s_mov_b32 m0, 46080
    s_mov_b32 s44, 786432
    buffer_load_dwordx4 v4, s[12:15], s44 offen sc1 lds
    s_mov_b32 m0, 47104
    s_mov_b32 s44, 786432
    buffer_load_dwordx4 v5, s[12:15], s44 offen sc1 lds
    s_mov_b32 m0, 48128
    s_mov_b32 s44, 786432
    buffer_load_dwordx4 v6, s[12:15], s44 offen sc1 lds
    s_waitcnt vmcnt(6)
    s_barrier
    s_mov_b32 m0, 9216
    s_mov_b32 s44, 1048576
    buffer_load_dwordx4 v4, s[12:15], s44 offen sc1 lds
    s_mov_b32 m0, 10240
    s_mov_b32 s44, 1048576
    buffer_load_dwordx4 v5, s[12:15], s44 offen sc1 lds
    s_mov_b32 m0, 11264
    s_mov_b32 s44, 1048576
    buffer_load_dwordx4 v6, s[12:15], s44 offen sc1 lds
    s_mov_b32 m0, 55296
    s_mov_b32 s45, 933888
    buffer_load_dwordx4 v7, s[16:19], s45 offen lds
    s_mov_b32 m0, 56320
    s_mov_b32 s45, 958464
    buffer_load_dwordx4 v8, s[16:19], s45 offen lds
    s_mov_b32 m0, 63488
    s_mov_b32 s45, 934912
    buffer_load_dwordx4 v7, s[16:19], s45 offen lds
    s_mov_b32 m0, 64512
    s_mov_b32 s45, 959488
    buffer_load_dwordx4 v8, s[16:19], s45 offen lds
    s_mov_b32 m0, 71680
    s_mov_b32 s45, 935936
    buffer_load_dwordx4 v7, s[16:19], s45 offen lds
    s_mov_b32 m0, 72704
    s_mov_b32 s45, 960512
    buffer_load_dwordx4 v8, s[16:19], s45 offen lds
    s_waitcnt vmcnt(12)
    s_barrier
    s_mov_b32 m0, 21504
    s_mov_b32 s44, 1310720
    buffer_load_dwordx4 v4, s[12:15], s44 offen sc1 lds
    s_mov_b32 m0, 22528
    s_mov_b32 s44, 1310720
    buffer_load_dwordx4 v5, s[12:15], s44 offen sc1 lds
    s_mov_b32 m0, 23552
    s_mov_b32 s44, 1310720
    buffer_load_dwordx4 v6, s[12:15], s44 offen sc1 lds
    s_mov_b32 m0, 79872
    s_mov_b32 s45, 1130496
    buffer_load_dwordx4 v7, s[16:19], s45 offen lds
    s_mov_b32 m0, 80896
    s_mov_b32 s45, 1155072
    buffer_load_dwordx4 v8, s[16:19], s45 offen lds
    s_mov_b32 m0, 88064
    s_mov_b32 s45, 1131520
    buffer_load_dwordx4 v7, s[16:19], s45 offen lds
    s_mov_b32 m0, 89088
    s_mov_b32 s45, 1156096
    buffer_load_dwordx4 v8, s[16:19], s45 offen lds
    s_mov_b32 m0, 96256
    s_mov_b32 s45, 1132544
    buffer_load_dwordx4 v7, s[16:19], s45 offen lds
    s_mov_b32 m0, 97280
    s_mov_b32 s45, 1157120
    buffer_load_dwordx4 v8, s[16:19], s45 offen lds
    s_waitcnt vmcnt(18)
    s_barrier
    s_mov_b32 m0, 33792
    s_mov_b32 s44, 1572864
    buffer_load_dwordx4 v4, s[12:15], s44 offen sc1 lds
    s_mov_b32 m0, 34816
    s_mov_b32 s44, 1572864
    buffer_load_dwordx4 v5, s[12:15], s44 offen sc1 lds
    s_mov_b32 m0, 35840
    s_mov_b32 s44, 1572864
    buffer_load_dwordx4 v6, s[12:15], s44 offen sc1 lds
    s_mov_b32 m0, 104448
    s_mov_b32 s45, 1327104
    buffer_load_dwordx4 v7, s[16:19], s45 offen lds
    s_mov_b32 m0, 105472
    s_mov_b32 s45, 1351680
    buffer_load_dwordx4 v8, s[16:19], s45 offen lds
    s_mov_b32 m0, 112640
    s_mov_b32 s45, 1328128
    buffer_load_dwordx4 v7, s[16:19], s45 offen lds
    s_mov_b32 m0, 113664
    s_mov_b32 s45, 1352704
    buffer_load_dwordx4 v8, s[16:19], s45 offen lds
    s_mov_b32 m0, 120832
    s_mov_b32 s45, 1329152
    buffer_load_dwordx4 v7, s[16:19], s45 offen lds
    s_mov_b32 m0, 121856
    s_mov_b32 s45, 1353728
    buffer_load_dwordx4 v8, s[16:19], s45 offen lds
    s_waitcnt vmcnt(18)
    s_barrier
    s_mov_b32 m0, 46080
    s_mov_b32 s44, 1835008
    buffer_load_dwordx4 v4, s[12:15], s44 offen sc1 lds
    s_mov_b32 m0, 47104
    s_mov_b32 s44, 1835008
    buffer_load_dwordx4 v5, s[12:15], s44 offen sc1 lds
    s_mov_b32 m0, 48128
    s_mov_b32 s44, 1835008
    buffer_load_dwordx4 v6, s[12:15], s44 offen sc1 lds
    s_mov_b32 m0, 129024
    s_mov_b32 s45, 1523712
    buffer_load_dwordx4 v7, s[16:19], s45 offen lds
    s_mov_b32 m0, 130048
    s_mov_b32 s45, 1548288
    buffer_load_dwordx4 v8, s[16:19], s45 offen lds
    s_mov_b32 m0, 137216
    s_mov_b32 s45, 1524736
    buffer_load_dwordx4 v7, s[16:19], s45 offen lds
    s_mov_b32 m0, 138240
    s_mov_b32 s45, 1549312
    buffer_load_dwordx4 v8, s[16:19], s45 offen lds
    s_mov_b32 m0, 145408
    s_mov_b32 s45, 1525760
    buffer_load_dwordx4 v7, s[16:19], s45 offen lds
    s_mov_b32 m0, 146432
    s_mov_b32 s45, 1550336
    buffer_load_dwordx4 v8, s[16:19], s45 offen lds
    s_waitcnt vmcnt(18)
    s_barrier
    s_waitcnt vmcnt(9)
    s_barrier
    s_waitcnt vmcnt(0)
    s_barrier
    s_barrier
    s_mov_b32 m0, 61440
    s_mov_b32 s78, 98304
    buffer_load_dwordx4 v224, s[24:27], s78 offen lds
    s_mov_b32 m0, 62464
    s_mov_b32 s78, 98304
    buffer_load_dwordx4 v225, s[24:27], s78 offen lds
    s_mov_b32 m0, 77824
    s_mov_b32 s78, 229376
    buffer_load_dwordx4 v224, s[24:27], s78 offen lds
    s_mov_b32 m0, 78848
    s_mov_b32 s78, 229376
    buffer_load_dwordx4 v225, s[24:27], s78 offen lds
    s_mov_b32 m0, 94208
    s_mov_b32 s78, 360448
    buffer_load_dwordx4 v224, s[24:27], s78 offen lds
    s_mov_b32 m0, 95232
    s_mov_b32 s78, 360448
    buffer_load_dwordx4 v225, s[24:27], s78 offen lds
    s_mov_b32 m0, 110592
    s_mov_b32 s78, 491520
    buffer_load_dwordx4 v224, s[24:27], s78 offen lds
    s_mov_b32 m0, 111616
    s_mov_b32 s78, 491520
    buffer_load_dwordx4 v225, s[24:27], s78 offen lds
    s_mov_b32 m0, 63488
    s_mov_b32 s78, 114688
    buffer_load_dwordx4 v224, s[24:27], s78 offen lds
    s_mov_b32 m0, 64512
    s_mov_b32 s78, 114688
    buffer_load_dwordx4 v225, s[24:27], s78 offen lds
    s_mov_b32 m0, 79872
    s_mov_b32 s78, 245760
    buffer_load_dwordx4 v224, s[24:27], s78 offen lds
    s_mov_b32 m0, 80896
    s_mov_b32 s78, 245760
    buffer_load_dwordx4 v225, s[24:27], s78 offen lds
    s_mov_b32 m0, 96256
    s_mov_b32 s78, 376832
    buffer_load_dwordx4 v224, s[24:27], s78 offen lds
    s_mov_b32 m0, 97280
    s_mov_b32 s78, 376832
    buffer_load_dwordx4 v225, s[24:27], s78 offen lds
    s_mov_b32 m0, 112640
    s_mov_b32 s78, 507904
    buffer_load_dwordx4 v224, s[24:27], s78 offen lds
    s_mov_b32 m0, 113664
    s_mov_b32 s78, 507904
    buffer_load_dwordx4 v225, s[24:27], s78 offen lds
    s_barrier
    s_branch A1L1_ST
A1L1_C:
    s_cmp_eq_u32 s28, 1
    s_cbranch_scc1 A1L1_V1
    s_cmp_eq_u32 s28, 2
    s_cbranch_scc1 A1L1_V2
    s_cmp_eq_u32 s28, 3
    s_cbranch_scc1 A1L1_V3
A1L1_V0:
    v_mov_b32 v8, v4
    v_mov_b32 v10, v6
    s_mov_b32 s38, 1
    s_mov_b32 s39, 0
    s_waitcnt lgkmcnt(0)
    s_barrier
    ds_read_b64_tr_b16 v[100:101], v10 offset:8192
    ds_read_b64_tr_b16 v[102:103], v10 offset:8704
    ds_read_b64_tr_b16 v[108:109], v8 offset:0
    ds_read_b64_tr_b16 v[110:111], v8 offset:768
    ds_read_b64_tr_b16 v[104:105], v10 offset:16384
    ds_read_b64_tr_b16 v[106:107], v10 offset:16896
    ds_read_b64_tr_b16 v[112:113], v8 offset:32
    ds_read_b64_tr_b16 v[114:115], v8 offset:800
    ds_read_b64_tr_b16 v[96:97], v10 offset:0
    ds_read_b64_tr_b16 v[98:99], v10 offset:512
    ds_read_b64_tr_b16 v[116:117], v8 offset:64
    ds_read_b64_tr_b16 v[118:119], v8 offset:832
    ds_read_b64_tr_b16 v[120:121], v8 offset:96
    ds_read_b64_tr_b16 v[122:123], v8 offset:864
    ds_read_b64_tr_b16 v[124:125], v8 offset:128
    ds_read_b64_tr_b16 v[126:127], v8 offset:896
A1L1_LOOP0:
    s_waitcnt lgkmcnt(0)
    v_mfma_f32_16x16x32_bf16 v[40:43], v[100:103], v[108:111], v[40:43]
    s_mul_i32 s43, s38, 12288
    s_mul_i32 s44, s38, 24576
    v_mfma_f32_16x16x32_bf16 v[60:63], v[108:111], v[104:107], v[60:63]
    v_add_u32 v14, s43, v4
    v_mfma_f32_16x16x32_bf16 v[88:91], v[20:23], v[108:111], v[88:91]
    v_add_u32 v16, s44, v6
    s_add_u32 s38, s38, 1
    v_mfma_f32_16x16x32_bf16 v[44:47], v[100:103], v[112:115], v[44:47]
    s_and_b32 s38, s38, 3
    v_mfma_f32_16x16x32_bf16 v[64:67], v[112:115], v[104:107], v[64:67]
    ds_read_b64_tr_b16 v[132:133], v10 offset:12288
    ds_read_b64_tr_b16 v[134:135], v10 offset:12800
    v_mfma_f32_16x16x32_bf16 v[24:27], v[96:99], v[112:115], v[24:27]
    ds_read_b64_tr_b16 v[140:141], v8 offset:6144
    v_mfma_f32_16x16x32_bf16 v[80:83], v[20:23], v[112:115], v[80:83]
    ds_read_b64_tr_b16 v[142:143], v8 offset:6912
    ds_read_b64_tr_b16 v[136:137], v10 offset:20480
    v_mfma_f32_16x16x32_bf16 v[84:87], v[112:115], v[112:115], v[84:87]
    ds_read_b64_tr_b16 v[138:139], v10 offset:20992
    v_mfma_f32_16x16x32_bf16 v[48:51], v[100:103], v[116:119], v[48:51]
    ds_read_b64_tr_b16 v[144:145], v8 offset:6176
    ds_read_b64_tr_b16 v[146:147], v8 offset:6944
    v_mfma_f32_16x16x32_bf16 v[68:71], v[116:119], v[104:107], v[68:71]
    ds_read_b64_tr_b16 v[128:129], v10 offset:4096
    v_mfma_f32_16x16x32_bf16 v[28:31], v[96:99], v[116:119], v[28:31]
    ds_read_b64_tr_b16 v[130:131], v10 offset:4608
    ds_read_b64_tr_b16 v[148:149], v8 offset:6208
    v_mfma_f32_16x16x32_bf16 v[52:55], v[100:103], v[120:123], v[52:55]
    ds_read_b64_tr_b16 v[150:151], v8 offset:6976
    v_mfma_f32_16x16x32_bf16 v[72:75], v[120:123], v[104:107], v[72:75]
    ds_read_b64_tr_b16 v[152:153], v8 offset:6240
    ds_read_b64_tr_b16 v[154:155], v8 offset:7008
    v_mfma_f32_16x16x32_bf16 v[32:35], v[96:99], v[120:123], v[32:35]
    ds_read_b64_tr_b16 v[156:157], v8 offset:6272
    v_mfma_f32_16x16x32_bf16 v[56:59], v[100:103], v[124:127], v[56:59]
    ds_read_b64_tr_b16 v[158:159], v8 offset:7040
    v_mfma_f32_16x16x32_bf16 v[76:79], v[124:127], v[104:107], v[76:79]
    v_mfma_f32_16x16x32_bf16 v[36:39], v[96:99], v[124:127], v[36:39]
    s_waitcnt lgkmcnt(0)
    s_barrier
    v_mfma_f32_16x16x32_bf16 v[40:43], v[132:135], v[140:143], v[40:43]
    ds_read_b64_tr_b16 v[100:101], v16 offset:8192
    ds_read_b64_tr_b16 v[102:103], v16 offset:8704
    v_mfma_f32_16x16x32_bf16 v[60:63], v[140:143], v[136:139], v[60:63]
    ds_read_b64_tr_b16 v[108:109], v14 offset:0
    v_mfma_f32_16x16x32_bf16 v[88:91], v[20:23], v[140:143], v[88:91]
    ds_read_b64_tr_b16 v[110:111], v14 offset:768
    ds_read_b64_tr_b16 v[104:105], v16 offset:16384
    v_mfma_f32_16x16x32_bf16 v[44:47], v[132:135], v[144:147], v[44:47]
    ds_read_b64_tr_b16 v[106:107], v16 offset:16896
    v_mfma_f32_16x16x32_bf16 v[64:67], v[144:147], v[136:139], v[64:67]
    ds_read_b64_tr_b16 v[112:113], v14 offset:32
    ds_read_b64_tr_b16 v[114:115], v14 offset:800
    v_mfma_f32_16x16x32_bf16 v[24:27], v[128:131], v[144:147], v[24:27]
    ds_read_b64_tr_b16 v[96:97], v16 offset:0
    v_mfma_f32_16x16x32_bf16 v[80:83], v[20:23], v[144:147], v[80:83]
    ds_read_b64_tr_b16 v[98:99], v16 offset:512
    ds_read_b64_tr_b16 v[116:117], v14 offset:64
    v_mfma_f32_16x16x32_bf16 v[84:87], v[144:147], v[144:147], v[84:87]
    ds_read_b64_tr_b16 v[118:119], v14 offset:832
    v_mfma_f32_16x16x32_bf16 v[48:51], v[132:135], v[148:151], v[48:51]
    ds_read_b64_tr_b16 v[120:121], v14 offset:96
    ds_read_b64_tr_b16 v[122:123], v14 offset:864
    v_mfma_f32_16x16x32_bf16 v[68:71], v[148:151], v[136:139], v[68:71]
    ds_read_b64_tr_b16 v[124:125], v14 offset:128
    v_mfma_f32_16x16x32_bf16 v[28:31], v[128:131], v[148:151], v[28:31]
    ds_read_b64_tr_b16 v[126:127], v14 offset:896
    v_mov_b32 v8, v14
    v_mfma_f32_16x16x32_bf16 v[52:55], v[132:135], v[152:155], v[52:55]
    v_mov_b32 v10, v16
    v_mfma_f32_16x16x32_bf16 v[72:75], v[152:155], v[136:139], v[72:75]
    v_mfma_f32_16x16x32_bf16 v[32:35], v[128:131], v[152:155], v[32:35]
    v_mfma_f32_16x16x32_bf16 v[56:59], v[132:135], v[156:159], v[56:59]
    v_mfma_f32_16x16x32_bf16 v[76:79], v[156:159], v[136:139], v[76:79]
    v_mfma_f32_16x16x32_bf16 v[36:39], v[128:131], v[156:159], v[36:39]
    s_add_u32 s39, s39, 1
    s_cmp_lt_u32 s39, 7
    s_cbranch_scc1 A1L1_LOOP0
    s_waitcnt lgkmcnt(12)
    v_mfma_f32_16x16x32_bf16 v[40:43], v[100:103], v[108:111], v[40:43]
    ds_read_b64_tr_b16 v[132:133], v10 offset:12288
    ds_read_b64_tr_b16 v[134:135], v10 offset:12800
    s_waitcnt lgkmcnt(12)
    v_mfma_f32_16x16x32_bf16 v[60:63], v[108:111], v[104:107], v[60:63]
    ds_read_b64_tr_b16 v[140:141], v8 offset:6144
    v_mfma_f32_16x16x32_bf16 v[88:91], v[20:23], v[108:111], v[88:91]
    ds_read_b64_tr_b16 v[142:143], v8 offset:6912
    ds_read_b64_tr_b16 v[136:137], v10 offset:20480
    s_waitcnt lgkmcnt(13)
    v_mfma_f32_16x16x32_bf16 v[44:47], v[100:103], v[112:115], v[44:47]
    ds_read_b64_tr_b16 v[138:139], v10 offset:20992
    v_mfma_f32_16x16x32_bf16 v[64:67], v[112:115], v[104:107], v[64:67]
    ds_read_b64_tr_b16 v[144:145], v8 offset:6176
    ds_read_b64_tr_b16 v[146:147], v8 offset:6944
    s_waitcnt lgkmcnt(14)
    v_mfma_f32_16x16x32_bf16 v[24:27], v[96:99], v[112:115], v[24:27]
    ds_read_b64_tr_b16 v[128:129], v10 offset:4096
    v_mfma_f32_16x16x32_bf16 v[80:83], v[20:23], v[112:115], v[80:83]
    ds_read_b64_tr_b16 v[130:131], v10 offset:4608
    ds_read_b64_tr_b16 v[148:149], v8 offset:6208
    v_mfma_f32_16x16x32_bf16 v[84:87], v[112:115], v[112:115], v[84:87]
    ds_read_b64_tr_b16 v[150:151], v8 offset:6976
    s_waitcnt lgkmcnt(14)
    v_mfma_f32_16x16x32_bf16 v[48:51], v[100:103], v[116:119], v[48:51]
    ds_read_b64_tr_b16 v[152:153], v8 offset:6240
    ds_read_b64_tr_b16 v[154:155], v8 offset:7008
    v_mfma_f32_16x16x32_bf16 v[68:71], v[116:119], v[104:107], v[68:71]
    ds_read_b64_tr_b16 v[156:157], v8 offset:6272
    v_mfma_f32_16x16x32_bf16 v[28:31], v[96:99], v[116:119], v[28:31]
    ds_read_b64_tr_b16 v[158:159], v8 offset:7040
    v_mfma_f32_16x16x32_bf16 v[52:55], v[100:103], v[120:123], v[52:55]
    v_mfma_f32_16x16x32_bf16 v[72:75], v[120:123], v[104:107], v[72:75]
    v_mfma_f32_16x16x32_bf16 v[32:35], v[96:99], v[120:123], v[32:35]
    s_waitcnt lgkmcnt(14)
    v_mfma_f32_16x16x32_bf16 v[56:59], v[100:103], v[124:127], v[56:59]
    v_mfma_f32_16x16x32_bf16 v[76:79], v[124:127], v[104:107], v[76:79]
    v_mfma_f32_16x16x32_bf16 v[36:39], v[96:99], v[124:127], v[36:39]
    s_waitcnt lgkmcnt(12)
    v_mfma_f32_16x16x32_bf16 v[40:43], v[132:135], v[140:143], v[40:43]
    s_waitcnt lgkmcnt(10)
    v_mfma_f32_16x16x32_bf16 v[60:63], v[140:143], v[136:139], v[60:63]
    v_mfma_f32_16x16x32_bf16 v[88:91], v[20:23], v[140:143], v[88:91]
    s_waitcnt lgkmcnt(8)
    v_mfma_f32_16x16x32_bf16 v[44:47], v[132:135], v[144:147], v[44:47]
    v_mfma_f32_16x16x32_bf16 v[64:67], v[144:147], v[136:139], v[64:67]
    s_waitcnt lgkmcnt(6)
    v_mfma_f32_16x16x32_bf16 v[24:27], v[128:131], v[144:147], v[24:27]
    v_mfma_f32_16x16x32_bf16 v[80:83], v[20:23], v[144:147], v[80:83]
    v_mfma_f32_16x16x32_bf16 v[84:87], v[144:147], v[144:147], v[84:87]
    s_waitcnt lgkmcnt(4)
    v_mfma_f32_16x16x32_bf16 v[48:51], v[132:135], v[148:151], v[48:51]
    v_mfma_f32_16x16x32_bf16 v[68:71], v[148:151], v[136:139], v[68:71]
    v_mfma_f32_16x16x32_bf16 v[28:31], v[128:131], v[148:151], v[28:31]
    s_waitcnt lgkmcnt(2)
    v_mfma_f32_16x16x32_bf16 v[52:55], v[132:135], v[152:155], v[52:55]
    v_mfma_f32_16x16x32_bf16 v[72:75], v[152:155], v[136:139], v[72:75]
    v_mfma_f32_16x16x32_bf16 v[32:35], v[128:131], v[152:155], v[32:35]
    s_waitcnt lgkmcnt(0)
    v_mfma_f32_16x16x32_bf16 v[56:59], v[132:135], v[156:159], v[56:59]
    v_mfma_f32_16x16x32_bf16 v[76:79], v[156:159], v[136:139], v[76:79]
    v_mfma_f32_16x16x32_bf16 v[36:39], v[128:131], v[156:159], v[36:39]
    s_nop 7
    v_cndmask_b32 v12, v84, v85, s[48:49]
    v_cndmask_b32 v13, v86, v87, s[48:49]
    v_mul_f32 v14, s62, v80
    v_cndmask_b32 v12, v12, v13, s[50:51]
    v_cndmask_b32 v12, 0, v12, s[52:53]
    v_mov_b32 v13, v12
    s_nop 1
    v_permlane16_swap_b32 v12, v13
    v_add_f32 v12, v12, v13
    v_mov_b32 v13, v12
    s_nop 1
    v_permlane32_swap_b32 v12, v13
    v_add_f32 v12, v12, v13
    v_fma_f32 v12, v12, s63, v173
    v_fma_f32 v12, -v14, v14, v12
    v_max_f32 v12, v173, v12
    v_rsq_f32 v12, v12
    s_mov_b64 exec, 0xffff
    ds_write_b32 v164, v14 offset:128
    ds_write_b32 v164, v12 offset:192
    s_mov_b64 exec, -1
    s_mov_b64 exec, 0xffff
    ds_write_b32 v164, v88 offset:0
    s_mov_b64 exec, -1
    s_waitcnt lgkmcnt(0)
    s_barrier
    s_branch A1L1_EP
A1L1_V1:
    v_mov_b32 v8, v4
    v_mov_b32 v10, v6
    s_mov_b32 s38, 1
    s_mov_b32 s39, 0
    s_waitcnt lgkmcnt(0)
    s_barrier
    ds_read_b64_tr_b16 v[100:101], v10 offset:8192
    ds_read_b64_tr_b16 v[102:103], v10 offset:8704
    ds_read_b64_tr_b16 v[108:109], v8 offset:0
    ds_read_b64_tr_b16 v[110:111], v8 offset:768
    ds_read_b64_tr_b16 v[104:105], v10 offset:16384
    ds_read_b64_tr_b16 v[106:107], v10 offset:16896
    ds_read_b64_tr_b16 v[112:113], v8 offset:32
    ds_read_b64_tr_b16 v[114:115], v8 offset:800
    ds_read_b64_tr_b16 v[96:97], v10 offset:0
    ds_read_b64_tr_b16 v[98:99], v10 offset:512
    ds_read_b64_tr_b16 v[116:117], v8 offset:64
    ds_read_b64_tr_b16 v[118:119], v8 offset:832
    ds_read_b64_tr_b16 v[120:121], v8 offset:96
    ds_read_b64_tr_b16 v[122:123], v8 offset:864
    ds_read_b64_tr_b16 v[124:125], v8 offset:128
    ds_read_b64_tr_b16 v[126:127], v8 offset:896
A1L1_LOOP1:
    s_waitcnt lgkmcnt(0)
    v_mfma_f32_16x16x32_bf16 v[40:43], v[100:103], v[108:111], v[40:43]
    s_mul_i32 s43, s38, 12288
    s_mul_i32 s44, s38, 24576
    v_mfma_f32_16x16x32_bf16 v[60:63], v[108:111], v[104:107], v[60:63]
    v_add_u32 v14, s43, v4
    v_mfma_f32_16x16x32_bf16 v[88:91], v[108:111], v[108:111], v[88:91]
    v_add_u32 v16, s44, v6
    s_add_u32 s38, s38, 1
    v_mfma_f32_16x16x32_bf16 v[44:47], v[100:103], v[112:115], v[44:47]
    s_and_b32 s38, s38, 3
    v_mfma_f32_16x16x32_bf16 v[64:67], v[112:115], v[104:107], v[64:67]
    ds_read_b64_tr_b16 v[132:133], v10 offset:12288
    ds_read_b64_tr_b16 v[134:135], v10 offset:12800
    v_mfma_f32_16x16x32_bf16 v[24:27], v[96:99], v[112:115], v[24:27]
    ds_read_b64_tr_b16 v[140:141], v8 offset:6144
    v_mfma_f32_16x16x32_bf16 v[48:51], v[100:103], v[116:119], v[48:51]
    ds_read_b64_tr_b16 v[142:143], v8 offset:6912
    ds_read_b64_tr_b16 v[136:137], v10 offset:20480
    v_mfma_f32_16x16x32_bf16 v[68:71], v[116:119], v[104:107], v[68:71]
    ds_read_b64_tr_b16 v[138:139], v10 offset:20992
    v_mfma_f32_16x16x32_bf16 v[28:31], v[96:99], v[116:119], v[28:31]
    ds_read_b64_tr_b16 v[144:145], v8 offset:6176
    ds_read_b64_tr_b16 v[146:147], v8 offset:6944
    v_mfma_f32_16x16x32_bf16 v[80:83], v[20:23], v[116:119], v[80:83]
    ds_read_b64_tr_b16 v[128:129], v10 offset:4096
    v_mfma_f32_16x16x32_bf16 v[84:87], v[116:119], v[116:119], v[84:87]
    ds_read_b64_tr_b16 v[130:131], v10 offset:4608
    ds_read_b64_tr_b16 v[148:149], v8 offset:6208
    v_mfma_f32_16x16x32_bf16 v[52:55], v[100:103], v[120:123], v[52:55]
    ds_read_b64_tr_b16 v[150:151], v8 offset:6976
    v_mfma_f32_16x16x32_bf16 v[72:75], v[120:123], v[104:107], v[72:75]
    ds_read_b64_tr_b16 v[152:153], v8 offset:6240
    ds_read_b64_tr_b16 v[154:155], v8 offset:7008
    v_mfma_f32_16x16x32_bf16 v[32:35], v[96:99], v[120:123], v[32:35]
    ds_read_b64_tr_b16 v[156:157], v8 offset:6272
    v_mfma_f32_16x16x32_bf16 v[56:59], v[100:103], v[124:127], v[56:59]
    ds_read_b64_tr_b16 v[158:159], v8 offset:7040
    v_mfma_f32_16x16x32_bf16 v[76:79], v[124:127], v[104:107], v[76:79]
    v_mfma_f32_16x16x32_bf16 v[36:39], v[96:99], v[124:127], v[36:39]
    s_waitcnt lgkmcnt(0)
    s_barrier
    v_mfma_f32_16x16x32_bf16 v[40:43], v[132:135], v[140:143], v[40:43]
    ds_read_b64_tr_b16 v[100:101], v16 offset:8192
    ds_read_b64_tr_b16 v[102:103], v16 offset:8704
    v_mfma_f32_16x16x32_bf16 v[60:63], v[140:143], v[136:139], v[60:63]
    ds_read_b64_tr_b16 v[108:109], v14 offset:0
    v_mfma_f32_16x16x32_bf16 v[88:91], v[140:143], v[140:143], v[88:91]
    ds_read_b64_tr_b16 v[110:111], v14 offset:768
    ds_read_b64_tr_b16 v[104:105], v16 offset:16384
    v_mfma_f32_16x16x32_bf16 v[44:47], v[132:135], v[144:147], v[44:47]
    ds_read_b64_tr_b16 v[106:107], v16 offset:16896
    v_mfma_f32_16x16x32_bf16 v[64:67], v[144:147], v[136:139], v[64:67]
    ds_read_b64_tr_b16 v[112:113], v14 offset:32
    ds_read_b64_tr_b16 v[114:115], v14 offset:800
    v_mfma_f32_16x16x32_bf16 v[24:27], v[128:131], v[144:147], v[24:27]
    ds_read_b64_tr_b16 v[96:97], v16 offset:0
    v_mfma_f32_16x16x32_bf16 v[48:51], v[132:135], v[148:151], v[48:51]
    ds_read_b64_tr_b16 v[98:99], v16 offset:512
    ds_read_b64_tr_b16 v[116:117], v14 offset:64
    v_mfma_f32_16x16x32_bf16 v[68:71], v[148:151], v[136:139], v[68:71]
    ds_read_b64_tr_b16 v[118:119], v14 offset:832
    v_mfma_f32_16x16x32_bf16 v[28:31], v[128:131], v[148:151], v[28:31]
    ds_read_b64_tr_b16 v[120:121], v14 offset:96
    ds_read_b64_tr_b16 v[122:123], v14 offset:864
    v_mfma_f32_16x16x32_bf16 v[80:83], v[20:23], v[148:151], v[80:83]
    ds_read_b64_tr_b16 v[124:125], v14 offset:128
    v_mfma_f32_16x16x32_bf16 v[84:87], v[148:151], v[148:151], v[84:87]
    ds_read_b64_tr_b16 v[126:127], v14 offset:896
    v_mov_b32 v8, v14
    v_mfma_f32_16x16x32_bf16 v[52:55], v[132:135], v[152:155], v[52:55]
    v_mov_b32 v10, v16
    v_mfma_f32_16x16x32_bf16 v[72:75], v[152:155], v[136:139], v[72:75]
    v_mfma_f32_16x16x32_bf16 v[32:35], v[128:131], v[152:155], v[32:35]
    v_mfma_f32_16x16x32_bf16 v[56:59], v[132:135], v[156:159], v[56:59]
    v_mfma_f32_16x16x32_bf16 v[76:79], v[156:159], v[136:139], v[76:79]
    v_mfma_f32_16x16x32_bf16 v[36:39], v[128:131], v[156:159], v[36:39]
    s_add_u32 s39, s39, 1
    s_cmp_lt_u32 s39, 7
    s_cbranch_scc1 A1L1_LOOP1
    s_waitcnt lgkmcnt(12)
    v_mfma_f32_16x16x32_bf16 v[40:43], v[100:103], v[108:111], v[40:43]
    ds_read_b64_tr_b16 v[132:133], v10 offset:12288
    ds_read_b64_tr_b16 v[134:135], v10 offset:12800
    s_waitcnt lgkmcnt(12)
    v_mfma_f32_16x16x32_bf16 v[60:63], v[108:111], v[104:107], v[60:63]
    ds_read_b64_tr_b16 v[140:141], v8 offset:6144
    v_mfma_f32_16x16x32_bf16 v[88:91], v[108:111], v[108:111], v[88:91]
    ds_read_b64_tr_b16 v[142:143], v8 offset:6912
    ds_read_b64_tr_b16 v[136:137], v10 offset:20480
    s_waitcnt lgkmcnt(13)
    v_mfma_f32_16x16x32_bf16 v[44:47], v[100:103], v[112:115], v[44:47]
    ds_read_b64_tr_b16 v[138:139], v10 offset:20992
    v_mfma_f32_16x16x32_bf16 v[64:67], v[112:115], v[104:107], v[64:67]
    ds_read_b64_tr_b16 v[144:145], v8 offset:6176
    ds_read_b64_tr_b16 v[146:147], v8 offset:6944
    s_waitcnt lgkmcnt(14)
    v_mfma_f32_16x16x32_bf16 v[24:27], v[96:99], v[112:115], v[24:27]
    ds_read_b64_tr_b16 v[128:129], v10 offset:4096
    s_waitcnt lgkmcnt(13)
    v_mfma_f32_16x16x32_bf16 v[48:51], v[100:103], v[116:119], v[48:51]
    ds_read_b64_tr_b16 v[130:131], v10 offset:4608
    ds_read_b64_tr_b16 v[148:149], v8 offset:6208
    v_mfma_f32_16x16x32_bf16 v[68:71], v[116:119], v[104:107], v[68:71]
    ds_read_b64_tr_b16 v[150:151], v8 offset:6976
    v_mfma_f32_16x16x32_bf16 v[28:31], v[96:99], v[116:119], v[28:31]
    ds_read_b64_tr_b16 v[152:153], v8 offset:6240
    ds_read_b64_tr_b16 v[154:155], v8 offset:7008
    v_mfma_f32_16x16x32_bf16 v[80:83], v[20:23], v[116:119], v[80:83]
    ds_read_b64_tr_b16 v[156:157], v8 offset:6272
    v_mfma_f32_16x16x32_bf16 v[84:87], v[116:119], v[116:119], v[84:87]
    ds_read_b64_tr_b16 v[158:159], v8 offset:7040
    s_waitcnt lgkmcnt(14)
    v_mfma_f32_16x16x32_bf16 v[52:55], v[100:103], v[120:123], v[52:55]
    v_mfma_f32_16x16x32_bf16 v[72:75], v[120:123], v[104:107], v[72:75]
    v_mfma_f32_16x16x32_bf16 v[32:35], v[96:99], v[120:123], v[32:35]
    v_mfma_f32_16x16x32_bf16 v[56:59], v[100:103], v[124:127], v[56:59]
    v_mfma_f32_16x16x32_bf16 v[76:79], v[124:127], v[104:107], v[76:79]
    v_mfma_f32_16x16x32_bf16 v[36:39], v[96:99], v[124:127], v[36:39]
    s_waitcnt lgkmcnt(12)
    v_mfma_f32_16x16x32_bf16 v[40:43], v[132:135], v[140:143], v[40:43]
    s_waitcnt lgkmcnt(10)
    v_mfma_f32_16x16x32_bf16 v[60:63], v[140:143], v[136:139], v[60:63]
    v_mfma_f32_16x16x32_bf16 v[88:91], v[140:143], v[140:143], v[88:91]
    s_waitcnt lgkmcnt(8)
    v_mfma_f32_16x16x32_bf16 v[44:47], v[132:135], v[144:147], v[44:47]
    v_mfma_f32_16x16x32_bf16 v[64:67], v[144:147], v[136:139], v[64:67]
    s_waitcnt lgkmcnt(6)
    v_mfma_f32_16x16x32_bf16 v[24:27], v[128:131], v[144:147], v[24:27]
    s_waitcnt lgkmcnt(4)
    v_mfma_f32_16x16x32_bf16 v[48:51], v[132:135], v[148:151], v[48:51]
    v_mfma_f32_16x16x32_bf16 v[68:71], v[148:151], v[136:139], v[68:71]
    v_mfma_f32_16x16x32_bf16 v[28:31], v[128:131], v[148:151], v[28:31]
    v_mfma_f32_16x16x32_bf16 v[80:83], v[20:23], v[148:151], v[80:83]
    v_mfma_f32_16x16x32_bf16 v[84:87], v[148:151], v[148:151], v[84:87]
    s_waitcnt lgkmcnt(2)
    v_mfma_f32_16x16x32_bf16 v[52:55], v[132:135], v[152:155], v[52:55]
    v_mfma_f32_16x16x32_bf16 v[72:75], v[152:155], v[136:139], v[72:75]
    v_mfma_f32_16x16x32_bf16 v[32:35], v[128:131], v[152:155], v[32:35]
    s_waitcnt lgkmcnt(0)
    v_mfma_f32_16x16x32_bf16 v[56:59], v[132:135], v[156:159], v[56:59]
    v_mfma_f32_16x16x32_bf16 v[76:79], v[156:159], v[136:139], v[76:79]
    v_mfma_f32_16x16x32_bf16 v[36:39], v[128:131], v[156:159], v[36:39]
    s_nop 7
    v_cndmask_b32 v12, v84, v85, s[48:49]
    v_cndmask_b32 v13, v86, v87, s[48:49]
    v_mul_f32 v14, s62, v80
    v_cndmask_b32 v12, v12, v13, s[50:51]
    v_cndmask_b32 v12, 0, v12, s[52:53]
    v_mov_b32 v13, v12
    s_nop 1
    v_permlane16_swap_b32 v12, v13
    v_add_f32 v12, v12, v13
    v_mov_b32 v13, v12
    s_nop 1
    v_permlane32_swap_b32 v12, v13
    v_add_f32 v12, v12, v13
    v_fma_f32 v12, v12, s63, v173
    v_fma_f32 v12, -v14, v14, v12
    v_max_f32 v12, v173, v12
    v_rsq_f32 v12, v12
    s_mov_b64 exec, 0xffff
    ds_write_b32 v164, v14 offset:256
    ds_write_b32 v164, v12 offset:320
    s_mov_b64 exec, -1
    v_cndmask_b32 v12, v88, v89, s[48:49]
    v_cndmask_b32 v13, v90, v91, s[48:49]
    v_cndmask_b32 v12, v12, v13, s[50:51]
    s_mov_b64 exec, s[52:53]
    ds_write_b32 v164, v12 offset:64
    s_mov_b64 exec, -1
    s_waitcnt lgkmcnt(0)
    s_barrier
    s_branch A1L1_EP
A1L1_V2:
    v_mov_b32 v8, v4
    v_mov_b32 v10, v6
    s_mov_b32 s38, 1
    s_mov_b32 s39, 0
    s_waitcnt lgkmcnt(0)
    s_barrier
    ds_read_b64_tr_b16 v[100:101], v10 offset:8192
    ds_read_b64_tr_b16 v[102:103], v10 offset:8704
    ds_read_b64_tr_b16 v[108:109], v8 offset:0
    ds_read_b64_tr_b16 v[110:111], v8 offset:768
    ds_read_b64_tr_b16 v[104:105], v10 offset:16384
    ds_read_b64_tr_b16 v[106:107], v10 offset:16896
    ds_read_b64_tr_b16 v[112:113], v8 offset:32
    ds_read_b64_tr_b16 v[114:115], v8 offset:800
    ds_read_b64_tr_b16 v[96:97], v10 offset:0
    ds_read_b64_tr_b16 v[98:99], v10 offset:512
    ds_read_b64_tr_b16 v[116:117], v8 offset:64
    ds_read_b64_tr_b16 v[118:119], v8 offset:832
    ds_read_b64_tr_b16 v[120:121], v8 offset:96
    ds_read_b64_tr_b16 v[122:123], v8 offset:864
    ds_read_b64_tr_b16 v[124:125], v8 offset:128
    ds_read_b64_tr_b16 v[126:127], v8 offset:896
A1L1_LOOP2:
    s_waitcnt lgkmcnt(0)
    v_mfma_f32_16x16x32_bf16 v[40:43], v[100:103], v[108:111], v[40:43]
    s_mul_i32 s43, s38, 12288
    s_mul_i32 s44, s38, 24576
    v_mfma_f32_16x16x32_bf16 v[60:63], v[108:111], v[104:107], v[60:63]
    v_add_u32 v14, s43, v4
    v_mfma_f32_16x16x32_bf16 v[44:47], v[100:103], v[112:115], v[44:47]
    v_add_u32 v16, s44, v6
    s_add_u32 s38, s38, 1
    v_mfma_f32_16x16x32_bf16 v[64:67], v[112:115], v[104:107], v[64:67]
    s_and_b32 s38, s38, 3
    v_mfma_f32_16x16x32_bf16 v[24:27], v[96:99], v[112:115], v[24:27]
    ds_read_b64_tr_b16 v[132:133], v10 offset:12288
    ds_read_b64_tr_b16 v[134:135], v10 offset:12800
    v_mfma_f32_16x16x32_bf16 v[48:51], v[100:103], v[116:119], v[48:51]
    ds_read_b64_tr_b16 v[140:141], v8 offset:6144
    v_mfma_f32_16x16x32_bf16 v[68:71], v[116:119], v[104:107], v[68:71]
    ds_read_b64_tr_b16 v[142:143], v8 offset:6912
    ds_read_b64_tr_b16 v[136:137], v10 offset:20480
    v_mfma_f32_16x16x32_bf16 v[28:31], v[96:99], v[116:119], v[28:31]
    ds_read_b64_tr_b16 v[138:139], v10 offset:20992
    v_mfma_f32_16x16x32_bf16 v[52:55], v[100:103], v[120:123], v[52:55]
    ds_read_b64_tr_b16 v[144:145], v8 offset:6176
    ds_read_b64_tr_b16 v[146:147], v8 offset:6944
    v_mfma_f32_16x16x32_bf16 v[72:75], v[120:123], v[104:107], v[72:75]
    ds_read_b64_tr_b16 v[128:129], v10 offset:4096
    v_mfma_f32_16x16x32_bf16 v[32:35], v[96:99], v[120:123], v[32:35]
    ds_read_b64_tr_b16 v[130:131], v10 offset:4608
    ds_read_b64_tr_b16 v[148:149], v8 offset:6208
    v_mfma_f32_16x16x32_bf16 v[80:83], v[20:23], v[120:123], v[80:83]
    ds_read_b64_tr_b16 v[150:151], v8 offset:6976
    v_mfma_f32_16x16x32_bf16 v[84:87], v[120:123], v[120:123], v[84:87]
    ds_read_b64_tr_b16 v[152:153], v8 offset:6240
    ds_read_b64_tr_b16 v[154:155], v8 offset:7008
    v_mfma_f32_16x16x32_bf16 v[56:59], v[100:103], v[124:127], v[56:59]
    ds_read_b64_tr_b16 v[156:157], v8 offset:6272
    v_mfma_f32_16x16x32_bf16 v[76:79], v[124:127], v[104:107], v[76:79]
    ds_read_b64_tr_b16 v[158:159], v8 offset:7040
    v_mfma_f32_16x16x32_bf16 v[36:39], v[96:99], v[124:127], v[36:39]
    s_waitcnt lgkmcnt(0)
    s_barrier
    v_mfma_f32_16x16x32_bf16 v[40:43], v[132:135], v[140:143], v[40:43]
    ds_read_b64_tr_b16 v[100:101], v16 offset:8192
    ds_read_b64_tr_b16 v[102:103], v16 offset:8704
    v_mfma_f32_16x16x32_bf16 v[60:63], v[140:143], v[136:139], v[60:63]
    ds_read_b64_tr_b16 v[108:109], v14 offset:0
    v_mfma_f32_16x16x32_bf16 v[44:47], v[132:135], v[144:147], v[44:47]
    ds_read_b64_tr_b16 v[110:111], v14 offset:768
    ds_read_b64_tr_b16 v[104:105], v16 offset:16384
    v_mfma_f32_16x16x32_bf16 v[64:67], v[144:147], v[136:139], v[64:67]
    ds_read_b64_tr_b16 v[106:107], v16 offset:16896
    v_mfma_f32_16x16x32_bf16 v[24:27], v[128:131], v[144:147], v[24:27]
    ds_read_b64_tr_b16 v[112:113], v14 offset:32
    ds_read_b64_tr_b16 v[114:115], v14 offset:800
    v_mfma_f32_16x16x32_bf16 v[48:51], v[132:135], v[148:151], v[48:51]
    ds_read_b64_tr_b16 v[96:97], v16 offset:0
    v_mfma_f32_16x16x32_bf16 v[68:71], v[148:151], v[136:139], v[68:71]
    ds_read_b64_tr_b16 v[98:99], v16 offset:512
    ds_read_b64_tr_b16 v[116:117], v14 offset:64
    v_mfma_f32_16x16x32_bf16 v[28:31], v[128:131], v[148:151], v[28:31]
    ds_read_b64_tr_b16 v[118:119], v14 offset:832
    v_mfma_f32_16x16x32_bf16 v[52:55], v[132:135], v[152:155], v[52:55]
    ds_read_b64_tr_b16 v[120:121], v14 offset:96
    ds_read_b64_tr_b16 v[122:123], v14 offset:864
    v_mfma_f32_16x16x32_bf16 v[72:75], v[152:155], v[136:139], v[72:75]
    ds_read_b64_tr_b16 v[124:125], v14 offset:128
    v_mfma_f32_16x16x32_bf16 v[32:35], v[128:131], v[152:155], v[32:35]
    ds_read_b64_tr_b16 v[126:127], v14 offset:896
    v_mov_b32 v8, v14
    v_mfma_f32_16x16x32_bf16 v[80:83], v[20:23], v[152:155], v[80:83]
    v_mov_b32 v10, v16
    v_mfma_f32_16x16x32_bf16 v[84:87], v[152:155], v[152:155], v[84:87]
    v_mfma_f32_16x16x32_bf16 v[56:59], v[132:135], v[156:159], v[56:59]
    v_mfma_f32_16x16x32_bf16 v[76:79], v[156:159], v[136:139], v[76:79]
    v_mfma_f32_16x16x32_bf16 v[36:39], v[128:131], v[156:159], v[36:39]
    s_add_u32 s39, s39, 1
    s_cmp_lt_u32 s39, 7
    s_cbranch_scc1 A1L1_LOOP2
    s_waitcnt lgkmcnt(12)
    v_mfma_f32_16x16x32_bf16 v[40:43], v[100:103], v[108:111], v[40:43]
    ds_read_b64_tr_b16 v[132:133], v10 offset:12288
    ds_read_b64_tr_b16 v[134:135], v10 offset:12800
    s_waitcnt lgkmcnt(12)
    v_mfma_f32_16x16x32_bf16 v[60:63], v[108:111], v[104:107], v[60:63]
    ds_read_b64_tr_b16 v[140:141], v8 offset:6144
    s_waitcnt lgkmcnt(11)
    v_mfma_f32_16x16x32_bf16 v[44:47], v[100:103], v[112:115], v[44:47]
    ds_read_b64_tr_b16 v[142:143], v8 offset:6912
    ds_read_b64_tr_b16 v[136:137], v10 offset:20480
    v_mfma_f32_16x16x32_bf16 v[64:67], v[112:115], v[104:107], v[64:67]
    ds_read_b64_tr_b16 v[138:139], v10 offset:20992
    s_waitcnt lgkmcnt(12)
    v_mfma_f32_16x16x32_bf16 v[24:27], v[96:99], v[112:115], v[24:27]
    ds_read_b64_tr_b16 v[144:145], v8 offset:6176
    ds_read_b64_tr_b16 v[146:147], v8 offset:6944
    s_waitcnt lgkmcnt(12)
    v_mfma_f32_16x16x32_bf16 v[48:51], v[100:103], v[116:119], v[48:51]
    ds_read_b64_tr_b16 v[128:129], v10 offset:4096
    v_mfma_f32_16x16x32_bf16 v[68:71], v[116:119], v[104:107], v[68:71]
    ds_read_b64_tr_b16 v[130:131], v10 offset:4608
    ds_read_b64_tr_b16 v[148:149], v8 offset:6208
    v_mfma_f32_16x16x32_bf16 v[28:31], v[96:99], v[116:119], v[28:31]
    ds_read_b64_tr_b16 v[150:151], v8 offset:6976
    s_waitcnt lgkmcnt(14)
    v_mfma_f32_16x16x32_bf16 v[52:55], v[100:103], v[120:123], v[52:55]
    ds_read_b64_tr_b16 v[152:153], v8 offset:6240
    ds_read_b64_tr_b16 v[154:155], v8 offset:7008
    v_mfma_f32_16x16x32_bf16 v[72:75], v[120:123], v[104:107], v[72:75]
    ds_read_b64_tr_b16 v[156:157], v8 offset:6272
    v_mfma_f32_16x16x32_bf16 v[32:35], v[96:99], v[120:123], v[32:35]
    ds_read_b64_tr_b16 v[158:159], v8 offset:7040
    v_mfma_f32_16x16x32_bf16 v[80:83], v[20:23], v[120:123], v[80:83]
    v_mfma_f32_16x16x32_bf16 v[84:87], v[120:123], v[120:123], v[84:87]
    s_waitcnt lgkmcnt(14)
    v_mfma_f32_16x16x32_bf16 v[56:59], v[100:103], v[124:127], v[56:59]
    v_mfma_f32_16x16x32_bf16 v[76:79], v[124:127], v[104:107], v[76:79]
    v_mfma_f32_16x16x32_bf16 v[36:39], v[96:99], v[124:127], v[36:39]
    s_waitcnt lgkmcnt(12)
    v_mfma_f32_16x16x32_bf16 v[40:43], v[132:135], v[140:143], v[40:43]
    s_waitcnt lgkmcnt(10)
    v_mfma_f32_16x16x32_bf16 v[60:63], v[140:143], v[136:139], v[60:63]
    s_waitcnt lgkmcnt(8)
    v_mfma_f32_16x16x32_bf16 v[44:47], v[132:135], v[144:147], v[44:47]
    v_mfma_f32_16x16x32_bf16 v[64:67], v[144:147], v[136:139], v[64:67]
    s_waitcnt lgkmcnt(6)
    v_mfma_f32_16x16x32_bf16 v[24:27], v[128:131], v[144:147], v[24:27]
    s_waitcnt lgkmcnt(4)
    v_mfma_f32_16x16x32_bf16 v[48:51], v[132:135], v[148:151], v[48:51]
    v_mfma_f32_16x16x32_bf16 v[68:71], v[148:151], v[136:139], v[68:71]
    v_mfma_f32_16x16x32_bf16 v[28:31], v[128:131], v[148:151], v[28:31]
    s_waitcnt lgkmcnt(2)
    v_mfma_f32_16x16x32_bf16 v[52:55], v[132:135], v[152:155], v[52:55]
    v_mfma_f32_16x16x32_bf16 v[72:75], v[152:155], v[136:139], v[72:75]
    v_mfma_f32_16x16x32_bf16 v[32:35], v[128:131], v[152:155], v[32:35]
    v_mfma_f32_16x16x32_bf16 v[80:83], v[20:23], v[152:155], v[80:83]
    v_mfma_f32_16x16x32_bf16 v[84:87], v[152:155], v[152:155], v[84:87]
    s_waitcnt lgkmcnt(0)
    v_mfma_f32_16x16x32_bf16 v[56:59], v[132:135], v[156:159], v[56:59]
    v_mfma_f32_16x16x32_bf16 v[76:79], v[156:159], v[136:139], v[76:79]
    v_mfma_f32_16x16x32_bf16 v[36:39], v[128:131], v[156:159], v[36:39]
    s_nop 7
    v_cndmask_b32 v12, v84, v85, s[48:49]
    v_cndmask_b32 v13, v86, v87, s[48:49]
    v_mul_f32 v14, s62, v80
    v_cndmask_b32 v12, v12, v13, s[50:51]
    v_cndmask_b32 v12, 0, v12, s[52:53]
    v_mov_b32 v13, v12
    s_nop 1
    v_permlane16_swap_b32 v12, v13
    v_add_f32 v12, v12, v13
    v_mov_b32 v13, v12
    s_nop 1
    v_permlane32_swap_b32 v12, v13
    v_add_f32 v12, v12, v13
    v_fma_f32 v12, v12, s63, v173
    v_fma_f32 v12, -v14, v14, v12
    v_max_f32 v12, v173, v12
    v_rsq_f32 v12, v12
    s_mov_b64 exec, 0xffff
    ds_write_b32 v164, v14 offset:384
    ds_write_b32 v164, v12 offset:448
    s_mov_b64 exec, -1
    s_waitcnt lgkmcnt(0)
    s_barrier
    s_branch A1L1_EP
A1L1_V3:
    v_mov_b32 v8, v4
    v_mov_b32 v10, v6
    s_mov_b32 s38, 1
    s_mov_b32 s39, 0
    s_waitcnt lgkmcnt(0)
    s_barrier
    ds_read_b64_tr_b16 v[100:101], v10 offset:8192
    ds_read_b64_tr_b16 v[102:103], v10 offset:8704
    ds_read_b64_tr_b16 v[108:109], v8 offset:0
    ds_read_b64_tr_b16 v[110:111], v8 offset:768
    ds_read_b64_tr_b16 v[104:105], v10 offset:16384
    ds_read_b64_tr_b16 v[106:107], v10 offset:16896
    ds_read_b64_tr_b16 v[112:113], v8 offset:32
    ds_read_b64_tr_b16 v[114:115], v8 offset:800
    ds_read_b64_tr_b16 v[96:97], v10 offset:0
    ds_read_b64_tr_b16 v[98:99], v10 offset:512
    ds_read_b64_tr_b16 v[116:117], v8 offset:64
    ds_read_b64_tr_b16 v[118:119], v8 offset:832
    ds_read_b64_tr_b16 v[120:121], v8 offset:96
    ds_read_b64_tr_b16 v[122:123], v8 offset:864
    ds_read_b64_tr_b16 v[124:125], v8 offset:128
    ds_read_b64_tr_b16 v[126:127], v8 offset:896
A1L1_LOOP3:
    s_waitcnt lgkmcnt(0)
    v_mfma_f32_16x16x32_bf16 v[40:43], v[100:103], v[108:111], v[40:43]
    s_mul_i32 s43, s38, 12288
    s_mul_i32 s44, s38, 24576
    v_mfma_f32_16x16x32_bf16 v[60:63], v[108:111], v[104:107], v[60:63]
    v_add_u32 v14, s43, v4
    v_mfma_f32_16x16x32_bf16 v[44:47], v[100:103], v[112:115], v[44:47]
    v_add_u32 v16, s44, v6
    s_add_u32 s38, s38, 1
    v_mfma_f32_16x16x32_bf16 v[64:67], v[112:115], v[104:107], v[64:67]
    s_and_b32 s38, s38, 3
    v_mfma_f32_16x16x32_bf16 v[24:27], v[96:99], v[112:115], v[24:27]
    ds_read_b64_tr_b16 v[132:133], v10 offset:12288
    ds_read_b64_tr_b16 v[134:135], v10 offset:12800
    v_mfma_f32_16x16x32_bf16 v[48:51], v[100:103], v[116:119], v[48:51]
    ds_read_b64_tr_b16 v[140:141], v8 offset:6144
    v_mfma_f32_16x16x32_bf16 v[68:71], v[116:119], v[104:107], v[68:71]
    ds_read_b64_tr_b16 v[142:143], v8 offset:6912
    ds_read_b64_tr_b16 v[136:137], v10 offset:20480
    v_mfma_f32_16x16x32_bf16 v[28:31], v[96:99], v[116:119], v[28:31]
    ds_read_b64_tr_b16 v[138:139], v10 offset:20992
    v_mfma_f32_16x16x32_bf16 v[52:55], v[100:103], v[120:123], v[52:55]
    ds_read_b64_tr_b16 v[144:145], v8 offset:6176
    ds_read_b64_tr_b16 v[146:147], v8 offset:6944
    v_mfma_f32_16x16x32_bf16 v[72:75], v[120:123], v[104:107], v[72:75]
    ds_read_b64_tr_b16 v[128:129], v10 offset:4096
    v_mfma_f32_16x16x32_bf16 v[32:35], v[96:99], v[120:123], v[32:35]
    ds_read_b64_tr_b16 v[130:131], v10 offset:4608
    ds_read_b64_tr_b16 v[148:149], v8 offset:6208
    v_mfma_f32_16x16x32_bf16 v[56:59], v[100:103], v[124:127], v[56:59]
    ds_read_b64_tr_b16 v[150:151], v8 offset:6976
    v_mfma_f32_16x16x32_bf16 v[76:79], v[124:127], v[104:107], v[76:79]
    ds_read_b64_tr_b16 v[152:153], v8 offset:6240
    ds_read_b64_tr_b16 v[154:155], v8 offset:7008
    v_mfma_f32_16x16x32_bf16 v[36:39], v[96:99], v[124:127], v[36:39]
    ds_read_b64_tr_b16 v[156:157], v8 offset:6272
    v_mfma_f32_16x16x32_bf16 v[80:83], v[20:23], v[124:127], v[80:83]
    ds_read_b64_tr_b16 v[158:159], v8 offset:7040
    v_mfma_f32_16x16x32_bf16 v[84:87], v[124:127], v[124:127], v[84:87]
    s_waitcnt lgkmcnt(0)
    s_barrier
    v_mfma_f32_16x16x32_bf16 v[40:43], v[132:135], v[140:143], v[40:43]
    ds_read_b64_tr_b16 v[100:101], v16 offset:8192
    ds_read_b64_tr_b16 v[102:103], v16 offset:8704
    v_mfma_f32_16x16x32_bf16 v[60:63], v[140:143], v[136:139], v[60:63]
    ds_read_b64_tr_b16 v[108:109], v14 offset:0
    v_mfma_f32_16x16x32_bf16 v[44:47], v[132:135], v[144:147], v[44:47]
    ds_read_b64_tr_b16 v[110:111], v14 offset:768
    ds_read_b64_tr_b16 v[104:105], v16 offset:16384
    v_mfma_f32_16x16x32_bf16 v[64:67], v[144:147], v[136:139], v[64:67]
    ds_read_b64_tr_b16 v[106:107], v16 offset:16896
    v_mfma_f32_16x16x32_bf16 v[24:27], v[128:131], v[144:147], v[24:27]
    ds_read_b64_tr_b16 v[112:113], v14 offset:32
    ds_read_b64_tr_b16 v[114:115], v14 offset:800
    v_mfma_f32_16x16x32_bf16 v[48:51], v[132:135], v[148:151], v[48:51]
    ds_read_b64_tr_b16 v[96:97], v16 offset:0
    v_mfma_f32_16x16x32_bf16 v[68:71], v[148:151], v[136:139], v[68:71]
    ds_read_b64_tr_b16 v[98:99], v16 offset:512
    ds_read_b64_tr_b16 v[116:117], v14 offset:64
    v_mfma_f32_16x16x32_bf16 v[28:31], v[128:131], v[148:151], v[28:31]
    ds_read_b64_tr_b16 v[118:119], v14 offset:832
    v_mfma_f32_16x16x32_bf16 v[52:55], v[132:135], v[152:155], v[52:55]
    ds_read_b64_tr_b16 v[120:121], v14 offset:96
    ds_read_b64_tr_b16 v[122:123], v14 offset:864
    v_mfma_f32_16x16x32_bf16 v[72:75], v[152:155], v[136:139], v[72:75]
    ds_read_b64_tr_b16 v[124:125], v14 offset:128
    v_mfma_f32_16x16x32_bf16 v[32:35], v[128:131], v[152:155], v[32:35]
    ds_read_b64_tr_b16 v[126:127], v14 offset:896
    v_mov_b32 v8, v14
    v_mfma_f32_16x16x32_bf16 v[56:59], v[132:135], v[156:159], v[56:59]
    v_mov_b32 v10, v16
    v_mfma_f32_16x16x32_bf16 v[76:79], v[156:159], v[136:139], v[76:79]
    v_mfma_f32_16x16x32_bf16 v[36:39], v[128:131], v[156:159], v[36:39]
    v_mfma_f32_16x16x32_bf16 v[80:83], v[20:23], v[156:159], v[80:83]
    v_mfma_f32_16x16x32_bf16 v[84:87], v[156:159], v[156:159], v[84:87]
    s_add_u32 s39, s39, 1
    s_cmp_lt_u32 s39, 7
    s_cbranch_scc1 A1L1_LOOP3
    s_waitcnt lgkmcnt(12)
    v_mfma_f32_16x16x32_bf16 v[40:43], v[100:103], v[108:111], v[40:43]
    ds_read_b64_tr_b16 v[132:133], v10 offset:12288
    ds_read_b64_tr_b16 v[134:135], v10 offset:12800
    s_waitcnt lgkmcnt(12)
    v_mfma_f32_16x16x32_bf16 v[60:63], v[108:111], v[104:107], v[60:63]
    ds_read_b64_tr_b16 v[140:141], v8 offset:6144
    s_waitcnt lgkmcnt(11)
    v_mfma_f32_16x16x32_bf16 v[44:47], v[100:103], v[112:115], v[44:47]
    ds_read_b64_tr_b16 v[142:143], v8 offset:6912
    ds_read_b64_tr_b16 v[136:137], v10 offset:20480
    v_mfma_f32_16x16x32_bf16 v[64:67], v[112:115], v[104:107], v[64:67]
    ds_read_b64_tr_b16 v[138:139], v10 offset:20992
    s_waitcnt lgkmcnt(12)
    v_mfma_f32_16x16x32_bf16 v[24:27], v[96:99], v[112:115], v[24:27]
    ds_read_b64_tr_b16 v[144:145], v8 offset:6176
    ds_read_b64_tr_b16 v[146:147], v8 offset:6944
    s_waitcnt lgkmcnt(12)
    v_mfma_f32_16x16x32_bf16 v[48:51], v[100:103], v[116:119], v[48:51]
    ds_read_b64_tr_b16 v[128:129], v10 offset:4096
    v_mfma_f32_16x16x32_bf16 v[68:71], v[116:119], v[104:107], v[68:71]
    ds_read_b64_tr_b16 v[130:131], v10 offset:4608
    ds_read_b64_tr_b16 v[148:149], v8 offset:6208
    v_mfma_f32_16x16x32_bf16 v[28:31], v[96:99], v[116:119], v[28:31]
    ds_read_b64_tr_b16 v[150:151], v8 offset:6976
    s_waitcnt lgkmcnt(14)
    v_mfma_f32_16x16x32_bf16 v[52:55], v[100:103], v[120:123], v[52:55]
    ds_read_b64_tr_b16 v[152:153], v8 offset:6240
    ds_read_b64_tr_b16 v[154:155], v8 offset:7008
    v_mfma_f32_16x16x32_bf16 v[72:75], v[120:123], v[104:107], v[72:75]
    ds_read_b64_tr_b16 v[156:157], v8 offset:6272
    v_mfma_f32_16x16x32_bf16 v[32:35], v[96:99], v[120:123], v[32:35]
    ds_read_b64_tr_b16 v[158:159], v8 offset:7040
    s_waitcnt lgkmcnt(14)
    v_mfma_f32_16x16x32_bf16 v[56:59], v[100:103], v[124:127], v[56:59]
    v_mfma_f32_16x16x32_bf16 v[76:79], v[124:127], v[104:107], v[76:79]
    v_mfma_f32_16x16x32_bf16 v[36:39], v[96:99], v[124:127], v[36:39]
    v_mfma_f32_16x16x32_bf16 v[80:83], v[20:23], v[124:127], v[80:83]
    v_mfma_f32_16x16x32_bf16 v[84:87], v[124:127], v[124:127], v[84:87]
    s_waitcnt lgkmcnt(12)
    v_mfma_f32_16x16x32_bf16 v[40:43], v[132:135], v[140:143], v[40:43]
    s_waitcnt lgkmcnt(10)
    v_mfma_f32_16x16x32_bf16 v[60:63], v[140:143], v[136:139], v[60:63]
    s_waitcnt lgkmcnt(8)
    v_mfma_f32_16x16x32_bf16 v[44:47], v[132:135], v[144:147], v[44:47]
    v_mfma_f32_16x16x32_bf16 v[64:67], v[144:147], v[136:139], v[64:67]
    s_waitcnt lgkmcnt(6)
    v_mfma_f32_16x16x32_bf16 v[24:27], v[128:131], v[144:147], v[24:27]
    s_waitcnt lgkmcnt(4)
    v_mfma_f32_16x16x32_bf16 v[48:51], v[132:135], v[148:151], v[48:51]
    v_mfma_f32_16x16x32_bf16 v[68:71], v[148:151], v[136:139], v[68:71]
    v_mfma_f32_16x16x32_bf16 v[28:31], v[128:131], v[148:151], v[28:31]
    s_waitcnt lgkmcnt(2)
    v_mfma_f32_16x16x32_bf16 v[52:55], v[132:135], v[152:155], v[52:55]
    v_mfma_f32_16x16x32_bf16 v[72:75], v[152:155], v[136:139], v[72:75]
    v_mfma_f32_16x16x32_bf16 v[32:35], v[128:131], v[152:155], v[32:35]
    s_waitcnt lgkmcnt(0)
    v_mfma_f32_16x16x32_bf16 v[56:59], v[132:135], v[156:159], v[56:59]
    v_mfma_f32_16x16x32_bf16 v[76:79], v[156:159], v[136:139], v[76:79]
    v_mfma_f32_16x16x32_bf16 v[36:39], v[128:131], v[156:159], v[36:39]
    v_mfma_f32_16x16x32_bf16 v[80:83], v[20:23], v[156:159], v[80:83]
    v_mfma_f32_16x16x32_bf16 v[84:87], v[156:159], v[156:159], v[84:87]
    s_nop 7
    v_cndmask_b32 v12, v84, v85, s[48:49]
    v_cndmask_b32 v13, v86, v87, s[48:49]
    v_mul_f32 v14, s62, v80
    v_cndmask_b32 v12, v12, v13, s[50:51]
    v_cndmask_b32 v12, 0, v12, s[52:53]
    v_mov_b32 v13, v12
    s_nop 1
    v_permlane16_swap_b32 v12, v13
    v_add_f32 v12, v12, v13
    v_mov_b32 v13, v12
    s_nop 1
    v_permlane32_swap_b32 v12, v13
    v_add_f32 v12, v12, v13
    v_fma_f32 v12, v12, s63, v173
    v_fma_f32 v12, -v14, v14, v12
    v_max_f32 v12, v173, v12
    v_rsq_f32 v12, v12
    s_mov_b64 exec, 0xffff
    ds_write_b32 v164, v14 offset:512
    ds_write_b32 v164, v12 offset:576
    s_mov_b64 exec, -1
    s_waitcnt lgkmcnt(0)
    s_barrier
    s_branch A1L1_EP
A1L1_EP:
    ds_read_b32 v96, v164 offset:0
    ds_read_b32 v97, v164 offset:64
    ds_read_b32 v106, v164 offset:128
    ds_read_b32 v107, v164 offset:192
    ds_read_b32 v116, v164 offset:256
    ds_read_b32 v117, v164 offset:320
    ds_read_b32 v126, v164 offset:384
    ds_read_b32 v127, v164 offset:448
    ds_read_b32 v136, v164 offset:512
    ds_read_b32 v137, v164 offset:576
    ds_read_b128 v[98:101], v166 offset:0
    ds_read_b128 v[102:105], v166 offset:64
    ds_read_b128 v[108:111], v166 offset:128
    ds_read_b128 v[112:115], v166 offset:192
    ds_read_b128 v[118:121], v166 offset:256
    ds_read_b128 v[122:125], v166 offset:320
    ds_read_b128 v[128:131], v166 offset:384
    ds_read_b128 v[132:135], v166 offset:448
    ds_read_b128 v[138:141], v166 offset:512
    ds_read_b128 v[142:145], v166 offset:576
    s_waitcnt lgkmcnt(14)
    v_mul_f32 v96, s62, v96
    v_fma_f32 v97, v97, s63, v173
    v_fma_f32 v97, -v96, v96, v97
    v_max_f32 v97, v173, v97
    v_rsq_f32 v97, v97
    s_nop 0
    v_pk_fma_f32 v[40:41], v[96:97], v[180:181], v[40:41] op_sel:[0,0,0] op_sel_hi:[0,1,1]
    v_pk_fma_f32 v[44:45], v[106:107], v[180:181], v[44:45] op_sel:[0,0,0] op_sel_hi:[0,1,1]
    v_pk_fma_f32 v[48:49], v[116:117], v[180:181], v[48:49] op_sel:[0,0,0] op_sel_hi:[0,1,1]
    s_waitcnt lgkmcnt(12)
    v_pk_fma_f32 v[52:53], v[126:127], v[180:181], v[52:53] op_sel:[0,0,0] op_sel_hi:[0,1,1]
    s_waitcnt lgkmcnt(10)
    v_pk_fma_f32 v[56:57], v[136:137], v[180:181], v[56:57] op_sel:[0,0,0] op_sel_hi:[0,1,1]
    v_pk_fma_f32 v[24:25], v[106:107], v[176:177], v[24:25] op_sel:[0,0,0] op_sel_hi:[0,1,1]
    v_pk_fma_f32 v[28:29], v[116:117], v[176:177], v[28:29] op_sel:[0,0,0] op_sel_hi:[0,1,1]
    v_pk_fma_f32 v[32:33], v[126:127], v[176:177], v[32:33] op_sel:[0,0,0] op_sel_hi:[0,1,1]
    v_pk_fma_f32 v[36:37], v[136:137], v[176:177], v[36:37] op_sel:[0,0,0] op_sel_hi:[0,1,1]
    v_pk_fma_f32 v[42:43], v[96:97], v[182:183], v[42:43] op_sel:[0,0,0] op_sel_hi:[0,1,1]
    v_pk_fma_f32 v[46:47], v[106:107], v[182:183], v[46:47] op_sel:[0,0,0] op_sel_hi:[0,1,1]
    v_pk_fma_f32 v[50:51], v[116:117], v[182:183], v[50:51] op_sel:[0,0,0] op_sel_hi:[0,1,1]
    v_pk_fma_f32 v[54:55], v[126:127], v[182:183], v[54:55] op_sel:[0,0,0] op_sel_hi:[0,1,1]
    v_pk_fma_f32 v[58:59], v[136:137], v[182:183], v[58:59] op_sel:[0,0,0] op_sel_hi:[0,1,1]
    v_pk_fma_f32 v[26:27], v[106:107], v[178:179], v[26:27] op_sel:[0,0,0] op_sel_hi:[0,1,1]
    v_pk_fma_f32 v[30:31], v[116:117], v[178:179], v[30:31] op_sel:[0,0,0] op_sel_hi:[0,1,1]
    v_pk_fma_f32 v[34:35], v[126:127], v[178:179], v[34:35] op_sel:[0,0,0] op_sel_hi:[0,1,1]
    v_pk_fma_f32 v[38:39], v[136:137], v[178:179], v[38:39] op_sel:[0,0,0] op_sel_hi:[0,1,1]
    v_pk_mul_f32 v[40:41], v[96:97], v[40:41] op_sel:[1,0] op_sel_hi:[1,1]
    v_pk_mul_f32 v[44:45], v[106:107], v[44:45] op_sel:[1,0] op_sel_hi:[1,1]
    v_pk_mul_f32 v[48:49], v[116:117], v[48:49] op_sel:[1,0] op_sel_hi:[1,1]
    v_pk_mul_f32 v[52:53], v[126:127], v[52:53] op_sel:[1,0] op_sel_hi:[1,1]
    v_pk_mul_f32 v[56:57], v[136:137], v[56:57] op_sel:[1,0] op_sel_hi:[1,1]
    v_cvt_pk_bf16_f32 v192, v24, v25
    v_cvt_pk_bf16_f32 v194, v28, v29
    v_cvt_pk_bf16_f32 v196, v32, v33
    v_cvt_pk_bf16_f32 v198, v36, v37
    v_pk_mul_f32 v[42:43], v[96:97], v[42:43] op_sel:[1,0] op_sel_hi:[1,1]
    v_pk_mul_f32 v[46:47], v[106:107], v[46:47] op_sel:[1,0] op_sel_hi:[1,1]
    v_pk_mul_f32 v[50:51], v[116:117], v[50:51] op_sel:[1,0] op_sel_hi:[1,1]
    v_pk_mul_f32 v[54:55], v[126:127], v[54:55] op_sel:[1,0] op_sel_hi:[1,1]
    v_pk_mul_f32 v[58:59], v[136:137], v[58:59] op_sel:[1,0] op_sel_hi:[1,1]
    v_cvt_pk_bf16_f32 v193, v26, v27
    v_cvt_pk_bf16_f32 v195, v30, v31
    v_cvt_pk_bf16_f32 v197, v34, v35
    v_cvt_pk_bf16_f32 v199, v38, v39
    v_cvt_pk_bf16_f32 v200, v40, v41
    v_cvt_pk_bf16_f32 v202, v44, v45
    v_cvt_pk_bf16_f32 v204, v48, v49
    v_cvt_pk_bf16_f32 v206, v52, v53
    v_cvt_pk_bf16_f32 v208, v56, v57
    v_cvt_pk_bf16_f32 v201, v42, v43
    v_cvt_pk_bf16_f32 v203, v46, v47
    v_cvt_pk_bf16_f32 v205, v50, v51
    v_cvt_pk_bf16_f32 v207, v54, v55
    v_cvt_pk_bf16_f32 v209, v58, v59
    v_mul_f32 v245, s61, v107
    v_mul_f32 v246, s61, v117
    v_mul_f32 v247, s61, v127
    v_mul_f32 v248, s61, v137
    v_mfma_f32_16x16x16_bf16 v[24:27], v[202:203], v[192:193], 0
    v_mfma_f32_16x16x16_bf16 v[44:47], v[200:201], v[192:193], 0
    v_mfma_f32_16x16x16_bf16 v[28:31], v[204:205], v[194:195], 0
    v_mfma_f32_16x16x16_bf16 v[48:51], v[202:203], v[194:195], 0
    v_mfma_f32_16x16x16_bf16 v[32:35], v[206:207], v[196:197], 0
    v_mfma_f32_16x16x16_bf16 v[52:55], v[204:205], v[196:197], 0
    v_mfma_f32_16x16x16_bf16 v[36:39], v[208:209], v[198:199], 0
    v_mfma_f32_16x16x16_bf16 v[56:59], v[206:207], v[198:199], 0
    s_waitcnt lgkmcnt(9)
    v_pk_mul_f32 v[98:99], v[98:99], v[174:175] op_sel:[0,0] op_sel_hi:[1,0]
    v_pk_mul_f32 v[100:101], v[100:101], v[174:175] op_sel:[0,0] op_sel_hi:[1,0]
    s_waitcnt lgkmcnt(8)
    v_pk_fma_f32 v[102:103], v[102:103], v[174:175], v[172:173] op_sel:[0,1,1] op_sel_hi:[1,1,1]
    v_pk_fma_f32 v[104:105], v[104:105], v[174:175], v[172:173] op_sel:[0,1,1] op_sel_hi:[1,1,1]
    v_pk_fma_f32 v[102:103], v[98:99], v[98:99], v[102:103] neg_lo:[1,0,0] neg_hi:[1,0,0]
    v_pk_fma_f32 v[104:105], v[100:101], v[100:101], v[104:105] neg_lo:[1,0,0] neg_hi:[1,0,0]
    v_max_f32 v102, v173, v102
    v_max_f32 v103, v173, v103
    v_max_f32 v104, v173, v104
    v_max_f32 v105, v173, v105
    v_rsq_f32 v102, v102
    v_rsq_f32 v103, v103
    v_rsq_f32 v104, v104
    v_rsq_f32 v105, v105
    v_pk_fma_f32 v[60:61], v[98:99], v[184:185], v[60:61] op_sel:[0,0,0] op_sel_hi:[1,0,1]
    s_waitcnt lgkmcnt(7)
    v_pk_fma_f32 v[64:65], v[108:109], v[184:185], v[64:65] op_sel:[0,0,0] op_sel_hi:[1,0,1]
    s_waitcnt lgkmcnt(5)
    v_pk_fma_f32 v[68:69], v[118:119], v[184:185], v[68:69] op_sel:[0,0,0] op_sel_hi:[1,0,1]
    s_waitcnt lgkmcnt(3)
    v_pk_fma_f32 v[72:73], v[128:129], v[184:185], v[72:73] op_sel:[0,0,0] op_sel_hi:[1,0,1]
    s_waitcnt lgkmcnt(1)
    v_pk_fma_f32 v[76:77], v[138:139], v[184:185], v[76:77] op_sel:[0,0,0] op_sel_hi:[1,0,1]
    v_pk_fma_f32 v[62:63], v[100:101], v[184:185], v[62:63] op_sel:[0,0,0] op_sel_hi:[1,0,1]
    v_pk_fma_f32 v[66:67], v[110:111], v[184:185], v[66:67] op_sel:[0,0,0] op_sel_hi:[1,0,1]
    v_pk_fma_f32 v[70:71], v[120:121], v[184:185], v[70:71] op_sel:[0,0,0] op_sel_hi:[1,0,1]
    v_pk_fma_f32 v[74:75], v[130:131], v[184:185], v[74:75] op_sel:[0,0,0] op_sel_hi:[1,0,1]
    v_pk_fma_f32 v[78:79], v[140:141], v[184:185], v[78:79] op_sel:[0,0,0] op_sel_hi:[1,0,1]
    v_pk_mul_f32 v[60:61], v[102:103], v[60:61]
    v_pk_mul_f32 v[64:65], v[112:113], v[64:65]
    v_pk_mul_f32 v[68:69], v[122:123], v[68:69]
    v_pk_mul_f32 v[72:73], v[132:133], v[72:73]
    s_waitcnt lgkmcnt(0)
    v_pk_mul_f32 v[76:77], v[142:143], v[76:77]
    v_pk_mul_f32 v[62:63], v[104:105], v[62:63]
    v_pk_mul_f32 v[66:67], v[114:115], v[66:67]
    v_pk_mul_f32 v[70:71], v[124:125], v[70:71]
    v_pk_mul_f32 v[74:75], v[134:135], v[74:75]
    v_pk_mul_f32 v[78:79], v[144:145], v[78:79]
    v_cvt_pk_bf16_f32 v210, v60, v61
    v_cvt_pk_bf16_f32 v212, v64, v65
    v_cvt_pk_bf16_f32 v214, v68, v69
    v_cvt_pk_bf16_f32 v216, v72, v73
    v_cvt_pk_bf16_f32 v218, v76, v77
    v_cvt_pk_bf16_f32 v211, v62, v63
    v_cvt_pk_bf16_f32 v213, v66, v67
    v_cvt_pk_bf16_f32 v215, v70, v71
    v_cvt_pk_bf16_f32 v217, v74, v75
    v_cvt_pk_bf16_f32 v219, v78, v79
    s_cmp_lg_u32 s31, 0
    s_cbranch_scc1 A1L1_NOTFIRST
    v_mov_b32 v44, 0xf149f2ca
    v_mov_b32 v45, 0xf149f2ca
    v_mov_b32 v46, 0xf149f2ca
    v_mov_b32 v47, 0xf149f2ca
A1L1_NOTFIRST:
    v_cndmask_b32 v97, v24, v25, s[48:49]
    v_cndmask_b32 v109, v28, v29, s[48:49]
    v_cndmask_b32 v121, v32, v33, s[48:49]
    v_cndmask_b32 v133, v36, v37, s[48:49]
    v_cndmask_b32 v98, v44, v45, s[48:49]
    v_cndmask_b32 v110, v48, v49, s[48:49]
    v_cndmask_b32 v122, v52, v53, s[48:49]
    v_cndmask_b32 v134, v56, v57, s[48:49]
    v_cndmask_b32 v99, v26, v27, s[48:49]
    v_cndmask_b32 v111, v30, v31, s[48:49]
    v_cndmask_b32 v123, v34, v35, s[48:49]
    v_cndmask_b32 v135, v38, v39, s[48:49]
    v_cndmask_b32 v100, v46, v47, s[48:49]
    v_cndmask_b32 v112, v50, v51, s[48:49]
    v_cndmask_b32 v124, v54, v55, s[48:49]
    v_cndmask_b32 v136, v58, v59, s[48:49]
    v_cndmask_b32 v97, v98, v97, s[56:57]
    v_cndmask_b32 v109, v110, v109, s[56:57]
    v_cndmask_b32 v121, v122, v121, s[56:57]
    v_cndmask_b32 v133, v134, v133, s[56:57]
    v_cndmask_b32 v98, v100, v99, s[58:59]
    v_cndmask_b32 v110, v112, v111, s[58:59]
    v_cndmask_b32 v122, v124, v123, s[58:59]
    v_cndmask_b32 v134, v136, v135, s[58:59]
    v_mul_f32 v97, v97, v245
    v_mul_f32 v109, v109, v246
    v_mul_f32 v121, v121, v247
    v_mul_f32 v133, v133, v248
    v_mul_f32 v98, v98, v245
    v_mul_f32 v110, v110, v246
    v_mul_f32 v122, v122, v247
    v_mul_f32 v134, v134, v248
    v_max_f32 v99, v97, v98
    v_max_f32 v111, v109, v110
    v_max_f32 v123, v121, v122
    v_max_f32 v135, v133, v134
    v_mov_b32 v100, v99
    v_mov_b32 v112, v111
    v_mov_b32 v124, v123
    v_mov_b32 v136, v135
    v_permlane16_swap_b32 v99, v100
    v_permlane16_swap_b32 v111, v112
    v_permlane16_swap_b32 v123, v124
    v_permlane16_swap_b32 v135, v136
    v_max_f32 v99, v99, v100
    v_max_f32 v111, v111, v112
    v_max_f32 v123, v123, v124
    v_max_f32 v135, v135, v136
    v_mov_b32 v100, v99
    v_mov_b32 v112, v111
    v_mov_b32 v124, v123
    v_mov_b32 v136, v135
    v_permlane32_swap_b32 v99, v100
    v_permlane32_swap_b32 v111, v112
    v_permlane32_swap_b32 v123, v124
    v_permlane32_swap_b32 v135, v136
    v_max_f32 v99, v99, v100
    v_max_f32 v111, v111, v112
    v_max_f32 v123, v123, v124
    v_max_f32 v135, v135, v136
    v_sub_f32 v97, v97, v99
    v_sub_f32 v109, v109, v111
    v_sub_f32 v121, v121, v123
    v_sub_f32 v133, v133, v135
    v_sub_f32 v98, v98, v99
    v_sub_f32 v110, v110, v111
    v_sub_f32 v122, v122, v123
    v_sub_f32 v134, v134, v135
    v_exp_f32 v97, v97
    v_exp_f32 v109, v109
    v_exp_f32 v121, v121
    v_exp_f32 v133, v133
    v_exp_f32 v98, v98
    v_exp_f32 v110, v110
    v_exp_f32 v122, v122
    v_exp_f32 v134, v134
    v_cvt_pk_bf16_f32 v97, v97, v97
    v_cvt_pk_bf16_f32 v109, v109, v109
    v_cvt_pk_bf16_f32 v121, v121, v121
    v_cvt_pk_bf16_f32 v133, v133, v133
    v_cvt_pk_bf16_f32 v98, v98, v98
    v_cvt_pk_bf16_f32 v110, v110, v110
    v_cvt_pk_bf16_f32 v122, v122, v122
    v_cvt_pk_bf16_f32 v134, v134, v134
    v_and_b32 v102, v97, v160
    v_and_b32 v114, v109, v160
    v_and_b32 v126, v121, v160
    v_and_b32 v138, v133, v160
    v_and_b32 v103, v98, v162
    v_and_b32 v115, v110, v162
    v_and_b32 v127, v122, v162
    v_and_b32 v139, v134, v162
    v_and_b32 v104, v97, v161
    v_and_b32 v116, v109, v161
    v_and_b32 v128, v121, v161
    v_and_b32 v140, v133, v161
    v_and_b32 v105, v98, v163
    v_and_b32 v117, v110, v163
    v_and_b32 v129, v122, v163
    v_and_b32 v141, v134, v163
    v_mfma_f32_16x16x16_bf16 v[64:67], v[212:213], v[102:103], 0
    v_mfma_f32_16x16x16_bf16 v[68:71], v[214:215], v[114:115], 0
    v_mfma_f32_16x16x16_bf16 v[72:75], v[216:217], v[126:127], 0
    v_mfma_f32_16x16x16_bf16 v[76:79], v[218:219], v[138:139], 0
    v_mfma_f32_16x16x16_bf16 v[144:147], v[20:21], v[102:103], 0
    v_mfma_f32_16x16x16_bf16 v[148:151], v[20:21], v[114:115], 0
    v_mfma_f32_16x16x16_bf16 v[152:155], v[20:21], v[126:127], 0
    v_mfma_f32_16x16x16_bf16 v[156:159], v[20:21], v[138:139], 0
    v_mfma_f32_16x16x16_bf16 v[64:67], v[210:211], v[104:105], v[64:67]
    v_mfma_f32_16x16x16_bf16 v[68:71], v[212:213], v[116:117], v[68:71]
    v_mfma_f32_16x16x16_bf16 v[72:75], v[214:215], v[128:129], v[72:75]
    v_mfma_f32_16x16x16_bf16 v[76:79], v[216:217], v[140:141], v[76:79]
    v_mfma_f32_16x16x16_bf16 v[144:147], v[20:21], v[104:105], v[144:147]
    v_mfma_f32_16x16x16_bf16 v[148:151], v[20:21], v[116:117], v[148:151]
    v_mfma_f32_16x16x16_bf16 v[152:155], v[20:21], v[128:129], v[152:155]
    v_mfma_f32_16x16x16_bf16 v[156:159], v[20:21], v[140:141], v[156:159]
    s_nop 4
    v_rcp_f32 v226, v144
    v_rcp_f32 v228, v148
    v_rcp_f32 v230, v152
    v_rcp_f32 v232, v156
    v_pk_mul_f32 v[64:65], v[226:227], v[64:65] op_sel:[0,0] op_sel_hi:[0,1]
    v_pk_mul_f32 v[68:69], v[228:229], v[68:69] op_sel:[0,0] op_sel_hi:[0,1]
    v_pk_mul_f32 v[72:73], v[230:231], v[72:73] op_sel:[0,0] op_sel_hi:[0,1]
    v_pk_mul_f32 v[76:77], v[232:233], v[76:77] op_sel:[0,0] op_sel_hi:[0,1]
    v_pk_mul_f32 v[66:67], v[226:227], v[66:67] op_sel:[0,0] op_sel_hi:[0,1]
    v_pk_mul_f32 v[70:71], v[228:229], v[70:71] op_sel:[0,0] op_sel_hi:[0,1]
    v_pk_mul_f32 v[74:75], v[230:231], v[74:75] op_sel:[0,0] op_sel_hi:[0,1]
    v_pk_mul_f32 v[78:79], v[232:233], v[78:79] op_sel:[0,0] op_sel_hi:[0,1]
    v_cvt_pk_bf16_f32 v236, v64, v65
    v_cvt_pk_bf16_f32 v238, v68, v69
    v_cvt_pk_bf16_f32 v240, v72, v73
    v_cvt_pk_bf16_f32 v242, v76, v77
    v_cvt_pk_bf16_f32 v237, v66, v67
    v_cvt_pk_bf16_f32 v239, v70, v71
    v_cvt_pk_bf16_f32 v241, v74, v75
    v_cvt_pk_bf16_f32 v243, v78, v79
    ds_write_b64 v167, v[236:237] offset:0
    ds_write_b64 v167, v[238:239] offset:2304
    ds_write_b64 v167, v[240:241] offset:4608
    ds_write_b64 v167, v[242:243] offset:6912
    s_waitcnt vmcnt(0) lgkmcnt(0)
    s_barrier
A1L1_ST:
    ds_read_b128 v[64:67], v170
    s_waitcnt lgkmcnt(0)
    buffer_store_dwordx4 v[64:67], v171, s[20:23], s36 offen sc1
    s_lshl_b32 s82, s31, 3
    s_add_u32 s82, s82, s32
    s_lshl_b32 s82, s82, 7
    s_add_u32 s82, s82, 98304
    s_waitcnt vmcnt(0)
    s_barrier
    s_cmp_lg_u32 s28, 0
    s_cbranch_scc1 H1S1
    v_mov_b32 v250, s34
    v_mov_b32 v251, s82
    s_mov_b64 exec, 1
    buffer_store_dword v250, v251, s[72:75], 0 offen sc1
    s_mov_b64 exec, -1
H1S1:
    s_lshl_b32 s81, s31, 6
    v_mov_b32 v4, 0
    v_mov_b32 v5, 0
    v_mov_b32 v6, 0
    v_mov_b32 v7, 0
    v_mov_b32 v22, 0
    v_mov_b32 v23, 0
    s_cmp_lt_u32 s28, 4
    s_cbranch_scc1 A2L1_SC
    s_sub_u32 s79, s28, 4
    s_lshl_b32 s35, s79, 4
    v_add_u32 v11, s35, v3
    v_add_u32 v13, s81, v11
    v_lshlrev_b32 v13, 10, v13
    v_xor_b32 v12, v3, v2
    v_lshlrev_b32 v12, 4, v12
    v_add_u32 v4, v13, v12
    v_add_u32 v13, 4096, v13
    v_xor_b32 v12, v3, v2
    v_xor_b32 v12, 4, v12
    v_lshlrev_b32 v12, 4, v12
    v_add_u32 v5, v13, v12
    v_add_u32 v13, 4096, v13
    v_xor_b32 v12, v3, v2
    v_xor_b32 v12, 8, v12
    v_lshlrev_b32 v12, 4, v12
    v_add_u32 v6, v13, v12
    v_add_u32 v13, 4096, v13
    v_xor_b32 v12, v3, v2
    v_xor_b32 v12, 12, v12
    v_lshlrev_b32 v12, 4, v12
    v_add_u32 v7, v13, v12
    s_lshl_b32 s40, s79, 12
    s_add_u32 s12, s8, 6815744
    s_addc_u32 s13, s9, 0
    s_mov_b32 s14, 2097152
    s_mov_b32 s15, 0x20000
    s_branch A2L1_SD
A2L1_SC:
    s_and_b32 s79, s28, 1
    s_lshr_b32 s80, s28, 1
    s_lshl_b32 s35, s79, 5
    s_add_u32 s35, s35, s81
    v_lshlrev_b32 v11, 2, v3
    v_add_u32 v11, s35, v11
    s_lshl_b32 s36, s32, 6
    s_lshl_b32 s37, s80, 5
    s_add_u32 s36, s36, s37
    v_add_u32 v13, s36, v2
    s_add_u32 s20, s8, 11010048
    s_addc_u32 s21, s9, 0
    s_mov_b32 s22, 2097152
    s_mov_b32 s23, 0x20000
    v_lshlrev_b32 v12, 12, v13
    v_lshlrev_b32 v14, 1, v11
    v_add_u32 v8, v12, v14
    s_mov_b32 s84, 0
    s_mov_b32 s85, 65536
    v_mul_u32_u24 v14, 144, v2
    v_lshlrev_b32 v15, 3, v3
    v_add_u32 v14, v14, v15
    s_mul_i32 s35, s80, 4608
    s_lshl_b32 s36, s79, 6
    s_add_u32 s35, s35, s36
    s_add_u32 s35, s35, 147712
    v_add_u32 v9, s35, v14
    s_lshl_b32 s35, s79, 5
    v_add_u32 v11, s35, v2
    v_lshlrev_b32 v11, 8, v11
    v_xor_b32 v12, v3, v2
    v_lshlrev_b32 v12, 4, v12
    v_add_u32 v16, v11, v12
    v_add_u32 v4, 114688, v16
    v_xor_b32 v12, v3, v2
    v_xor_b32 v12, 4, v12
    v_lshlrev_b32 v12, 4, v12
    v_add_u32 v17, v11, v12
    v_add_u32 v5, 114688, v17
    v_xor_b32 v12, v3, v2
    v_xor_b32 v12, 8, v12
    v_lshlrev_b32 v12, 4, v12
    v_add_u32 v18, v11, v12
    v_add_u32 v6, 114688, v18
    v_xor_b32 v12, v3, v2
    v_xor_b32 v12, 12, v12
    v_lshlrev_b32 v12, 4, v12
    v_add_u32 v19, v11, v12
    v_add_u32 v7, 114688, v19
    v_lshrrev_b32 v11, 2, v2
    v_lshlrev_b32 v12, 3, v3
    v_add_u32 v12, v12, v11
    v_lshlrev_b32 v12, 7, v12
    v_lshrrev_b32 v11, 1, v11
    v_and_b32 v13, 1, v3
    v_lshlrev_b32 v13, 1, v13
    v_or_b32 v11, v11, v13
    s_lshl_b32 s35, s80, 1
    v_xor_b32 v11, s35, v11
    v_lshlrev_b32 v13, 5, v11
    v_and_b32 v14, 3, v1
    v_lshlrev_b32 v14, 3, v14
    v_add_u32 v12, v12, v14
    v_add_u32 v12, 49152, v12
    v_add_u32 v20, v12, v13
    v_xor_b32 v13, 32, v13
    v_add_u32 v21, v12, v13
    v_mov_b32 v24, 0
    v_mov_b32 v25, 0
    v_mov_b32 v26, 0
    v_mov_b32 v27, 0
    v_mov_b32 v28, 0
    v_mov_b32 v29, 0
    v_mov_b32 v30, 0
    v_mov_b32 v31, 0
    v_mov_b32 v32, 0
    v_mov_b32 v33, 0
    v_mov_b32 v34, 0
    v_mov_b32 v35, 0
    v_mov_b32 v36, 0
    v_mov_b32 v37, 0
    v_mov_b32 v38, 0
    v_mov_b32 v39, 0
    v_lshrrev_b32 v14, 3, v1
    s_lshl_b32 s35, s28, 3
    v_add_u32 v14, s35, v14
    v_and_b32 v15, 7, v1
    v_lshlrev_b32 v15, 4, v15
    v_mul_u32_u24 v12, 144, v14
    v_add_u32 v12, v12, v15
    v_add_u32 v22, 147712, v12
    v_lshlrev_b32 v14, 12, v14
    v_add_u32 v23, v14, v15
    s_lshl_b32 s83, s32, 18
    s_lshl_b32 s35, s81, 1
    s_add_u32 s83, s83, s35
A2L1_SD:
    s_cmp_lg_u32 s28, 5
    s_cbranch_scc1 PRM_A1
    s_lshl_b32 s95, s32, 18
PRM_A1:
    s_cmp_lt_u32 s28, 4
    s_cbranch_scc1 H1NW1
    s_waitcnt vmcnt(0) lgkmcnt(0)
H1NW1:
    s_lshl_b32 s82, s31, 10
    s_add_u32 s82, s82, 98304
    s_cmp_lg_u32 s28, 0
    s_cbranch_scc1 H1W1_D
    v_lshlrev_b32 v250, 7, v1
    v_add_u32 v250, s82, v250
    s_mov_b64 exec, 0xff
    s_mov_b32 s90, 0
H1W1_P:
    buffer_load_dword v246, v250, s[72:75], 0 offen sc1
    s_waitcnt vmcnt(0)
    v_cmp_eq_u32 vcc, s34, v246
    s_nop 0
    s_cmp_eq_u64 vcc, exec
    s_cbranch_scc1 H1W1_X
    s_sleep 2
    s_add_u32 s90, s90, 1
    s_cmp_lt_u32 s90, 200000
    s_cbranch_scc1 H1W1_P
H1W1_X:
    s_mov_b64 exec, -1
H1W1_D:
    s_barrier
A2L1_BEGIN:
    s_cmp_lt_u32 s28, 4
    s_cbranch_scc1 A2L1_C
    s_add_u32 m0, s40, 0
    s_mov_b32 s44, 0
    buffer_load_dwordx4 v4, s[12:15], s44 offen sc1 lds
    s_add_u32 m0, s40, 1024
    s_mov_b32 s44, 0
    buffer_load_dwordx4 v5, s[12:15], s44 offen sc1 lds
    s_add_u32 m0, s40, 2048
    s_mov_b32 s44, 0
    buffer_load_dwordx4 v6, s[12:15], s44 offen sc1 lds
    s_add_u32 m0, s40, 3072
    s_mov_b32 s44, 0
    buffer_load_dwordx4 v7, s[12:15], s44 offen sc1 lds
    s_add_u32 m0, s40, 16384
    s_mov_b32 s44, 256
    buffer_load_dwordx4 v4, s[12:15], s44 offen sc1 lds
    s_add_u32 m0, s40, 17408
    s_mov_b32 s44, 256
    buffer_load_dwordx4 v5, s[12:15], s44 offen sc1 lds
    s_add_u32 m0, s40, 18432
    s_mov_b32 s44, 256
    buffer_load_dwordx4 v6, s[12:15], s44 offen sc1 lds
    s_add_u32 m0, s40, 19456
    s_mov_b32 s44, 256
    buffer_load_dwordx4 v7, s[12:15], s44 offen sc1 lds
    s_add_u32 m0, s40, 32768
    s_mov_b32 s44, 512
    buffer_load_dwordx4 v4, s[12:15], s44 offen sc1 lds
    s_add_u32 m0, s40, 33792
    s_mov_b32 s44, 512
    buffer_load_dwordx4 v5, s[12:15], s44 offen sc1 lds
    s_add_u32 m0, s40, 34816
    s_mov_b32 s44, 512
    buffer_load_dwordx4 v6, s[12:15], s44 offen sc1 lds
    s_add_u32 m0, s40, 35840
    s_mov_b32 s44, 512
    buffer_load_dwordx4 v7, s[12:15], s44 offen sc1 lds
    s_add_u32 m0, s40, 114688
    s_mov_b32 s44, 768
    buffer_load_dwordx4 v4, s[12:15], s44 offen sc1 lds
    s_add_u32 m0, s40, 115712
    s_mov_b32 s44, 768
    buffer_load_dwordx4 v5, s[12:15], s44 offen sc1 lds
    s_add_u32 m0, s40, 116736
    s_mov_b32 s44, 768
    buffer_load_dwordx4 v6, s[12:15], s44 offen sc1 lds
    s_add_u32 m0, s40, 117760
    s_mov_b32 s44, 768
    buffer_load_dwordx4 v7, s[12:15], s44 offen sc1 lds
    s_waitcnt vmcnt(12)
    s_barrier
    s_waitcnt vmcnt(8)
    s_barrier
    s_waitcnt vmcnt(4)
    s_barrier
    s_waitcnt vmcnt(0)
    s_barrier
    v_lshrrev_b32 v14, 3, v1
    s_lshl_b32 s35, s28, 3
    v_add_u32 v14, s35, v14
    v_and_b32 v15, 7, v1
    v_lshlrev_b32 v15, 4, v15
    v_mul_u32_u24 v12, 144, v14
    v_add_u32 v12, v12, v15
    v_add_u32 v22, 147712, v12
    v_lshlrev_b32 v14, 12, v14
    v_add_u32 v23, v14, v15
    s_lshl_b32 s83, s32, 18
    s_lshl_b32 s35, s81, 1
    s_add_u32 s83, s83, s35
    s_barrier
    s_branch A2L1_ST
A2L1_C:
    buffer_load_dwordx2 v[80:81], v8, s[20:23], s84 offen offset:0 sc1
    buffer_load_dwordx2 v[82:83], v8, s[20:23], s85 offen offset:0 sc1
    buffer_load_dwordx2 v[84:85], v8, s[20:23], s84 offen offset:32 sc1
    buffer_load_dwordx2 v[86:87], v8, s[20:23], s85 offen offset:32 sc1
    ds_read_b64_tr_b16 v[48:49], v20 offset:0
    ds_read_b64_tr_b16 v[50:51], v20 offset:512
    ds_read_b64_tr_b16 v[52:53], v21 offset:0
    ds_read_b64_tr_b16 v[54:55], v21 offset:512
    s_barrier
    ds_read_b128 v[40:43], v16 offset:0
    ds_read_b128 v[44:47], v16 offset:4096
    s_waitcnt lgkmcnt(1)
    v_mfma_f32_16x16x32_bf16 v[24:27], v[40:43], v[48:51], v[24:27]
    ds_read_b128 v[88:91], v17 offset:0
    ds_read_b128 v[92:95], v17 offset:4096
    v_mfma_f32_16x16x32_bf16 v[28:31], v[40:43], v[52:55], v[28:31]
    ds_read_b64_tr_b16 v[96:97], v20 offset:4096
    ds_read_b64_tr_b16 v[98:99], v20 offset:4608
    s_waitcnt lgkmcnt(4)
    v_mfma_f32_16x16x32_bf16 v[32:35], v[44:47], v[48:51], v[32:35]
    ds_read_b64_tr_b16 v[100:101], v21 offset:4096
    ds_read_b64_tr_b16 v[102:103], v21 offset:4608
    v_mfma_f32_16x16x32_bf16 v[36:39], v[44:47], v[52:55], v[36:39]
    s_waitcnt lgkmcnt(2)
    v_mfma_f32_16x16x32_bf16 v[24:27], v[88:91], v[96:99], v[24:27]
    ds_read_b128 v[40:43], v18 offset:0
    ds_read_b128 v[44:47], v18 offset:4096
    s_waitcnt lgkmcnt(2)
    v_mfma_f32_16x16x32_bf16 v[28:31], v[88:91], v[100:103], v[28:31]
    ds_read_b64_tr_b16 v[48:49], v20 offset:8192
    ds_read_b64_tr_b16 v[50:51], v20 offset:8704
    v_mfma_f32_16x16x32_bf16 v[32:35], v[92:95], v[96:99], v[32:35]
    ds_read_b64_tr_b16 v[52:53], v21 offset:8192
    ds_read_b64_tr_b16 v[54:55], v21 offset:8704
    v_mfma_f32_16x16x32_bf16 v[36:39], v[92:95], v[100:103], v[36:39]
    s_waitcnt lgkmcnt(2)
    v_mfma_f32_16x16x32_bf16 v[24:27], v[40:43], v[48:51], v[24:27]
    ds_read_b128 v[88:91], v19 offset:0
    ds_read_b128 v[92:95], v19 offset:4096
    s_waitcnt lgkmcnt(2)
    v_mfma_f32_16x16x32_bf16 v[28:31], v[40:43], v[52:55], v[28:31]
    ds_read_b64_tr_b16 v[96:97], v20 offset:12288
    ds_read_b64_tr_b16 v[98:99], v20 offset:12800
    v_mfma_f32_16x16x32_bf16 v[32:35], v[44:47], v[48:51], v[32:35]
    ds_read_b64_tr_b16 v[100:101], v21 offset:12288
    ds_read_b64_tr_b16 v[102:103], v21 offset:12800
    v_mfma_f32_16x16x32_bf16 v[36:39], v[44:47], v[52:55], v[36:39]
    s_waitcnt lgkmcnt(2)
    v_mfma_f32_16x16x32_bf16 v[24:27], v[88:91], v[96:99], v[24:27]
    ds_read_b64_tr_b16 v[48:49], v20 offset:16384
    ds_read_b64_tr_b16 v[50:51], v20 offset:16896
    s_waitcnt lgkmcnt(2)
    v_mfma_f32_16x16x32_bf16 v[28:31], v[88:91], v[100:103], v[28:31]
    ds_read_b64_tr_b16 v[52:53], v21 offset:16384
    ds_read_b64_tr_b16 v[54:55], v21 offset:16896
    v_mfma_f32_16x16x32_bf16 v[32:35], v[92:95], v[96:99], v[32:35]
    v_mfma_f32_16x16x32_bf16 v[36:39], v[92:95], v[100:103], v[36:39]
    s_barrier
    ds_read_b128 v[40:43], v16 offset:16384
    ds_read_b128 v[44:47], v16 offset:20480
    s_waitcnt lgkmcnt(1)
    v_mfma_f32_16x16x32_bf16 v[24:27], v[40:43], v[48:51], v[24:27]
    ds_read_b128 v[88:91], v17 offset:16384
    ds_read_b128 v[92:95], v17 offset:20480
    v_mfma_f32_16x16x32_bf16 v[28:31], v[40:43], v[52:55], v[28:31]
    ds_read_b64_tr_b16 v[96:97], v20 offset:20480
    ds_read_b64_tr_b16 v[98:99], v20 offset:20992
    s_waitcnt lgkmcnt(4)
    v_mfma_f32_16x16x32_bf16 v[32:35], v[44:47], v[48:51], v[32:35]
    ds_read_b64_tr_b16 v[100:101], v21 offset:20480
    ds_read_b64_tr_b16 v[102:103], v21 offset:20992
    v_mfma_f32_16x16x32_bf16 v[36:39], v[44:47], v[52:55], v[36:39]
    s_waitcnt lgkmcnt(2)
    v_mfma_f32_16x16x32_bf16 v[24:27], v[88:91], v[96:99], v[24:27]
    ds_read_b128 v[40:43], v18 offset:16384
    ds_read_b128 v[44:47], v18 offset:20480
    s_waitcnt lgkmcnt(2)
    v_mfma_f32_16x16x32_bf16 v[28:31], v[88:91], v[100:103], v[28:31]
    ds_read_b64_tr_b16 v[48:49], v20 offset:24576
    ds_read_b64_tr_b16 v[50:51], v20 offset:25088
    v_mfma_f32_16x16x32_bf16 v[32:35], v[92:95], v[96:99], v[32:35]
    ds_read_b64_tr_b16 v[52:53], v21 offset:24576
    ds_read_b64_tr_b16 v[54:55], v21 offset:25088
    v_mfma_f32_16x16x32_bf16 v[36:39], v[92:95], v[100:103], v[36:39]
    s_waitcnt lgkmcnt(2)
    v_mfma_f32_16x16x32_bf16 v[24:27], v[40:43], v[48:51], v[24:27]
    ds_read_b128 v[88:91], v19 offset:16384
    ds_read_b128 v[92:95], v19 offset:20480
    s_waitcnt lgkmcnt(2)
    v_mfma_f32_16x16x32_bf16 v[28:31], v[40:43], v[52:55], v[28:31]
    ds_read_b64_tr_b16 v[96:97], v20 offset:28672
    ds_read_b64_tr_b16 v[98:99], v20 offset:29184
    v_mfma_f32_16x16x32_bf16 v[32:35], v[44:47], v[48:51], v[32:35]
    ds_read_b64_tr_b16 v[100:101], v21 offset:28672
    ds_read_b64_tr_b16 v[102:103], v21 offset:29184
    v_mfma_f32_16x16x32_bf16 v[36:39], v[44:47], v[52:55], v[36:39]
    s_waitcnt lgkmcnt(2)
    v_mfma_f32_16x16x32_bf16 v[24:27], v[88:91], v[96:99], v[24:27]
    ds_read_b64_tr_b16 v[48:49], v20 offset:32768
    ds_read_b64_tr_b16 v[50:51], v20 offset:33280
    s_waitcnt lgkmcnt(2)
    v_mfma_f32_16x16x32_bf16 v[28:31], v[88:91], v[100:103], v[28:31]
    ds_read_b64_tr_b16 v[52:53], v21 offset:32768
    ds_read_b64_tr_b16 v[54:55], v21 offset:33280
    v_mfma_f32_16x16x32_bf16 v[32:35], v[92:95], v[96:99], v[32:35]
    v_mfma_f32_16x16x32_bf16 v[36:39], v[92:95], v[100:103], v[36:39]
    s_barrier
    ds_read_b128 v[40:43], v16 offset:32768
    ds_read_b128 v[44:47], v16 offset:36864
    s_waitcnt lgkmcnt(1)
    v_mfma_f32_16x16x32_bf16 v[24:27], v[40:43], v[48:51], v[24:27]
    ds_read_b128 v[88:91], v17 offset:32768
    ds_read_b128 v[92:95], v17 offset:36864
    v_mfma_f32_16x16x32_bf16 v[28:31], v[40:43], v[52:55], v[28:31]
    ds_read_b64_tr_b16 v[96:97], v20 offset:36864
    ds_read_b64_tr_b16 v[98:99], v20 offset:37376
    s_waitcnt lgkmcnt(4)
    v_mfma_f32_16x16x32_bf16 v[32:35], v[44:47], v[48:51], v[32:35]
    ds_read_b64_tr_b16 v[100:101], v21 offset:36864
    ds_read_b64_tr_b16 v[102:103], v21 offset:37376
    v_mfma_f32_16x16x32_bf16 v[36:39], v[44:47], v[52:55], v[36:39]
    s_waitcnt lgkmcnt(2)
    v_mfma_f32_16x16x32_bf16 v[24:27], v[88:91], v[96:99], v[24:27]
    ds_read_b128 v[40:43], v18 offset:32768
    ds_read_b128 v[44:47], v18 offset:36864
    s_waitcnt lgkmcnt(2)
    v_mfma_f32_16x16x32_bf16 v[28:31], v[88:91], v[100:103], v[28:31]
    ds_read_b64_tr_b16 v[48:49], v20 offset:40960
    ds_read_b64_tr_b16 v[50:51], v20 offset:41472
    v_mfma_f32_16x16x32_bf16 v[32:35], v[92:95], v[96:99], v[32:35]
    ds_read_b64_tr_b16 v[52:53], v21 offset:40960
    ds_read_b64_tr_b16 v[54:55], v21 offset:41472
    v_mfma_f32_16x16x32_bf16 v[36:39], v[92:95], v[100:103], v[36:39]
    s_waitcnt lgkmcnt(2)
    v_mfma_f32_16x16x32_bf16 v[24:27], v[40:43], v[48:51], v[24:27]
    ds_read_b128 v[88:91], v19 offset:32768
    ds_read_b128 v[92:95], v19 offset:36864
    s_waitcnt lgkmcnt(2)
    v_mfma_f32_16x16x32_bf16 v[28:31], v[40:43], v[52:55], v[28:31]
    ds_read_b64_tr_b16 v[96:97], v20 offset:45056
    ds_read_b64_tr_b16 v[98:99], v20 offset:45568
    v_mfma_f32_16x16x32_bf16 v[32:35], v[44:47], v[48:51], v[32:35]
    ds_read_b64_tr_b16 v[100:101], v21 offset:45056
    ds_read_b64_tr_b16 v[102:103], v21 offset:45568
    v_mfma_f32_16x16x32_bf16 v[36:39], v[44:47], v[52:55], v[36:39]
    s_waitcnt lgkmcnt(2)
    v_mfma_f32_16x16x32_bf16 v[24:27], v[88:91], v[96:99], v[24:27]
    ds_read_b64_tr_b16 v[48:49], v20 offset:49152
    ds_read_b64_tr_b16 v[50:51], v20 offset:49664
    s_waitcnt lgkmcnt(2)
    v_mfma_f32_16x16x32_bf16 v[28:31], v[88:91], v[100:103], v[28:31]
    ds_read_b64_tr_b16 v[52:53], v21 offset:49152
    ds_read_b64_tr_b16 v[54:55], v21 offset:49664
    v_mfma_f32_16x16x32_bf16 v[32:35], v[92:95], v[96:99], v[32:35]
    v_mfma_f32_16x16x32_bf16 v[36:39], v[92:95], v[100:103], v[36:39]
    s_barrier
    ds_read_b128 v[40:43], v4 offset:0
    ds_read_b128 v[44:47], v4 offset:4096
    s_waitcnt lgkmcnt(1)
    v_mfma_f32_16x16x32_bf16 v[24:27], v[40:43], v[48:51], v[24:27]
    ds_read_b128 v[88:91], v5 offset:0
    ds_read_b128 v[92:95], v5 offset:4096
    v_mfma_f32_16x16x32_bf16 v[28:31], v[40:43], v[52:55], v[28:31]
    ds_read_b64_tr_b16 v[96:97], v20 offset:53248
    ds_read_b64_tr_b16 v[98:99], v20 offset:53760
    s_waitcnt lgkmcnt(4)
    v_mfma_f32_16x16x32_bf16 v[32:35], v[44:47], v[48:51], v[32:35]
    ds_read_b64_tr_b16 v[100:101], v21 offset:53248
    ds_read_b64_tr_b16 v[102:103], v21 offset:53760
    v_mfma_f32_16x16x32_bf16 v[36:39], v[44:47], v[52:55], v[36:39]
    s_waitcnt lgkmcnt(2)
    v_mfma_f32_16x16x32_bf16 v[24:27], v[88:91], v[96:99], v[24:27]
    ds_read_b128 v[40:43], v6 offset:0
    ds_read_b128 v[44:47], v6 offset:4096
    s_waitcnt lgkmcnt(2)
    v_mfma_f32_16x16x32_bf16 v[28:31], v[88:91], v[100:103], v[28:31]
    ds_read_b64_tr_b16 v[48:49], v20 offset:57344
    ds_read_b64_tr_b16 v[50:51], v20 offset:57856
    v_mfma_f32_16x16x32_bf16 v[32:35], v[92:95], v[96:99], v[32:35]
    ds_read_b64_tr_b16 v[52:53], v21 offset:57344
    ds_read_b64_tr_b16 v[54:55], v21 offset:57856
    v_mfma_f32_16x16x32_bf16 v[36:39], v[92:95], v[100:103], v[36:39]
    s_waitcnt lgkmcnt(2)
    v_mfma_f32_16x16x32_bf16 v[24:27], v[40:43], v[48:51], v[24:27]
    ds_read_b128 v[88:91], v7 offset:0
    ds_read_b128 v[92:95], v7 offset:4096
    s_waitcnt lgkmcnt(2)
    v_mfma_f32_16x16x32_bf16 v[28:31], v[40:43], v[52:55], v[28:31]
    ds_read_b64_tr_b16 v[96:97], v20 offset:61440
    ds_read_b64_tr_b16 v[98:99], v20 offset:61952
    v_mfma_f32_16x16x32_bf16 v[32:35], v[44:47], v[48:51], v[32:35]
    ds_read_b64_tr_b16 v[100:101], v21 offset:61440
    ds_read_b64_tr_b16 v[102:103], v21 offset:61952
    v_mfma_f32_16x16x32_bf16 v[36:39], v[44:47], v[52:55], v[36:39]
    s_waitcnt lgkmcnt(2)
    v_mfma_f32_16x16x32_bf16 v[24:27], v[88:91], v[96:99], v[24:27]
    s_waitcnt lgkmcnt(0)
    v_mfma_f32_16x16x32_bf16 v[28:31], v[88:91], v[100:103], v[28:31]
    v_mfma_f32_16x16x32_bf16 v[32:35], v[92:95], v[96:99], v[32:35]
    v_mfma_f32_16x16x32_bf16 v[36:39], v[92:95], v[100:103], v[36:39]
    s_waitcnt vmcnt(0)
    s_add_u32 s16, s8, 32768
    s_addc_u32 s17, s9, 0
    s_mov_b32 s18, 16384
    s_mov_b32 s19, 0x20000
    v_lshlrev_b32 v64, 16, v80
    v_and_b32 v65, 0xffff0000, v80
    v_lshlrev_b32 v66, 16, v81
    v_and_b32 v67, 0xffff0000, v81
    v_lshlrev_b32 v68, 16, v82
    v_and_b32 v69, 0xffff0000, v82
    v_lshlrev_b32 v70, 16, v83
    v_and_b32 v71, 0xffff0000, v83
    v_lshlrev_b32 v72, 16, v84
    v_and_b32 v73, 0xffff0000, v84
    v_lshlrev_b32 v74, 16, v85
    v_and_b32 v75, 0xffff0000, v85
    v_lshlrev_b32 v76, 16, v86
    v_and_b32 v77, 0xffff0000, v86
    v_lshlrev_b32 v78, 16, v87
    v_and_b32 v79, 0xffff0000, v87
    s_nop 3
    v_pk_add_f32 v[24:25], v[24:25], v[64:65]
    v_pk_add_f32 v[26:27], v[26:27], v[66:67]
    v_pk_add_f32 v[28:29], v[28:29], v[68:69]
    v_pk_add_f32 v[30:31], v[30:31], v[70:71]
    v_pk_add_f32 v[32:33], v[32:33], v[72:73]
    v_pk_add_f32 v[34:35], v[34:35], v[74:75]
    v_pk_add_f32 v[36:37], v[36:37], v[76:77]
    v_pk_add_f32 v[38:39], v[38:39], v[78:79]
    v_cvt_pk_bf16_f32 v40, v24, v25
    v_cvt_pk_bf16_f32 v41, v26, v27
    ds_write_b64 v9, v[40:41] offset:0
    v_cvt_pk_bf16_f32 v42, v28, v29
    v_cvt_pk_bf16_f32 v43, v30, v31
    ds_write_b64 v9, v[42:43] offset:2304
    v_cvt_pk_bf16_f32 v44, v32, v33
    v_cvt_pk_bf16_f32 v45, v34, v35
    ds_write_b64 v9, v[44:45] offset:32
    v_cvt_pk_bf16_f32 v46, v36, v37
    v_cvt_pk_bf16_f32 v47, v38, v39
    ds_write_b64 v9, v[46:47] offset:2336
    v_pk_add_f32 v[48:49], v[24:25], v[28:29]
    v_pk_mul_f32 v[52:53], v[24:25], v[24:25]
    v_pk_add_f32 v[50:51], v[26:27], v[30:31]
    v_pk_mul_f32 v[54:55], v[26:27], v[26:27]
    v_pk_fma_f32 v[52:53], v[28:29], v[28:29], v[52:53]
    v_pk_fma_f32 v[54:55], v[30:31], v[30:31], v[54:55]
    v_pk_add_f32 v[56:57], v[32:33], v[36:37]
    v_pk_mul_f32 v[60:61], v[32:33], v[32:33]
    v_pk_add_f32 v[58:59], v[34:35], v[38:39]
    v_pk_mul_f32 v[62:63], v[34:35], v[34:35]
    v_pk_fma_f32 v[60:61], v[36:37], v[36:37], v[60:61]
    v_pk_fma_f32 v[62:63], v[38:39], v[38:39], v[62:63]
    v_add_f32_dpp v48, v48, v48 row_ror:8 row_mask:0xf bank_mask:0xf
    v_add_f32_dpp v49, v49, v49 row_ror:8 row_mask:0xf bank_mask:0xf
    v_add_f32_dpp v50, v50, v50 row_ror:8 row_mask:0xf bank_mask:0xf
    v_add_f32_dpp v51, v51, v51 row_ror:8 row_mask:0xf bank_mask:0xf
    v_add_f32_dpp v52, v52, v52 row_ror:8 row_mask:0xf bank_mask:0xf
    v_add_f32_dpp v53, v53, v53 row_ror:8 row_mask:0xf bank_mask:0xf
    v_add_f32_dpp v54, v54, v54 row_ror:8 row_mask:0xf bank_mask:0xf
    v_add_f32_dpp v55, v55, v55 row_ror:8 row_mask:0xf bank_mask:0xf
    v_add_f32_dpp v56, v56, v56 row_ror:8 row_mask:0xf bank_mask:0xf
    v_add_f32_dpp v57, v57, v57 row_ror:8 row_mask:0xf bank_mask:0xf
    v_add_f32_dpp v58, v58, v58 row_ror:8 row_mask:0xf bank_mask:0xf
    v_add_f32_dpp v59, v59, v59 row_ror:8 row_mask:0xf bank_mask:0xf
    v_add_f32_dpp v60, v60, v60 row_ror:8 row_mask:0xf bank_mask:0xf
    v_add_f32_dpp v61, v61, v61 row_ror:8 row_mask:0xf bank_mask:0xf
    v_add_f32_dpp v62, v62, v62 row_ror:8 row_mask:0xf bank_mask:0xf
    v_add_f32_dpp v63, v63, v63 row_ror:8 row_mask:0xf bank_mask:0xf
    v_add_f32_dpp v48, v48, v48 row_ror:4 row_mask:0xf bank_mask:0xf
    v_add_f32_dpp v49, v49, v49 row_ror:4 row_mask:0xf bank_mask:0xf
    v_add_f32_dpp v50, v50, v50 row_ror:4 row_mask:0xf bank_mask:0xf
    v_add_f32_dpp v51, v51, v51 row_ror:4 row_mask:0xf bank_mask:0xf
    v_add_f32_dpp v52, v52, v52 row_ror:4 row_mask:0xf bank_mask:0xf
    v_add_f32_dpp v53, v53, v53 row_ror:4 row_mask:0xf bank_mask:0xf
    v_add_f32_dpp v54, v54, v54 row_ror:4 row_mask:0xf bank_mask:0xf
    v_add_f32_dpp v55, v55, v55 row_ror:4 row_mask:0xf bank_mask:0xf
    v_add_f32_dpp v56, v56, v56 row_ror:4 row_mask:0xf bank_mask:0xf
    v_add_f32_dpp v57, v57, v57 row_ror:4 row_mask:0xf bank_mask:0xf
    v_add_f32_dpp v58, v58, v58 row_ror:4 row_mask:0xf bank_mask:0xf
    v_add_f32_dpp v59, v59, v59 row_ror:4 row_mask:0xf bank_mask:0xf
    v_add_f32_dpp v60, v60, v60 row_ror:4 row_mask:0xf bank_mask:0xf
    v_add_f32_dpp v61, v61, v61 row_ror:4 row_mask:0xf bank_mask:0xf
    v_add_f32_dpp v62, v62, v62 row_ror:4 row_mask:0xf bank_mask:0xf
    v_add_f32_dpp v63, v63, v63 row_ror:4 row_mask:0xf bank_mask:0xf
    v_add_f32_dpp v48, v48, v48 row_ror:2 row_mask:0xf bank_mask:0xf
    v_add_f32_dpp v49, v49, v49 row_ror:2 row_mask:0xf bank_mask:0xf
    v_add_f32_dpp v50, v50, v50 row_ror:2 row_mask:0xf bank_mask:0xf
    v_add_f32_dpp v51, v51, v51 row_ror:2 row_mask:0xf bank_mask:0xf
    v_add_f32_dpp v52, v52, v52 row_ror:2 row_mask:0xf bank_mask:0xf
    v_add_f32_dpp v53, v53, v53 row_ror:2 row_mask:0xf bank_mask:0xf
    v_add_f32_dpp v54, v54, v54 row_ror:2 row_mask:0xf bank_mask:0xf
    v_add_f32_dpp v55, v55, v55 row_ror:2 row_mask:0xf bank_mask:0xf
    v_add_f32_dpp v56, v56, v56 row_ror:2 row_mask:0xf bank_mask:0xf
    v_add_f32_dpp v57, v57, v57 row_ror:2 row_mask:0xf bank_mask:0xf
    v_add_f32_dpp v58, v58, v58 row_ror:2 row_mask:0xf bank_mask:0xf
    v_add_f32_dpp v59, v59, v59 row_ror:2 row_mask:0xf bank_mask:0xf
    v_add_f32_dpp v60, v60, v60 row_ror:2 row_mask:0xf bank_mask:0xf
    v_add_f32_dpp v61, v61, v61 row_ror:2 row_mask:0xf bank_mask:0xf
    v_add_f32_dpp v62, v62, v62 row_ror:2 row_mask:0xf bank_mask:0xf
    v_add_f32_dpp v63, v63, v63 row_ror:2 row_mask:0xf bank_mask:0xf
    v_add_f32_dpp v48, v48, v48 row_ror:1 row_mask:0xf bank_mask:0xf
    v_add_f32_dpp v49, v49, v49 row_ror:1 row_mask:0xf bank_mask:0xf
    v_add_f32_dpp v50, v50, v50 row_ror:1 row_mask:0xf bank_mask:0xf
    v_add_f32_dpp v51, v51, v51 row_ror:1 row_mask:0xf bank_mask:0xf
    v_add_f32_dpp v52, v52, v52 row_ror:1 row_mask:0xf bank_mask:0xf
    v_add_f32_dpp v53, v53, v53 row_ror:1 row_mask:0xf bank_mask:0xf
    v_add_f32_dpp v54, v54, v54 row_ror:1 row_mask:0xf bank_mask:0xf
    v_add_f32_dpp v55, v55, v55 row_ror:1 row_mask:0xf bank_mask:0xf
    v_add_f32_dpp v56, v56, v56 row_ror:1 row_mask:0xf bank_mask:0xf
    v_add_f32_dpp v57, v57, v57 row_ror:1 row_mask:0xf bank_mask:0xf
    v_add_f32_dpp v58, v58, v58 row_ror:1 row_mask:0xf bank_mask:0xf
    v_add_f32_dpp v59, v59, v59 row_ror:1 row_mask:0xf bank_mask:0xf
    v_add_f32_dpp v60, v60, v60 row_ror:1 row_mask:0xf bank_mask:0xf
    v_add_f32_dpp v61, v61, v61 row_ror:1 row_mask:0xf bank_mask:0xf
    v_add_f32_dpp v62, v62, v62 row_ror:1 row_mask:0xf bank_mask:0xf
    v_add_f32_dpp v63, v63, v63 row_ror:1 row_mask:0xf bank_mask:0xf
    s_lshl_b32 s44, s80, 9
    s_lshl_b32 s45, s79, 7
    s_add_u32 s44, s44, s45
    s_add_u32 s44, s44, 156928
    v_lshlrev_b32 v11, 4, v3
    v_add_u32 v11, s44, v11
    v_cmp_eq_u32 vcc, 0, v2
    s_nop 0
    s_and_saveexec_b64 s[46:47], vcc
    ds_write_b128 v11, v[48:51] offset:0
    ds_write_b128 v11, v[52:55] offset:256
    ds_write_b128 v11, v[56:59] offset:64
    ds_write_b128 v11, v[60:63] offset:320
    s_mov_b64 exec, s[46:47]
    s_waitcnt lgkmcnt(0)
    s_barrier
A2L1_ST:
    ds_read_b128 v[84:87], v22
    s_cmp_gt_u32 s28, 1
    s_cbranch_scc1 A2L1_NOAT
    s_lshl_b32 s44, s28, 8
    s_add_u32 s44, s44, 156928
    v_lshlrev_b32 v11, 2, v1
    v_add_u32 v12, s44, v11
    ds_read_b32 v13, v12
    ds_read_b32 v14, v12 offset:512
    s_lshl_b32 s44, s28, 13
    s_lshl_b32 s45, s81, 2
    s_add_u32 s44, s44, s45
    s_waitcnt lgkmcnt(0)
    v_add_f32 v13, v13, v14
    buffer_atomic_add_f32 v13, v11, s[16:19], s44 offen
A2L1_NOAT:
    s_add_u32 s12, s8, 14155776
    s_addc_u32 s13, s9, 0
    s_mov_b32 s14, 2097152
    s_mov_b32 s15, 0x20000
    s_waitcnt lgkmcnt(0)
    buffer_store_dwordx4 v[84:87], v23, s[12:15], s83 offen sc1
    s_lshl_b32 s82, s2, 7
    s_add_u32 s82, s82, 131072
    s_and_b32 s35, s2, 7
    s_lshl_b32 s35, s35, 4
    s_lshr_b32 s36, s2, 3
    s_and_b32 s36, s36, 15
    s_add_u32 s52, s35, s36
    s_lshr_b32 s53, s2, 7
    s_waitcnt vmcnt(0)
    s_barrier
    s_cmp_lg_u32 s28, 0
    s_cbranch_scc1 H2S1
    v_mov_b32 v250, s34
    v_mov_b32 v251, s82
    s_mov_b64 exec, 1
    buffer_store_dword v250, v251, s[72:75], 0 offen sc1
    s_mov_b64 exec, -1
H2S1:
    s_add_u32 s36, s8, 262144
    s_addc_u32 s37, s9, 0
    s_mov_b32 s38, 4259840
    s_mov_b32 s39, 0x20000
    s_lshl_b32 s40, s52, 2
    s_lshr_b32 s41, s28, 1
    s_add_u32 s40, s40, s41
    s_mul_i32 s40, s40, 8320
    s_mul_i32 s41, s41, 16704
    s_and_b32 s42, s28, 1
    s_mul_i32 s42, s42, 8324
    s_add_u32 s41, s41, s42
    s_add_u32 s41, s41, 49152
    v_lshlrev_b32 v6, 4, v1
    s_add_u32 m0, s41, 0
    s_add_u32 s42, s40, 0
    buffer_load_dwordx4 v6, s[36:39], s42 offen sc1 lds
    s_add_u32 m0, s41, 1024
    s_add_u32 s42, s40, 1024
    buffer_load_dwordx4 v6, s[36:39], s42 offen sc1 lds
    s_add_u32 m0, s41, 2048
    s_add_u32 s42, s40, 2048
    buffer_load_dwordx4 v6, s[36:39], s42 offen sc1 lds
    s_add_u32 m0, s41, 3072
    s_add_u32 s42, s40, 3072
    buffer_load_dwordx4 v6, s[36:39], s42 offen sc1 lds
    s_add_u32 m0, s41, 4096
    s_add_u32 s42, s40, 4096
    buffer_load_dwordx4 v6, s[36:39], s42 offen sc1 lds
    s_add_u32 m0, s41, 5120
    s_add_u32 s42, s40, 5120
    buffer_load_dwordx4 v6, s[36:39], s42 offen sc1 lds
    s_add_u32 m0, s41, 6144
    s_add_u32 s42, s40, 6144
    buffer_load_dwordx4 v6, s[36:39], s42 offen sc1 lds
    s_add_u32 m0, s41, 7168
    s_add_u32 s42, s40, 7168
    buffer_load_dwordx4 v6, s[36:39], s42 offen sc1 lds
    s_mov_b64 exec, 0xff
    s_add_u32 m0, s41, 8192
    s_add_u32 s42, s40, 8192
    buffer_load_dwordx4 v6, s[36:39], s42 offen sc1 lds
    s_mov_b64 exec, -1
    s_load_dwordx2 s[50:51], s[0:1], 72
    s_waitcnt lgkmcnt(0)
    s_lshl_b32 s46, s52, 3
    s_load_dwordx2 s[92:93], s[50:51], s46
    v_lshlrev_b32 v4, 3, v0
    v_lshlrev_b32 v5, 4, v0
    s_lshl_b32 s35, s52, 14
    s_mov_b32 s37, 8192
    s_add_u32 s12, s8, 14155776
    s_addc_u32 s13, s9, 0
    s_mov_b32 s14, 2097152
    s_mov_b32 s15, 0x20000
    s_add_u32 s16, s8, 32768
    s_addc_u32 s17, s9, 0
    s_mov_b32 s18, 16384
    s_mov_b32 s19, 0x20000
    v_mov_b32 v36, 0x3b000000
    v_mov_b32 v37, 0x3727c5ac
    v_cmp_gt_u32 vcc, 128, v0
    s_nop 0
    s_and_saveexec_b64 s[42:43], vcc
    v_lshrrev_b32 v7, 5, v0
    v_mul_u32_u24 v7, 4608, v7
    v_and_b32 v8, 31, v0
    v_lshlrev_b32 v8, 4, v8
    v_add_u32 v7, v7, v8
    v_mov_b32 v44, 0
    v_mov_b32 v45, 0
    v_mov_b32 v46, 0
    v_mov_b32 v47, 0
    ds_write_b128 v7, v[44:47] offset:0
    s_mov_b64 exec, s[42:43]
    s_and_b32 s46, s28, 3
    s_mul_i32 s46, s46, 16704
    s_add_u32 s46, s46, 49152
    v_and_b32 v11, 1, v2
    v_mul_u32_u24 v11, 4160, v11
    v_lshrrev_b32 v12, 1, v2
    v_and_b32 v13, 1, v12
    v_xor_b32 v13, 1, v13
    v_mul_u32_u24 v13, 8324, v13
    v_add_u32 v11, v11, v13
    v_lshlrev_b32 v13, 2, v3
    v_sub_u32 v13, v13, v12
    v_add_u32 v13, 7, v13
    v_lshlrev_b32 v13, 2, v13
    v_add_u32 v11, v11, v13
    v_add_u32 v60, s46, v11
    v_lshlrev_b32 v12, 5, v2
    v_lshlrev_b32 v13, 4, v3
    v_add_u32 v12, v12, v13
    s_and_b32 s46, s28, 3
    s_mul_i32 s46, s46, 4608
    v_add_u32 v68, s46, v12
    v_mov_b32 v72, 0
    v_mov_b32 v73, 0
    v_mov_b32 v74, 0
    v_mov_b32 v75, 0
    v_mov_b32 v76, 0
    v_mov_b32 v77, 0
    v_mov_b32 v78, 0
    v_mov_b32 v79, 0
    v_mov_b32 v80, 0
    v_mov_b32 v81, 0
    v_mov_b32 v82, 0
    v_mov_b32 v83, 0
    v_mov_b32 v84, 0
    v_mov_b32 v85, 0
    v_mov_b32 v86, 0
    v_mov_b32 v87, 0
    v_lshlrev_b32 v14, 5, v2
    v_lshlrev_b32 v15, 3, v3
    v_add_u32 v14, v14, v15
    v_add_u32 v16, s46, v14
    s_and_b32 s46, s28, 3
    s_lshl_b32 s46, s46, 12
    v_add_u32 v17, s46, v14
    s_and_b32 s46, s28, 3
    s_lshl_b32 s46, s46, 11
    v_add_u32 v18, s46, v14
    v_lshlrev_b32 v19, 2, v0
    s_lshr_b32 s46, s28, 1
    s_and_b32 s47, s46, 1
    s_lshr_b32 s48, s46, 1
    s_lshl_b32 s48, s48, 2
    s_mul_i32 s49, s47, 3
    s_add_u32 s47, s47, 1
    s_cmp_eq_u32 s53, 0
    s_cselect_b32 s47, s49, s47
    s_add_u32 s48, s48, s47
    s_lshl_b32 s48, s48, 18
    s_lshl_b32 s49, s52, 3
    s_add_u32 s54, s48, s49
    v_and_b32 v20, 127, v0
    v_lshlrev_b32 v20, 11, v20
    v_mov_b32 v10, v20
    s_waitcnt vmcnt(0)
    s_waitcnt lgkmcnt(0)
    s_mov_b32 s82, 131072
    s_cmp_lg_u32 s28, 0
    s_cbranch_scc1 H2W1_D
    s_sleep 4
    v_lshlrev_b32 v250, 7, v1
    v_add_u32 v250, s82, v250
    v_add_u32 v251, 8192, v250
    v_add_u32 v252, 16384, v250
    v_add_u32 v253, 24576, v250
    s_mov_b32 s90, 0
H2W1_P:
    buffer_load_dword v246, v250, s[72:75], 0 offen sc1
    buffer_load_dword v247, v251, s[72:75], 0 offen sc1
    buffer_load_dword v248, v252, s[72:75], 0 offen sc1
    buffer_load_dword v249, v253, s[72:75], 0 offen sc1
    s_waitcnt vmcnt(0)
    v_cmp_eq_u32 vcc, s34, v246
    v_cmp_eq_u32 s[84:85], s34, v247
    v_cmp_eq_u32 s[86:87], s34, v248
    v_cmp_eq_u32 s[88:89], s34, v249
    s_and_b64 s[84:85], s[84:85], s[86:87]
    s_and_b64 vcc, vcc, s[88:89]
    s_and_b64 vcc, vcc, s[84:85]
    s_nop 0
    s_cmp_eq_u64 vcc, exec
    s_cbranch_scc1 H2W1_X
    s_sleep 2
    s_add_u32 s90, s90, 1
    s_cmp_lt_u32 s90, 200000
    s_cbranch_scc1 H2W1_P
H2W1_X:
    s_mov_b64 exec, -1
H2W1_D:
    s_barrier
    buffer_load_dwordx4 v[28:31], v5, s[16:19], 0 offen sc1
    buffer_load_dwordx4 v[32:35], v5, s[16:19], s37 offen sc1
    s_add_u32 s36, s35, 0
    buffer_load_dwordx2 v[20:21], v4, s[12:15], s36 offen sc1
    s_add_u32 s36, s35, 4096
    buffer_load_dwordx2 v[22:23], v4, s[12:15], s36 offen sc1
    s_add_u32 s36, s35, 8192
    buffer_load_dwordx2 v[24:25], v4, s[12:15], s36 offen sc1
    s_add_u32 s36, s35, 12288
    buffer_load_dwordx2 v[26:27], v4, s[12:15], s36 offen sc1
    s_waitcnt vmcnt(0)
    v_pk_mul_f32 v[28:29], v[28:29], v[36:37] op_sel:[0,0] op_sel_hi:[1,0]
    v_pk_fma_f32 v[32:33], v[32:33], v[36:37], v[36:37] op_sel:[0,0,1] op_sel_hi:[1,0,1]
    v_pk_mul_f32 v[30:31], v[30:31], v[36:37] op_sel:[0,0] op_sel_hi:[1,0]
    v_pk_fma_f32 v[34:35], v[34:35], v[36:37], v[36:37] op_sel:[0,0,1] op_sel_hi:[1,0,1]
    v_pk_fma_f32 v[32:33], v[28:29], v[28:29], v[32:33] neg_lo:[1,0,0] neg_hi:[1,0,0]
    v_pk_fma_f32 v[34:35], v[30:31], v[30:31], v[34:35] neg_lo:[1,0,0] neg_hi:[1,0,0]
    v_max_f32 v32, v37, v32
    v_max_f32 v33, v37, v33
    v_max_f32 v34, v37, v34
    v_max_f32 v35, v37, v35
    v_rsq_f32 v32, v32
    v_rsq_f32 v33, v33
    v_rsq_f32 v34, v34
    v_rsq_f32 v35, v35
    v_pk_mul_f32 v[40:41], v[28:29], v[32:33]
    v_pk_mul_f32 v[42:43], v[30:31], v[34:35]
    v_lshlrev_b32 v88, 16, v20
    v_and_b32 v89, 0xffff0000, v20
    v_lshlrev_b32 v90, 16, v21
    v_and_b32 v91, 0xffff0000, v21
    v_lshlrev_b32 v92, 16, v22
    v_and_b32 v93, 0xffff0000, v22
    v_lshlrev_b32 v94, 16, v23
    v_and_b32 v95, 0xffff0000, v23
    v_lshlrev_b32 v96, 16, v24
    v_and_b32 v97, 0xffff0000, v24
    v_lshlrev_b32 v98, 16, v25
    v_and_b32 v99, 0xffff0000, v25
    v_lshlrev_b32 v100, 16, v26
    v_and_b32 v101, 0xffff0000, v26
    v_lshlrev_b32 v102, 16, v27
    v_and_b32 v103, 0xffff0000, v27
    v_pk_fma_f32 v[88:89], v[88:89], v[32:33], v[40:41] neg_lo:[0,0,1] neg_hi:[0,0,1]
    v_pk_fma_f32 v[90:91], v[90:91], v[34:35], v[42:43] neg_lo:[0,0,1] neg_hi:[0,0,1]
    v_pk_fma_f32 v[92:93], v[92:93], v[32:33], v[40:41] neg_lo:[0,0,1] neg_hi:[0,0,1]
    v_pk_fma_f32 v[94:95], v[94:95], v[34:35], v[42:43] neg_lo:[0,0,1] neg_hi:[0,0,1]
    v_pk_fma_f32 v[96:97], v[96:97], v[32:33], v[40:41] neg_lo:[0,0,1] neg_hi:[0,0,1]
    v_pk_fma_f32 v[98:99], v[98:99], v[34:35], v[42:43] neg_lo:[0,0,1] neg_hi:[0,0,1]
    v_pk_fma_f32 v[100:101], v[100:101], v[32:33], v[40:41] neg_lo:[0,0,1] neg_hi:[0,0,1]
    v_pk_fma_f32 v[102:103], v[102:103], v[34:35], v[42:43] neg_lo:[0,0,1] neg_hi:[0,0,1]
    v_cvt_pk_bf16_f32 v48, v88, v89
    v_cvt_pk_bf16_f32 v49, v90, v91
    v_cvt_pk_bf16_f32 v50, v92, v93
    v_cvt_pk_bf16_f32 v51, v94, v95
    v_cvt_pk_bf16_f32 v52, v96, v97
    v_cvt_pk_bf16_f32 v53, v98, v99
    v_cvt_pk_bf16_f32 v54, v100, v101
    v_cvt_pk_bf16_f32 v55, v102, v103
    ds_write_b64 v4, v[48:49] offset:512
    ds_write_b64 v4, v[50:51] offset:5120
    ds_write_b64 v4, v[52:53] offset:9728
    ds_write_b64 v4, v[54:55] offset:14336
    s_add_u32 s46, s28, 1
    s_lshr_b32 s46, s46, 1
    s_and_b32 s46, s46, 1
    s_cmp_lg_u32 s46, s53
    s_cbranch_scc1 BL1_NOX
    ds_write_b64 v4, v[20:21] offset:18432
    ds_write_b64 v4, v[22:23] offset:22528
    ds_write_b64 v4, v[24:25] offset:26624
    ds_write_b64 v4, v[26:27] offset:30720
BL1_NOX:
    s_waitcnt vmcnt(0) lgkmcnt(0)
    s_barrier
    s_cmp_gt_u32 s28, 3
    s_cbranch_scc1 BL1_JOIN
    s_cmp_eq_u32 s53, 1
    s_cbranch_scc1 BL1_TS1
    ds_read_b64 v[104:105], v60 offset:4032
    ds_read_b64 v[106:107], v60 offset:4040
    ds_read_b128 v[136:139], v68 offset:480
    ds_read_b128 v[140:143], v68 offset:992
    ds_read_b128 v[144:147], v68 offset:1504
    ds_read_b128 v[148:151], v68 offset:2016
    ds_read_b128 v[152:155], v68 offset:2528
    ds_read_b128 v[156:159], v68 offset:3040
    ds_read_b128 v[160:163], v68 offset:3552
    ds_read_b128 v[164:167], v68 offset:4064
    ds_read_b64 v[108:109], v60 offset:3520
    ds_read_b64 v[110:111], v60 offset:3528
    ds_read_b64 v[112:113], v60 offset:3008
    ds_read_b64 v[114:115], v60 offset:3016
    ds_read_b64 v[116:117], v60 offset:2496
    ds_read_b64 v[118:119], v60 offset:2504
    ds_read_b64 v[120:121], v60 offset:1984
    ds_read_b64 v[122:123], v60 offset:1992
    ds_read_b64 v[124:125], v60 offset:1472
    ds_read_b64 v[126:127], v60 offset:1480
    ds_read_b64 v[128:129], v60 offset:960
    ds_read_b64 v[130:131], v60 offset:968
    ds_read_b64 v[132:133], v60 offset:448
    ds_read_b64 v[134:135], v60 offset:456
    s_waitcnt lgkmcnt(14)
    v_mfma_f32_16x16x32_bf16 v[72:75], v[104:107], v[136:139], v[72:75]
    ds_read_b64 v[186:187], v60 offset:3968
    ds_read_b64 v[188:189], v60 offset:3976
    v_mfma_f32_16x16x32_bf16 v[76:79], v[104:107], v[148:151], v[76:79]
    ds_read_b128 v[218:221], v68 offset:416
    v_mfma_f32_16x16x32_bf16 v[80:83], v[104:107], v[152:155], v[80:83]
    ds_read_b128 v[222:225], v68 offset:928
    v_mfma_f32_16x16x32_bf16 v[84:87], v[104:107], v[164:167], v[84:87]
    ds_read_b128 v[226:229], v68 offset:1440
    ds_read_b128 v[230:233], v68 offset:1952
    s_waitcnt lgkmcnt(14)
    v_mfma_f32_16x16x32_bf16 v[76:79], v[108:111], v[144:147], v[76:79]
    ds_read_b128 v[234:237], v68 offset:2464
    v_mfma_f32_16x16x32_bf16 v[80:83], v[108:111], v[148:151], v[80:83]
    ds_read_b128 v[238:241], v68 offset:2976
    v_mfma_f32_16x16x32_bf16 v[84:87], v[108:111], v[160:163], v[84:87]
    ds_read_b128 v[242:245], v68 offset:3488
    ds_read_b128 v[246:249], v68 offset:4000
    v_mfma_f32_16x16x32_bf16 v[76:79], v[112:115], v[140:143], v[76:79]
    ds_read_b64 v[190:191], v60 offset:3456
    v_mfma_f32_16x16x32_bf16 v[80:83], v[112:115], v[144:147], v[80:83]
    ds_read_b64 v[192:193], v60 offset:3464
    v_mfma_f32_16x16x32_bf16 v[84:87], v[112:115], v[156:159], v[84:87]
    ds_read_b64 v[194:195], v60 offset:2944
    ds_read_b64 v[196:197], v60 offset:2952
    v_mfma_f32_16x16x32_bf16 v[76:79], v[116:119], v[136:139], v[76:79]
    ds_read_b64 v[198:199], v60 offset:2432
    v_mfma_f32_16x16x32_bf16 v[80:83], v[116:119], v[140:143], v[80:83]
    ds_read_b64 v[200:201], v60 offset:2440
    v_mfma_f32_16x16x32_bf16 v[84:87], v[116:119], v[152:155], v[84:87]
    ds_read_b64 v[202:203], v60 offset:1920
    ds_read_b64 v[204:205], v60 offset:1928
    s_waitcnt lgkmcnt(14)
    v_mfma_f32_16x16x32_bf16 v[80:83], v[120:123], v[136:139], v[80:83]
    ds_read_b64 v[206:207], v60 offset:1408
    v_mfma_f32_16x16x32_bf16 v[84:87], v[120:123], v[148:151], v[84:87]
    ds_read_b64 v[208:209], v60 offset:1416
    v_mfma_f32_16x16x32_bf16 v[84:87], v[124:127], v[144:147], v[84:87]
    ds_read_b64 v[210:211], v60 offset:896
    ds_read_b64 v[212:213], v60 offset:904
    v_mfma_f32_16x16x32_bf16 v[84:87], v[128:131], v[140:143], v[84:87]
    ds_read_b64 v[214:215], v60 offset:384
    v_mfma_f32_16x16x32_bf16 v[84:87], v[132:135], v[136:139], v[84:87]
    ds_read_b64 v[216:217], v60 offset:392
    v_mfma_f32_16x16x32_bf16 v[72:75], v[186:189], v[218:221], v[72:75]
    ds_read_b64 v[104:105], v60 offset:3904
    ds_read_b64 v[106:107], v60 offset:3912
    s_waitcnt lgkmcnt(14)
    v_mfma_f32_16x16x32_bf16 v[76:79], v[186:189], v[230:233], v[76:79]
    ds_read_b128 v[136:139], v68 offset:352
    v_mfma_f32_16x16x32_bf16 v[80:83], v[186:189], v[234:237], v[80:83]
    ds_read_b128 v[140:143], v68 offset:864
    v_mfma_f32_16x16x32_bf16 v[84:87], v[186:189], v[246:249], v[84:87]
    ds_read_b128 v[144:147], v68 offset:1376
    ds_read_b128 v[148:151], v68 offset:1888
    v_mfma_f32_16x16x32_bf16 v[76:79], v[190:193], v[226:229], v[76:79]
    ds_read_b128 v[152:155], v68 offset:2400
    v_mfma_f32_16x16x32_bf16 v[80:83], v[190:193], v[230:233], v[80:83]
    ds_read_b128 v[156:159], v68 offset:2912
    v_mfma_f32_16x16x32_bf16 v[84:87], v[190:193], v[242:245], v[84:87]
    ds_read_b128 v[160:163], v68 offset:3424
    ds_read_b128 v[164:167], v68 offset:3936
    s_waitcnt lgkmcnt(14)
    v_mfma_f32_16x16x32_bf16 v[76:79], v[194:197], v[222:225], v[76:79]
    ds_read_b64 v[108:109], v60 offset:3392
    v_mfma_f32_16x16x32_bf16 v[80:83], v[194:197], v[226:229], v[80:83]
    ds_read_b64 v[110:111], v60 offset:3400
    v_mfma_f32_16x16x32_bf16 v[84:87], v[194:197], v[238:241], v[84:87]
    ds_read_b64 v[112:113], v60 offset:2880
    ds_read_b64 v[114:115], v60 offset:2888
    v_mfma_f32_16x16x32_bf16 v[76:79], v[198:201], v[218:221], v[76:79]
    ds_read_b64 v[116:117], v60 offset:2368
    v_mfma_f32_16x16x32_bf16 v[80:83], v[198:201], v[222:225], v[80:83]
    ds_read_b64 v[118:119], v60 offset:2376
    v_mfma_f32_16x16x32_bf16 v[84:87], v[198:201], v[234:237], v[84:87]
    ds_read_b64 v[120:121], v60 offset:1856
    ds_read_b64 v[122:123], v60 offset:1864
    v_mfma_f32_16x16x32_bf16 v[80:83], v[202:205], v[218:221], v[80:83]
    ds_read_b64 v[124:125], v60 offset:1344
    v_mfma_f32_16x16x32_bf16 v[84:87], v[202:205], v[230:233], v[84:87]
    ds_read_b64 v[126:127], v60 offset:1352
    v_mfma_f32_16x16x32_bf16 v[84:87], v[206:209], v[226:229], v[84:87]
    ds_read_b64 v[128:129], v60 offset:832
    ds_read_b64 v[130:131], v60 offset:840
    s_waitcnt lgkmcnt(14)
    v_mfma_f32_16x16x32_bf16 v[84:87], v[210:213], v[222:225], v[84:87]
    ds_read_b64 v[132:133], v60 offset:320
    v_mfma_f32_16x16x32_bf16 v[84:87], v[214:217], v[218:221], v[84:87]
    ds_read_b64 v[134:135], v60 offset:328
    v_mfma_f32_16x16x32_bf16 v[72:75], v[104:107], v[136:139], v[72:75]
    ds_read_b64 v[186:187], v60 offset:3840
    ds_read_b64 v[188:189], v60 offset:3848
    v_mfma_f32_16x16x32_bf16 v[76:79], v[104:107], v[148:151], v[76:79]
    ds_read_b128 v[218:221], v68 offset:288
    v_mfma_f32_16x16x32_bf16 v[80:83], v[104:107], v[152:155], v[80:83]
    ds_read_b128 v[222:225], v68 offset:800
    s_waitcnt lgkmcnt(14)
    v_mfma_f32_16x16x32_bf16 v[84:87], v[104:107], v[164:167], v[84:87]
    ds_read_b128 v[226:229], v68 offset:1312
    ds_read_b128 v[230:233], v68 offset:1824
    v_mfma_f32_16x16x32_bf16 v[76:79], v[108:111], v[144:147], v[76:79]
    ds_read_b128 v[234:237], v68 offset:2336
    v_mfma_f32_16x16x32_bf16 v[80:83], v[108:111], v[148:151], v[80:83]
    ds_read_b128 v[238:241], v68 offset:2848
    v_mfma_f32_16x16x32_bf16 v[84:87], v[108:111], v[160:163], v[84:87]
    ds_read_b128 v[242:245], v68 offset:3360
    ds_read_b128 v[246:249], v68 offset:3872
    v_mfma_f32_16x16x32_bf16 v[76:79], v[112:115], v[140:143], v[76:79]
    ds_read_b64 v[190:191], v60 offset:3328
    v_mfma_f32_16x16x32_bf16 v[80:83], v[112:115], v[144:147], v[80:83]
    ds_read_b64 v[192:193], v60 offset:3336
    v_mfma_f32_16x16x32_bf16 v[84:87], v[112:115], v[156:159], v[84:87]
    ds_read_b64 v[194:195], v60 offset:2816
    ds_read_b64 v[196:197], v60 offset:2824
    s_waitcnt lgkmcnt(14)
    v_mfma_f32_16x16x32_bf16 v[76:79], v[116:119], v[136:139], v[76:79]
    ds_read_b64 v[198:199], v60 offset:2304
    v_mfma_f32_16x16x32_bf16 v[80:83], v[116:119], v[140:143], v[80:83]
    ds_read_b64 v[200:201], v60 offset:2312
    v_mfma_f32_16x16x32_bf16 v[84:87], v[116:119], v[152:155], v[84:87]
    ds_read_b64 v[202:203], v60 offset:1792
    ds_read_b64 v[204:205], v60 offset:1800
    v_mfma_f32_16x16x32_bf16 v[80:83], v[120:123], v[136:139], v[80:83]
    ds_read_b64 v[206:207], v60 offset:1280
    v_mfma_f32_16x16x32_bf16 v[84:87], v[120:123], v[148:151], v[84:87]
    ds_read_b64 v[208:209], v60 offset:1288
    v_mfma_f32_16x16x32_bf16 v[84:87], v[124:127], v[144:147], v[84:87]
    ds_read_b64 v[210:211], v60 offset:768
    ds_read_b64 v[212:213], v60 offset:776
    v_mfma_f32_16x16x32_bf16 v[84:87], v[128:131], v[140:143], v[84:87]
    ds_read_b64 v[214:215], v60 offset:256
    v_mfma_f32_16x16x32_bf16 v[84:87], v[132:135], v[136:139], v[84:87]
    ds_read_b64 v[216:217], v60 offset:264
    s_waitcnt lgkmcnt(14)
    v_mfma_f32_16x16x32_bf16 v[72:75], v[186:189], v[218:221], v[72:75]
    ds_read_b64 v[104:105], v60 offset:3776
    ds_read_b64 v[106:107], v60 offset:3784
    v_mfma_f32_16x16x32_bf16 v[76:79], v[186:189], v[230:233], v[76:79]
    ds_read_b128 v[136:139], v68 offset:224
    v_mfma_f32_16x16x32_bf16 v[80:83], v[186:189], v[234:237], v[80:83]
    ds_read_b128 v[140:143], v68 offset:736
    v_mfma_f32_16x16x32_bf16 v[84:87], v[186:189], v[246:249], v[84:87]
    ds_read_b128 v[144:147], v68 offset:1248
    ds_read_b128 v[148:151], v68 offset:1760
    s_waitcnt lgkmcnt(14)
    v_mfma_f32_16x16x32_bf16 v[76:79], v[190:193], v[226:229], v[76:79]
    ds_read_b128 v[152:155], v68 offset:2272
    v_mfma_f32_16x16x32_bf16 v[80:83], v[190:193], v[230:233], v[80:83]
    ds_read_b128 v[156:159], v68 offset:2784
    v_mfma_f32_16x16x32_bf16 v[84:87], v[190:193], v[242:245], v[84:87]
    ds_read_b128 v[160:163], v68 offset:3296
    ds_read_b128 v[164:167], v68 offset:3808
    v_mfma_f32_16x16x32_bf16 v[76:79], v[194:197], v[222:225], v[76:79]
    ds_read_b64 v[108:109], v60 offset:3264
    v_mfma_f32_16x16x32_bf16 v[80:83], v[194:197], v[226:229], v[80:83]
    ds_read_b64 v[110:111], v60 offset:3272
    v_mfma_f32_16x16x32_bf16 v[84:87], v[194:197], v[238:241], v[84:87]
    ds_read_b64 v[112:113], v60 offset:2752
    ds_read_b64 v[114:115], v60 offset:2760
    v_mfma_f32_16x16x32_bf16 v[76:79], v[198:201], v[218:221], v[76:79]
    ds_read_b64 v[116:117], v60 offset:2240
    v_mfma_f32_16x16x32_bf16 v[80:83], v[198:201], v[222:225], v[80:83]
    ds_read_b64 v[118:119], v60 offset:2248
    v_mfma_f32_16x16x32_bf16 v[84:87], v[198:201], v[234:237], v[84:87]
    ds_read_b64 v[120:121], v60 offset:1728
    ds_read_b64 v[122:123], v60 offset:1736
    s_waitcnt lgkmcnt(14)
    v_mfma_f32_16x16x32_bf16 v[80:83], v[202:205], v[218:221], v[80:83]
    ds_read_b64 v[124:125], v60 offset:1216
    v_mfma_f32_16x16x32_bf16 v[84:87], v[202:205], v[230:233], v[84:87]
    ds_read_b64 v[126:127], v60 offset:1224
    v_mfma_f32_16x16x32_bf16 v[84:87], v[206:209], v[226:229], v[84:87]
    ds_read_b64 v[128:129], v60 offset:704
    ds_read_b64 v[130:131], v60 offset:712
    v_mfma_f32_16x16x32_bf16 v[84:87], v[210:213], v[222:225], v[84:87]
    ds_read_b64 v[132:133], v60 offset:192
    v_mfma_f32_16x16x32_bf16 v[84:87], v[214:217], v[218:221], v[84:87]
    ds_read_b64 v[134:135], v60 offset:200
    v_mfma_f32_16x16x32_bf16 v[72:75], v[104:107], v[136:139], v[72:75]
    ds_read_b64 v[186:187], v60 offset:3712
    ds_read_b64 v[188:189], v60 offset:3720
    s_waitcnt lgkmcnt(14)
    v_mfma_f32_16x16x32_bf16 v[76:79], v[104:107], v[148:151], v[76:79]
    ds_read_b128 v[218:221], v68 offset:160
    v_mfma_f32_16x16x32_bf16 v[80:83], v[104:107], v[152:155], v[80:83]
    ds_read_b128 v[222:225], v68 offset:672
    v_mfma_f32_16x16x32_bf16 v[84:87], v[104:107], v[164:167], v[84:87]
    ds_read_b128 v[226:229], v68 offset:1184
    ds_read_b128 v[230:233], v68 offset:1696
    v_mfma_f32_16x16x32_bf16 v[76:79], v[108:111], v[144:147], v[76:79]
    ds_read_b128 v[234:237], v68 offset:2208
    v_mfma_f32_16x16x32_bf16 v[80:83], v[108:111], v[148:151], v[80:83]
    ds_read_b128 v[238:241], v68 offset:2720
    v_mfma_f32_16x16x32_bf16 v[84:87], v[108:111], v[160:163], v[84:87]
    ds_read_b128 v[242:245], v68 offset:3232
    ds_read_b128 v[246:249], v68 offset:3744
    s_waitcnt lgkmcnt(14)
    v_mfma_f32_16x16x32_bf16 v[76:79], v[112:115], v[140:143], v[76:79]
    ds_read_b64 v[190:191], v60 offset:3200
    v_mfma_f32_16x16x32_bf16 v[80:83], v[112:115], v[144:147], v[80:83]
    ds_read_b64 v[192:193], v60 offset:3208
    v_mfma_f32_16x16x32_bf16 v[84:87], v[112:115], v[156:159], v[84:87]
    ds_read_b64 v[194:195], v60 offset:2688
    ds_read_b64 v[196:197], v60 offset:2696
    v_mfma_f32_16x16x32_bf16 v[76:79], v[116:119], v[136:139], v[76:79]
    ds_read_b64 v[198:199], v60 offset:2176
    v_mfma_f32_16x16x32_bf16 v[80:83], v[116:119], v[140:143], v[80:83]
    ds_read_b64 v[200:201], v60 offset:2184
    v_mfma_f32_16x16x32_bf16 v[84:87], v[116:119], v[152:155], v[84:87]
    ds_read_b64 v[202:203], v60 offset:1664
    ds_read_b64 v[204:205], v60 offset:1672
    v_mfma_f32_16x16x32_bf16 v[80:83], v[120:123], v[136:139], v[80:83]
    ds_read_b64 v[206:207], v60 offset:1152
    v_mfma_f32_16x16x32_bf16 v[84:87], v[120:123], v[148:151], v[84:87]
    ds_read_b64 v[208:209], v60 offset:1160
    v_mfma_f32_16x16x32_bf16 v[84:87], v[124:127], v[144:147], v[84:87]
    ds_read_b64 v[210:211], v60 offset:640
    ds_read_b64 v[212:213], v60 offset:648
    s_waitcnt lgkmcnt(14)
    v_mfma_f32_16x16x32_bf16 v[84:87], v[128:131], v[140:143], v[84:87]
    ds_read_b64 v[214:215], v60 offset:128
    v_mfma_f32_16x16x32_bf16 v[84:87], v[132:135], v[136:139], v[84:87]
    ds_read_b64 v[216:217], v60 offset:136
    v_mfma_f32_16x16x32_bf16 v[72:75], v[186:189], v[218:221], v[72:75]
    ds_read_b64 v[104:105], v60 offset:3648
    ds_read_b64 v[106:107], v60 offset:3656
    v_mfma_f32_16x16x32_bf16 v[76:79], v[186:189], v[230:233], v[76:79]
    ds_read_b128 v[136:139], v68 offset:96
    v_mfma_f32_16x16x32_bf16 v[80:83], v[186:189], v[234:237], v[80:83]
    ds_read_b128 v[140:143], v68 offset:608
    s_waitcnt lgkmcnt(14)
    v_mfma_f32_16x16x32_bf16 v[84:87], v[186:189], v[246:249], v[84:87]
    ds_read_b128 v[144:147], v68 offset:1120
    ds_read_b128 v[148:151], v68 offset:1632
    v_mfma_f32_16x16x32_bf16 v[76:79], v[190:193], v[226:229], v[76:79]
    ds_read_b128 v[152:155], v68 offset:2144
    v_mfma_f32_16x16x32_bf16 v[80:83], v[190:193], v[230:233], v[80:83]
    ds_read_b128 v[156:159], v68 offset:2656
    v_mfma_f32_16x16x32_bf16 v[84:87], v[190:193], v[242:245], v[84:87]
    ds_read_b128 v[160:163], v68 offset:3168
    ds_read_b128 v[164:167], v68 offset:3680
    v_mfma_f32_16x16x32_bf16 v[76:79], v[194:197], v[222:225], v[76:79]
    ds_read_b64 v[108:109], v60 offset:3136
    v_mfma_f32_16x16x32_bf16 v[80:83], v[194:197], v[226:229], v[80:83]
    ds_read_b64 v[110:111], v60 offset:3144
    v_mfma_f32_16x16x32_bf16 v[84:87], v[194:197], v[238:241], v[84:87]
    ds_read_b64 v[112:113], v60 offset:2624
    ds_read_b64 v[114:115], v60 offset:2632
    s_waitcnt lgkmcnt(14)
    v_mfma_f32_16x16x32_bf16 v[76:79], v[198:201], v[218:221], v[76:79]
    ds_read_b64 v[116:117], v60 offset:2112
    v_mfma_f32_16x16x32_bf16 v[80:83], v[198:201], v[222:225], v[80:83]
    ds_read_b64 v[118:119], v60 offset:2120
    v_mfma_f32_16x16x32_bf16 v[84:87], v[198:201], v[234:237], v[84:87]
    ds_read_b64 v[120:121], v60 offset:1600
    ds_read_b64 v[122:123], v60 offset:1608
    v_mfma_f32_16x16x32_bf16 v[80:83], v[202:205], v[218:221], v[80:83]
    ds_read_b64 v[124:125], v60 offset:1088
    v_mfma_f32_16x16x32_bf16 v[84:87], v[202:205], v[230:233], v[84:87]
    ds_read_b64 v[126:127], v60 offset:1096
    v_mfma_f32_16x16x32_bf16 v[84:87], v[206:209], v[226:229], v[84:87]
    ds_read_b64 v[128:129], v60 offset:576
    ds_read_b64 v[130:131], v60 offset:584
    v_mfma_f32_16x16x32_bf16 v[84:87], v[210:213], v[222:225], v[84:87]
    ds_read_b64 v[132:133], v60 offset:64
    v_mfma_f32_16x16x32_bf16 v[84:87], v[214:217], v[218:221], v[84:87]
    ds_read_b64 v[134:135], v60 offset:72
    s_waitcnt lgkmcnt(14)
    v_mfma_f32_16x16x32_bf16 v[72:75], v[104:107], v[136:139], v[72:75]
    ds_read_b64 v[186:187], v60 offset:3584
    ds_read_b64 v[188:189], v60 offset:3592
    v_mfma_f32_16x16x32_bf16 v[76:79], v[104:107], v[148:151], v[76:79]
    ds_read_b128 v[218:221], v68 offset:32
    v_mfma_f32_16x16x32_bf16 v[80:83], v[104:107], v[152:155], v[80:83]
    ds_read_b128 v[222:225], v68 offset:544
    v_mfma_f32_16x16x32_bf16 v[84:87], v[104:107], v[164:167], v[84:87]
    ds_read_b128 v[226:229], v68 offset:1056
    ds_read_b128 v[230:233], v68 offset:1568
    s_waitcnt lgkmcnt(14)
    v_mfma_f32_16x16x32_bf16 v[76:79], v[108:111], v[144:147], v[76:79]
    ds_read_b128 v[234:237], v68 offset:2080
    v_mfma_f32_16x16x32_bf16 v[80:83], v[108:111], v[148:151], v[80:83]
    ds_read_b128 v[238:241], v68 offset:2592
    v_mfma_f32_16x16x32_bf16 v[84:87], v[108:111], v[160:163], v[84:87]
    ds_read_b128 v[242:245], v68 offset:3104
    ds_read_b128 v[246:249], v68 offset:3616
    v_mfma_f32_16x16x32_bf16 v[76:79], v[112:115], v[140:143], v[76:79]
    ds_read_b64 v[190:191], v60 offset:3072
    v_mfma_f32_16x16x32_bf16 v[80:83], v[112:115], v[144:147], v[80:83]
    ds_read_b64 v[192:193], v60 offset:3080
    v_mfma_f32_16x16x32_bf16 v[84:87], v[112:115], v[156:159], v[84:87]
    ds_read_b64 v[194:195], v60 offset:2560
    ds_read_b64 v[196:197], v60 offset:2568
    v_mfma_f32_16x16x32_bf16 v[76:79], v[116:119], v[136:139], v[76:79]
    ds_read_b64 v[198:199], v60 offset:2048
    v_mfma_f32_16x16x32_bf16 v[80:83], v[116:119], v[140:143], v[80:83]
    ds_read_b64 v[200:201], v60 offset:2056
    v_mfma_f32_16x16x32_bf16 v[84:87], v[116:119], v[152:155], v[84:87]
    ds_read_b64 v[202:203], v60 offset:1536
    ds_read_b64 v[204:205], v60 offset:1544
    s_waitcnt lgkmcnt(14)
    v_mfma_f32_16x16x32_bf16 v[80:83], v[120:123], v[136:139], v[80:83]
    ds_read_b64 v[206:207], v60 offset:1024
    v_mfma_f32_16x16x32_bf16 v[84:87], v[120:123], v[148:151], v[84:87]
    ds_read_b64 v[208:209], v60 offset:1032
    v_mfma_f32_16x16x32_bf16 v[84:87], v[124:127], v[144:147], v[84:87]
    ds_read_b64 v[210:211], v60 offset:512
    ds_read_b64 v[212:213], v60 offset:520
    v_mfma_f32_16x16x32_bf16 v[84:87], v[128:131], v[140:143], v[84:87]
    ds_read_b64 v[214:215], v60 offset:0
    v_mfma_f32_16x16x32_bf16 v[84:87], v[132:135], v[136:139], v[84:87]
    ds_read_b64 v[216:217], v60 offset:8
    v_mfma_f32_16x16x32_bf16 v[72:75], v[186:189], v[218:221], v[72:75]
    s_waitcnt lgkmcnt(14)
    v_mfma_f32_16x16x32_bf16 v[76:79], v[186:189], v[230:233], v[76:79]
    v_mfma_f32_16x16x32_bf16 v[80:83], v[186:189], v[234:237], v[80:83]
    v_mfma_f32_16x16x32_bf16 v[84:87], v[186:189], v[246:249], v[84:87]
    s_waitcnt lgkmcnt(12)
    v_mfma_f32_16x16x32_bf16 v[76:79], v[190:193], v[226:229], v[76:79]
    v_mfma_f32_16x16x32_bf16 v[80:83], v[190:193], v[230:233], v[80:83]
    v_mfma_f32_16x16x32_bf16 v[84:87], v[190:193], v[242:245], v[84:87]
    s_waitcnt lgkmcnt(10)
    v_mfma_f32_16x16x32_bf16 v[76:79], v[194:197], v[222:225], v[76:79]
    v_mfma_f32_16x16x32_bf16 v[80:83], v[194:197], v[226:229], v[80:83]
    v_mfma_f32_16x16x32_bf16 v[84:87], v[194:197], v[238:241], v[84:87]
    s_waitcnt lgkmcnt(8)
    v_mfma_f32_16x16x32_bf16 v[76:79], v[198:201], v[218:221], v[76:79]
    v_mfma_f32_16x16x32_bf16 v[80:83], v[198:201], v[222:225], v[80:83]
    v_mfma_f32_16x16x32_bf16 v[84:87], v[198:201], v[234:237], v[84:87]
    s_waitcnt lgkmcnt(6)
    v_mfma_f32_16x16x32_bf16 v[80:83], v[202:205], v[218:221], v[80:83]
    v_mfma_f32_16x16x32_bf16 v[84:87], v[202:205], v[230:233], v[84:87]
    s_waitcnt lgkmcnt(4)
    v_mfma_f32_16x16x32_bf16 v[84:87], v[206:209], v[226:229], v[84:87]
    s_waitcnt lgkmcnt(2)
    v_mfma_f32_16x16x32_bf16 v[84:87], v[210:213], v[222:225], v[84:87]
    s_waitcnt lgkmcnt(0)
    v_mfma_f32_16x16x32_bf16 v[84:87], v[214:217], v[218:221], v[84:87]
    ds_read_b64 v[104:105], v16 offset:512
    ds_read_b64 v[112:113], v17 offset:18432
    ds_read_b64 v[106:107], v16 offset:2048
    ds_read_b64 v[114:115], v17 offset:19968
    ds_read_b64 v[108:109], v16 offset:2560
    ds_read_b64 v[116:117], v17 offset:20480
    ds_read_b64 v[110:111], v16 offset:4096
    ds_read_b64 v[118:119], v17 offset:22016
    s_and_b32 s46, s28, 1
    s_lshr_b32 s47, s28, 1
    s_cmp_eq_u32 s47, 0
    s_cselect_b32 s48, s92, s93
    s_lshl_b32 s49, s48, 16
    s_and_b32 s48, s48, 0xffff0000
    s_cmp_eq_u32 s46, 0
    s_cselect_b32 s48, s49, s48
    v_mov_b32 v136, s48
    s_waitcnt lgkmcnt(7)
    v_lshlrev_b32 v140, 16, v104
    v_and_b32 v141, 0xffff0000, v104
    s_waitcnt lgkmcnt(6)
    v_lshlrev_b32 v144, 16, v112
    v_and_b32 v145, 0xffff0000, v112
    v_lshlrev_b32 v142, 16, v105
    v_and_b32 v143, 0xffff0000, v105
    v_lshlrev_b32 v146, 16, v113
    v_and_b32 v147, 0xffff0000, v113
    s_waitcnt lgkmcnt(5)
    v_lshlrev_b32 v148, 16, v106
    v_and_b32 v149, 0xffff0000, v106
    s_waitcnt lgkmcnt(4)
    v_lshlrev_b32 v152, 16, v114
    v_and_b32 v153, 0xffff0000, v114
    v_lshlrev_b32 v150, 16, v107
    v_and_b32 v151, 0xffff0000, v107
    v_lshlrev_b32 v154, 16, v115
    v_and_b32 v155, 0xffff0000, v115
    s_waitcnt lgkmcnt(3)
    v_lshlrev_b32 v156, 16, v108
    v_and_b32 v157, 0xffff0000, v108
    s_waitcnt lgkmcnt(2)
    v_lshlrev_b32 v160, 16, v116
    v_and_b32 v161, 0xffff0000, v116
    v_lshlrev_b32 v158, 16, v109
    v_and_b32 v159, 0xffff0000, v109
    v_lshlrev_b32 v162, 16, v117
    v_and_b32 v163, 0xffff0000, v117
    s_waitcnt lgkmcnt(1)
    v_lshlrev_b32 v164, 16, v110
    v_and_b32 v165, 0xffff0000, v110
    s_waitcnt lgkmcnt(0)
    v_lshlrev_b32 v168, 16, v118
    v_and_b32 v169, 0xffff0000, v118
    v_lshlrev_b32 v166, 16, v111
    v_and_b32 v167, 0xffff0000, v111
    v_lshlrev_b32 v170, 16, v119
    v_and_b32 v171, 0xffff0000, v119
    v_pk_fma_f32 v[72:73], v[140:141], v[136:137], v[72:73] op_sel:[0,0,0] op_sel_hi:[1,0,1]
    v_pk_fma_f32 v[74:75], v[142:143], v[136:137], v[74:75] op_sel:[0,0,0] op_sel_hi:[1,0,1]
    v_pk_fma_f32 v[76:77], v[148:149], v[136:137], v[76:77] op_sel:[0,0,0] op_sel_hi:[1,0,1]
    v_pk_fma_f32 v[78:79], v[150:151], v[136:137], v[78:79] op_sel:[0,0,0] op_sel_hi:[1,0,1]
    v_pk_fma_f32 v[80:81], v[156:157], v[136:137], v[80:81] op_sel:[0,0,0] op_sel_hi:[1,0,1]
    v_pk_fma_f32 v[82:83], v[158:159], v[136:137], v[82:83] op_sel:[0,0,0] op_sel_hi:[1,0,1]
    v_pk_fma_f32 v[84:85], v[164:165], v[136:137], v[84:85] op_sel:[0,0,0] op_sel_hi:[1,0,1]
    v_pk_fma_f32 v[86:87], v[166:167], v[136:137], v[86:87] op_sel:[0,0,0] op_sel_hi:[1,0,1]
    v_pk_add_f32 v[72:73], v[72:73], v[144:145]
    v_pk_add_f32 v[74:75], v[74:75], v[146:147]
    v_pk_add_f32 v[76:77], v[76:77], v[152:153]
    v_pk_add_f32 v[78:79], v[78:79], v[154:155]
    v_pk_add_f32 v[80:81], v[80:81], v[160:161]
    v_pk_add_f32 v[82:83], v[82:83], v[162:163]
    v_pk_add_f32 v[84:85], v[84:85], v[168:169]
    v_pk_add_f32 v[86:87], v[86:87], v[170:171]
    v_cvt_pk_bf16_f32 v120, v72, v73
    v_cvt_pk_bf16_f32 v121, v74, v75
    ds_write_b64 v18, v[120:121] offset:34816
    v_cvt_pk_bf16_f32 v122, v76, v77
    v_cvt_pk_bf16_f32 v123, v78, v79
    ds_write_b64 v18, v[122:123] offset:35328
    v_cvt_pk_bf16_f32 v124, v80, v81
    v_cvt_pk_bf16_f32 v125, v82, v83
    ds_write_b64 v18, v[124:125] offset:35840
    v_cvt_pk_bf16_f32 v126, v84, v85
    v_cvt_pk_bf16_f32 v127, v86, v87
    ds_write_b64 v18, v[126:127] offset:36352
    s_branch BL1_JOIN
BL1_TS1:
    ds_read_b64 v[104:105], v60 offset:4032
    ds_read_b64 v[106:107], v60 offset:4040
    ds_read_b128 v[136:139], v68 offset:480
    ds_read_b128 v[140:143], v68 offset:992
    ds_read_b128 v[144:147], v68 offset:1504
    ds_read_b128 v[148:151], v68 offset:2016
    ds_read_b128 v[152:155], v68 offset:2528
    ds_read_b128 v[156:159], v68 offset:3040
    ds_read_b128 v[160:163], v68 offset:3552
    ds_read_b64 v[108:109], v60 offset:3520
    ds_read_b64 v[110:111], v60 offset:3528
    ds_read_b64 v[112:113], v60 offset:3008
    ds_read_b64 v[114:115], v60 offset:3016
    ds_read_b64 v[116:117], v60 offset:2496
    ds_read_b64 v[118:119], v60 offset:2504
    ds_read_b64 v[120:121], v60 offset:1984
    ds_read_b64 v[122:123], v60 offset:1992
    ds_read_b64 v[124:125], v60 offset:1472
    ds_read_b64 v[126:127], v60 offset:1480
    ds_read_b64 v[128:129], v60 offset:960
    ds_read_b64 v[130:131], v60 offset:968
    s_waitcnt lgkmcnt(14)
    v_mfma_f32_16x16x32_bf16 v[72:75], v[104:107], v[140:143], v[72:75]
    ds_read_b64 v[186:187], v60 offset:3968
    ds_read_b64 v[188:189], v60 offset:3976
    v_mfma_f32_16x16x32_bf16 v[76:79], v[104:107], v[144:147], v[76:79]
    ds_read_b128 v[218:221], v68 offset:416
    s_waitcnt lgkmcnt(14)
    v_mfma_f32_16x16x32_bf16 v[80:83], v[104:107], v[156:159], v[80:83]
    ds_read_b128 v[222:225], v68 offset:928
    v_mfma_f32_16x16x32_bf16 v[84:87], v[104:107], v[160:163], v[84:87]
    ds_read_b128 v[226:229], v68 offset:1440
    s_waitcnt lgkmcnt(14)
    v_mfma_f32_16x16x32_bf16 v[72:75], v[108:111], v[136:139], v[72:75]
    ds_read_b128 v[230:233], v68 offset:1952
    v_mfma_f32_16x16x32_bf16 v[76:79], v[108:111], v[140:143], v[76:79]
    ds_read_b128 v[234:237], v68 offset:2464
    v_mfma_f32_16x16x32_bf16 v[80:83], v[108:111], v[152:155], v[80:83]
    ds_read_b128 v[238:241], v68 offset:2976
    ds_read_b128 v[242:245], v68 offset:3488
    v_mfma_f32_16x16x32_bf16 v[84:87], v[108:111], v[156:159], v[84:87]
    ds_read_b64 v[190:191], v60 offset:3456
    s_waitcnt lgkmcnt(14)
    v_mfma_f32_16x16x32_bf16 v[76:79], v[112:115], v[136:139], v[76:79]
    ds_read_b64 v[192:193], v60 offset:3464
    v_mfma_f32_16x16x32_bf16 v[80:83], v[112:115], v[148:151], v[80:83]
    ds_read_b64 v[194:195], v60 offset:2944
    v_mfma_f32_16x16x32_bf16 v[84:87], v[112:115], v[152:155], v[84:87]
    ds_read_b64 v[196:197], v60 offset:2952
    v_mfma_f32_16x16x32_bf16 v[80:83], v[116:119], v[144:147], v[80:83]
    ds_read_b64 v[198:199], v60 offset:2432
    v_mfma_f32_16x16x32_bf16 v[84:87], v[116:119], v[148:151], v[84:87]
    ds_read_b64 v[200:201], v60 offset:2440
    ds_read_b64 v[202:203], v60 offset:1920
    v_mfma_f32_16x16x32_bf16 v[80:83], v[120:123], v[140:143], v[80:83]
    ds_read_b64 v[204:205], v60 offset:1928
    v_mfma_f32_16x16x32_bf16 v[84:87], v[120:123], v[144:147], v[84:87]
    ds_read_b64 v[206:207], v60 offset:1408
    s_waitcnt lgkmcnt(14)
    v_mfma_f32_16x16x32_bf16 v[80:83], v[124:127], v[136:139], v[80:83]
    ds_read_b64 v[208:209], v60 offset:1416
    v_mfma_f32_16x16x32_bf16 v[84:87], v[124:127], v[140:143], v[84:87]
    ds_read_b64 v[210:211], v60 offset:896
    v_mfma_f32_16x16x32_bf16 v[84:87], v[128:131], v[136:139], v[84:87]
    ds_read_b64 v[212:213], v60 offset:904
    v_mfma_f32_16x16x32_bf16 v[72:75], v[186:189], v[222:225], v[72:75]
    ds_read_b64 v[104:105], v60 offset:3904
    ds_read_b64 v[106:107], v60 offset:3912
    s_waitcnt lgkmcnt(14)
    v_mfma_f32_16x16x32_bf16 v[76:79], v[186:189], v[226:229], v[76:79]
    ds_read_b128 v[136:139], v68 offset:352
    v_mfma_f32_16x16x32_bf16 v[80:83], v[186:189], v[238:241], v[80:83]
    ds_read_b128 v[140:143], v68 offset:864
    v_mfma_f32_16x16x32_bf16 v[84:87], v[186:189], v[242:245], v[84:87]
    ds_read_b128 v[144:147], v68 offset:1376
    s_waitcnt lgkmcnt(14)
    v_mfma_f32_16x16x32_bf16 v[72:75], v[190:193], v[218:221], v[72:75]
    ds_read_b128 v[148:151], v68 offset:1888
    v_mfma_f32_16x16x32_bf16 v[76:79], v[190:193], v[222:225], v[76:79]
    ds_read_b128 v[152:155], v68 offset:2400
    v_mfma_f32_16x16x32_bf16 v[80:83], v[190:193], v[234:237], v[80:83]
    ds_read_b128 v[156:159], v68 offset:2912
    ds_read_b128 v[160:163], v68 offset:3424
    v_mfma_f32_16x16x32_bf16 v[84:87], v[190:193], v[238:241], v[84:87]
    ds_read_b64 v[108:109], v60 offset:3392
    s_waitcnt lgkmcnt(14)
    v_mfma_f32_16x16x32_bf16 v[76:79], v[194:197], v[218:221], v[76:79]
    ds_read_b64 v[110:111], v60 offset:3400
    v_mfma_f32_16x16x32_bf16 v[80:83], v[194:197], v[230:233], v[80:83]
    ds_read_b64 v[112:113], v60 offset:2880
    v_mfma_f32_16x16x32_bf16 v[84:87], v[194:197], v[234:237], v[84:87]
    ds_read_b64 v[114:115], v60 offset:2888
    v_mfma_f32_16x16x32_bf16 v[80:83], v[198:201], v[226:229], v[80:83]
    ds_read_b64 v[116:117], v60 offset:2368
    v_mfma_f32_16x16x32_bf16 v[84:87], v[198:201], v[230:233], v[84:87]
    ds_read_b64 v[118:119], v60 offset:2376
    ds_read_b64 v[120:121], v60 offset:1856
    v_mfma_f32_16x16x32_bf16 v[80:83], v[202:205], v[222:225], v[80:83]
    ds_read_b64 v[122:123], v60 offset:1864
    v_mfma_f32_16x16x32_bf16 v[84:87], v[202:205], v[226:229], v[84:87]
    ds_read_b64 v[124:125], v60 offset:1344
    s_waitcnt lgkmcnt(14)
    v_mfma_f32_16x16x32_bf16 v[80:83], v[206:209], v[218:221], v[80:83]
    ds_read_b64 v[126:127], v60 offset:1352
    v_mfma_f32_16x16x32_bf16 v[84:87], v[206:209], v[222:225], v[84:87]
    ds_read_b64 v[128:129], v60 offset:832
    v_mfma_f32_16x16x32_bf16 v[84:87], v[210:213], v[218:221], v[84:87]
    ds_read_b64 v[130:131], v60 offset:840
    v_mfma_f32_16x16x32_bf16 v[72:75], v[104:107], v[140:143], v[72:75]
    ds_read_b64 v[186:187], v60 offset:3840
    ds_read_b64 v[188:189], v60 offset:3848
    s_waitcnt lgkmcnt(14)
    v_mfma_f32_16x16x32_bf16 v[76:79], v[104:107], v[144:147], v[76:79]
    ds_read_b128 v[218:221], v68 offset:288
    v_mfma_f32_16x16x32_bf16 v[80:83], v[104:107], v[156:159], v[80:83]
    ds_read_b128 v[222:225], v68 offset:800
    v_mfma_f32_16x16x32_bf16 v[84:87], v[104:107], v[160:163], v[84:87]
    ds_read_b128 v[226:229], v68 offset:1312
    s_waitcnt lgkmcnt(14)
    v_mfma_f32_16x16x32_bf16 v[72:75], v[108:111], v[136:139], v[72:75]
    ds_read_b128 v[230:233], v68 offset:1824
    v_mfma_f32_16x16x32_bf16 v[76:79], v[108:111], v[140:143], v[76:79]
    ds_read_b128 v[234:237], v68 offset:2336
    v_mfma_f32_16x16x32_bf16 v[80:83], v[108:111], v[152:155], v[80:83]
    ds_read_b128 v[238:241], v68 offset:2848
    ds_read_b128 v[242:245], v68 offset:3360
    v_mfma_f32_16x16x32_bf16 v[84:87], v[108:111], v[156:159], v[84:87]
    ds_read_b64 v[190:191], v60 offset:3328
    s_waitcnt lgkmcnt(14)
    v_mfma_f32_16x16x32_bf16 v[76:79], v[112:115], v[136:139], v[76:79]
    ds_read_b64 v[192:193], v60 offset:3336
    v_mfma_f32_16x16x32_bf16 v[80:83], v[112:115], v[148:151], v[80:83]
    ds_read_b64 v[194:195], v60 offset:2816
    v_mfma_f32_16x16x32_bf16 v[84:87], v[112:115], v[152:155], v[84:87]
    ds_read_b64 v[196:197], v60 offset:2824
    v_mfma_f32_16x16x32_bf16 v[80:83], v[116:119], v[144:147], v[80:83]
    ds_read_b64 v[198:199], v60 offset:2304
    v_mfma_f32_16x16x32_bf16 v[84:87], v[116:119], v[148:151], v[84:87]
    ds_read_b64 v[200:201], v60 offset:2312
    ds_read_b64 v[202:203], v60 offset:1792
    v_mfma_f32_16x16x32_bf16 v[80:83], v[120:123], v[140:143], v[80:83]
    ds_read_b64 v[204:205], v60 offset:1800
    v_mfma_f32_16x16x32_bf16 v[84:87], v[120:123], v[144:147], v[84:87]
    ds_read_b64 v[206:207], v60 offset:1280
    s_waitcnt lgkmcnt(14)
    v_mfma_f32_16x16x32_bf16 v[80:83], v[124:127], v[136:139], v[80:83]
    ds_read_b64 v[208:209], v60 offset:1288
    v_mfma_f32_16x16x32_bf16 v[84:87], v[124:127], v[140:143], v[84:87]
    ds_read_b64 v[210:211], v60 offset:768
    v_mfma_f32_16x16x32_bf16 v[84:87], v[128:131], v[136:139], v[84:87]
    ds_read_b64 v[212:213], v60 offset:776
    v_mfma_f32_16x16x32_bf16 v[72:75], v[186:189], v[222:225], v[72:75]
    ds_read_b64 v[104:105], v60 offset:3776
    ds_read_b64 v[106:107], v60 offset:3784
    s_waitcnt lgkmcnt(14)
    v_mfma_f32_16x16x32_bf16 v[76:79], v[186:189], v[226:229], v[76:79]
    ds_read_b128 v[136:139], v68 offset:224
    v_mfma_f32_16x16x32_bf16 v[80:83], v[186:189], v[238:241], v[80:83]
    ds_read_b128 v[140:143], v68 offset:736
    v_mfma_f32_16x16x32_bf16 v[84:87], v[186:189], v[242:245], v[84:87]
    ds_read_b128 v[144:147], v68 offset:1248
    s_waitcnt lgkmcnt(14)
    v_mfma_f32_16x16x32_bf16 v[72:75], v[190:193], v[218:221], v[72:75]
    ds_read_b128 v[148:151], v68 offset:1760
    v_mfma_f32_16x16x32_bf16 v[76:79], v[190:193], v[222:225], v[76:79]
    ds_read_b128 v[152:155], v68 offset:2272
    v_mfma_f32_16x16x32_bf16 v[80:83], v[190:193], v[234:237], v[80:83]
    ds_read_b128 v[156:159], v68 offset:2784
    ds_read_b128 v[160:163], v68 offset:3296
    v_mfma_f32_16x16x32_bf16 v[84:87], v[190:193], v[238:241], v[84:87]
    ds_read_b64 v[108:109], v60 offset:3264
    s_waitcnt lgkmcnt(14)
    v_mfma_f32_16x16x32_bf16 v[76:79], v[194:197], v[218:221], v[76:79]
    ds_read_b64 v[110:111], v60 offset:3272
    v_mfma_f32_16x16x32_bf16 v[80:83], v[194:197], v[230:233], v[80:83]
    ds_read_b64 v[112:113], v60 offset:2752
    v_mfma_f32_16x16x32_bf16 v[84:87], v[194:197], v[234:237], v[84:87]
    ds_read_b64 v[114:115], v60 offset:2760
    v_mfma_f32_16x16x32_bf16 v[80:83], v[198:201], v[226:229], v[80:83]
    ds_read_b64 v[116:117], v60 offset:2240
    v_mfma_f32_16x16x32_bf16 v[84:87], v[198:201], v[230:233], v[84:87]
    ds_read_b64 v[118:119], v60 offset:2248
    ds_read_b64 v[120:121], v60 offset:1728
    v_mfma_f32_16x16x32_bf16 v[80:83], v[202:205], v[222:225], v[80:83]
    ds_read_b64 v[122:123], v60 offset:1736
    v_mfma_f32_16x16x32_bf16 v[84:87], v[202:205], v[226:229], v[84:87]
    ds_read_b64 v[124:125], v60 offset:1216
    s_waitcnt lgkmcnt(14)
    v_mfma_f32_16x16x32_bf16 v[80:83], v[206:209], v[218:221], v[80:83]
    ds_read_b64 v[126:127], v60 offset:1224
    v_mfma_f32_16x16x32_bf16 v[84:87], v[206:209], v[222:225], v[84:87]
    ds_read_b64 v[128:129], v60 offset:704
    v_mfma_f32_16x16x32_bf16 v[84:87], v[210:213], v[218:221], v[84:87]
    ds_read_b64 v[130:131], v60 offset:712
    v_mfma_f32_16x16x32_bf16 v[72:75], v[104:107], v[140:143], v[72:75]
    ds_read_b64 v[186:187], v60 offset:3712
    ds_read_b64 v[188:189], v60 offset:3720
    s_waitcnt lgkmcnt(14)
    v_mfma_f32_16x16x32_bf16 v[76:79], v[104:107], v[144:147], v[76:79]
    ds_read_b128 v[218:221], v68 offset:160
    v_mfma_f32_16x16x32_bf16 v[80:83], v[104:107], v[156:159], v[80:83]
    ds_read_b128 v[222:225], v68 offset:672
    v_mfma_f32_16x16x32_bf16 v[84:87], v[104:107], v[160:163], v[84:87]
    ds_read_b128 v[226:229], v68 offset:1184
    s_waitcnt lgkmcnt(14)
    v_mfma_f32_16x16x32_bf16 v[72:75], v[108:111], v[136:139], v[72:75]
    ds_read_b128 v[230:233], v68 offset:1696
    v_mfma_f32_16x16x32_bf16 v[76:79], v[108:111], v[140:143], v[76:79]
    ds_read_b128 v[234:237], v68 offset:2208
    v_mfma_f32_16x16x32_bf16 v[80:83], v[108:111], v[152:155], v[80:83]
    ds_read_b128 v[238:241], v68 offset:2720
    ds_read_b128 v[242:245], v68 offset:3232
    v_mfma_f32_16x16x32_bf16 v[84:87], v[108:111], v[156:159], v[84:87]
    ds_read_b64 v[190:191], v60 offset:3200
    s_waitcnt lgkmcnt(14)
    v_mfma_f32_16x16x32_bf16 v[76:79], v[112:115], v[136:139], v[76:79]
    ds_read_b64 v[192:193], v60 offset:3208
    v_mfma_f32_16x16x32_bf16 v[80:83], v[112:115], v[148:151], v[80:83]
    ds_read_b64 v[194:195], v60 offset:2688
    v_mfma_f32_16x16x32_bf16 v[84:87], v[112:115], v[152:155], v[84:87]
    ds_read_b64 v[196:197], v60 offset:2696
    v_mfma_f32_16x16x32_bf16 v[80:83], v[116:119], v[144:147], v[80:83]
    ds_read_b64 v[198:199], v60 offset:2176
    v_mfma_f32_16x16x32_bf16 v[84:87], v[116:119], v[148:151], v[84:87]
    ds_read_b64 v[200:201], v60 offset:2184
    ds_read_b64 v[202:203], v60 offset:1664
    v_mfma_f32_16x16x32_bf16 v[80:83], v[120:123], v[140:143], v[80:83]
    ds_read_b64 v[204:205], v60 offset:1672
    v_mfma_f32_16x16x32_bf16 v[84:87], v[120:123], v[144:147], v[84:87]
    ds_read_b64 v[206:207], v60 offset:1152
    s_waitcnt lgkmcnt(14)
    v_mfma_f32_16x16x32_bf16 v[80:83], v[124:127], v[136:139], v[80:83]
    ds_read_b64 v[208:209], v60 offset:1160
    v_mfma_f32_16x16x32_bf16 v[84:87], v[124:127], v[140:143], v[84:87]
    ds_read_b64 v[210:211], v60 offset:640
    v_mfma_f32_16x16x32_bf16 v[84:87], v[128:131], v[136:139], v[84:87]
    ds_read_b64 v[212:213], v60 offset:648
    v_mfma_f32_16x16x32_bf16 v[72:75], v[186:189], v[222:225], v[72:75]
    ds_read_b64 v[104:105], v60 offset:3648
    ds_read_b64 v[106:107], v60 offset:3656
    s_waitcnt lgkmcnt(14)
    v_mfma_f32_16x16x32_bf16 v[76:79], v[186:189], v[226:229], v[76:79]
    ds_read_b128 v[136:139], v68 offset:96
    v_mfma_f32_16x16x32_bf16 v[80:83], v[186:189], v[238:241], v[80:83]
    ds_read_b128 v[140:143], v68 offset:608
    v_mfma_f32_16x16x32_bf16 v[84:87], v[186:189], v[242:245], v[84:87]
    ds_read_b128 v[144:147], v68 offset:1120
    s_waitcnt lgkmcnt(14)
    v_mfma_f32_16x16x32_bf16 v[72:75], v[190:193], v[218:221], v[72:75]
    ds_read_b128 v[148:151], v68 offset:1632
    v_mfma_f32_16x16x32_bf16 v[76:79], v[190:193], v[222:225], v[76:79]
    ds_read_b128 v[152:155], v68 offset:2144
    v_mfma_f32_16x16x32_bf16 v[80:83], v[190:193], v[234:237], v[80:83]
    ds_read_b128 v[156:159], v68 offset:2656
    ds_read_b128 v[160:163], v68 offset:3168
    v_mfma_f32_16x16x32_bf16 v[84:87], v[190:193], v[238:241], v[84:87]
    ds_read_b64 v[108:109], v60 offset:3136
    s_waitcnt lgkmcnt(14)
    v_mfma_f32_16x16x32_bf16 v[76:79], v[194:197], v[218:221], v[76:79]
    ds_read_b64 v[110:111], v60 offset:3144
    v_mfma_f32_16x16x32_bf16 v[80:83], v[194:197], v[230:233], v[80:83]
    ds_read_b64 v[112:113], v60 offset:2624
    v_mfma_f32_16x16x32_bf16 v[84:87], v[194:197], v[234:237], v[84:87]
    ds_read_b64 v[114:115], v60 offset:2632
    v_mfma_f32_16x16x32_bf16 v[80:83], v[198:201], v[226:229], v[80:83]
    ds_read_b64 v[116:117], v60 offset:2112
    v_mfma_f32_16x16x32_bf16 v[84:87], v[198:201], v[230:233], v[84:87]
    ds_read_b64 v[118:119], v60 offset:2120
    ds_read_b64 v[120:121], v60 offset:1600
    v_mfma_f32_16x16x32_bf16 v[80:83], v[202:205], v[222:225], v[80:83]
    ds_read_b64 v[122:123], v60 offset:1608
    v_mfma_f32_16x16x32_bf16 v[84:87], v[202:205], v[226:229], v[84:87]
    ds_read_b64 v[124:125], v60 offset:1088
    s_waitcnt lgkmcnt(14)
    v_mfma_f32_16x16x32_bf16 v[80:83], v[206:209], v[218:221], v[80:83]
    ds_read_b64 v[126:127], v60 offset:1096
    v_mfma_f32_16x16x32_bf16 v[84:87], v[206:209], v[222:225], v[84:87]
    ds_read_b64 v[128:129], v60 offset:576
    v_mfma_f32_16x16x32_bf16 v[84:87], v[210:213], v[218:221], v[84:87]
    ds_read_b64 v[130:131], v60 offset:584
    v_mfma_f32_16x16x32_bf16 v[72:75], v[104:107], v[140:143], v[72:75]
    ds_read_b64 v[186:187], v60 offset:3584
    ds_read_b64 v[188:189], v60 offset:3592
    s_waitcnt lgkmcnt(14)
    v_mfma_f32_16x16x32_bf16 v[76:79], v[104:107], v[144:147], v[76:79]
    ds_read_b128 v[218:221], v68 offset:32
    v_mfma_f32_16x16x32_bf16 v[80:83], v[104:107], v[156:159], v[80:83]
    ds_read_b128 v[222:225], v68 offset:544
    v_mfma_f32_16x16x32_bf16 v[84:87], v[104:107], v[160:163], v[84:87]
    ds_read_b128 v[226:229], v68 offset:1056
    s_waitcnt lgkmcnt(14)
    v_mfma_f32_16x16x32_bf16 v[72:75], v[108:111], v[136:139], v[72:75]
    ds_read_b128 v[230:233], v68 offset:1568
    v_mfma_f32_16x16x32_bf16 v[76:79], v[108:111], v[140:143], v[76:79]
    ds_read_b128 v[234:237], v68 offset:2080
    v_mfma_f32_16x16x32_bf16 v[80:83], v[108:111], v[152:155], v[80:83]
    ds_read_b128 v[238:241], v68 offset:2592
    ds_read_b128 v[242:245], v68 offset:3104
    v_mfma_f32_16x16x32_bf16 v[84:87], v[108:111], v[156:159], v[84:87]
    ds_read_b64 v[190:191], v60 offset:3072
    s_waitcnt lgkmcnt(14)
    v_mfma_f32_16x16x32_bf16 v[76:79], v[112:115], v[136:139], v[76:79]
    ds_read_b64 v[192:193], v60 offset:3080
    v_mfma_f32_16x16x32_bf16 v[80:83], v[112:115], v[148:151], v[80:83]
    ds_read_b64 v[194:195], v60 offset:2560
    v_mfma_f32_16x16x32_bf16 v[84:87], v[112:115], v[152:155], v[84:87]
    ds_read_b64 v[196:197], v60 offset:2568
    v_mfma_f32_16x16x32_bf16 v[80:83], v[116:119], v[144:147], v[80:83]
    ds_read_b64 v[198:199], v60 offset:2048
    v_mfma_f32_16x16x32_bf16 v[84:87], v[116:119], v[148:151], v[84:87]
    ds_read_b64 v[200:201], v60 offset:2056
    ds_read_b64 v[202:203], v60 offset:1536
    v_mfma_f32_16x16x32_bf16 v[80:83], v[120:123], v[140:143], v[80:83]
    ds_read_b64 v[204:205], v60 offset:1544
    v_mfma_f32_16x16x32_bf16 v[84:87], v[120:123], v[144:147], v[84:87]
    ds_read_b64 v[206:207], v60 offset:1024
    s_waitcnt lgkmcnt(14)
    v_mfma_f32_16x16x32_bf16 v[80:83], v[124:127], v[136:139], v[80:83]
    ds_read_b64 v[208:209], v60 offset:1032
    v_mfma_f32_16x16x32_bf16 v[84:87], v[124:127], v[140:143], v[84:87]
    ds_read_b64 v[210:211], v60 offset:512
    v_mfma_f32_16x16x32_bf16 v[84:87], v[128:131], v[136:139], v[84:87]
    ds_read_b64 v[212:213], v60 offset:520
    v_mfma_f32_16x16x32_bf16 v[72:75], v[186:189], v[222:225], v[72:75]
    s_waitcnt lgkmcnt(14)
    v_mfma_f32_16x16x32_bf16 v[76:79], v[186:189], v[226:229], v[76:79]
    s_waitcnt lgkmcnt(13)
    v_mfma_f32_16x16x32_bf16 v[80:83], v[186:189], v[238:241], v[80:83]
    s_waitcnt lgkmcnt(12)
    v_mfma_f32_16x16x32_bf16 v[84:87], v[186:189], v[242:245], v[84:87]
    s_waitcnt lgkmcnt(10)
    v_mfma_f32_16x16x32_bf16 v[72:75], v[190:193], v[218:221], v[72:75]
    v_mfma_f32_16x16x32_bf16 v[76:79], v[190:193], v[222:225], v[76:79]
    v_mfma_f32_16x16x32_bf16 v[80:83], v[190:193], v[234:237], v[80:83]
    v_mfma_f32_16x16x32_bf16 v[84:87], v[190:193], v[238:241], v[84:87]
    s_waitcnt lgkmcnt(8)
    v_mfma_f32_16x16x32_bf16 v[76:79], v[194:197], v[218:221], v[76:79]
    v_mfma_f32_16x16x32_bf16 v[80:83], v[194:197], v[230:233], v[80:83]
    v_mfma_f32_16x16x32_bf16 v[84:87], v[194:197], v[234:237], v[84:87]
    s_waitcnt lgkmcnt(6)
    v_mfma_f32_16x16x32_bf16 v[80:83], v[198:201], v[226:229], v[80:83]
    v_mfma_f32_16x16x32_bf16 v[84:87], v[198:201], v[230:233], v[84:87]
    s_waitcnt lgkmcnt(4)
    v_mfma_f32_16x16x32_bf16 v[80:83], v[202:205], v[222:225], v[80:83]
    v_mfma_f32_16x16x32_bf16 v[84:87], v[202:205], v[226:229], v[84:87]
    s_waitcnt lgkmcnt(2)
    v_mfma_f32_16x16x32_bf16 v[80:83], v[206:209], v[218:221], v[80:83]
    v_mfma_f32_16x16x32_bf16 v[84:87], v[206:209], v[222:225], v[84:87]
    s_waitcnt lgkmcnt(0)
    v_mfma_f32_16x16x32_bf16 v[84:87], v[210:213], v[218:221], v[84:87]
    ds_read_b64 v[104:105], v16 offset:1024
    ds_read_b64 v[112:113], v17 offset:18944
    ds_read_b64 v[106:107], v16 offset:1536
    ds_read_b64 v[114:115], v17 offset:19456
    ds_read_b64 v[108:109], v16 offset:3072
    ds_read_b64 v[116:117], v17 offset:20992
    ds_read_b64 v[110:111], v16 offset:3584
    ds_read_b64 v[118:119], v17 offset:21504
    s_and_b32 s46, s28, 1
    s_lshr_b32 s47, s28, 1
    s_cmp_eq_u32 s47, 0
    s_cselect_b32 s48, s92, s93
    s_lshl_b32 s49, s48, 16
    s_and_b32 s48, s48, 0xffff0000
    s_cmp_eq_u32 s46, 0
    s_cselect_b32 s48, s49, s48
    v_mov_b32 v136, s48
    s_waitcnt lgkmcnt(7)
    v_lshlrev_b32 v140, 16, v104
    v_and_b32 v141, 0xffff0000, v104
    s_waitcnt lgkmcnt(6)
    v_lshlrev_b32 v144, 16, v112
    v_and_b32 v145, 0xffff0000, v112
    v_lshlrev_b32 v142, 16, v105
    v_and_b32 v143, 0xffff0000, v105
    v_lshlrev_b32 v146, 16, v113
    v_and_b32 v147, 0xffff0000, v113
    s_waitcnt lgkmcnt(5)
    v_lshlrev_b32 v148, 16, v106
    v_and_b32 v149, 0xffff0000, v106
    s_waitcnt lgkmcnt(4)
    v_lshlrev_b32 v152, 16, v114
    v_and_b32 v153, 0xffff0000, v114
    v_lshlrev_b32 v150, 16, v107
    v_and_b32 v151, 0xffff0000, v107
    v_lshlrev_b32 v154, 16, v115
    v_and_b32 v155, 0xffff0000, v115
    s_waitcnt lgkmcnt(3)
    v_lshlrev_b32 v156, 16, v108
    v_and_b32 v157, 0xffff0000, v108
    s_waitcnt lgkmcnt(2)
    v_lshlrev_b32 v160, 16, v116
    v_and_b32 v161, 0xffff0000, v116
    v_lshlrev_b32 v158, 16, v109
    v_and_b32 v159, 0xffff0000, v109
    v_lshlrev_b32 v162, 16, v117
    v_and_b32 v163, 0xffff0000, v117
    s_waitcnt lgkmcnt(1)
    v_lshlrev_b32 v164, 16, v110
    v_and_b32 v165, 0xffff0000, v110
    s_waitcnt lgkmcnt(0)
    v_lshlrev_b32 v168, 16, v118
    v_and_b32 v169, 0xffff0000, v118
    v_lshlrev_b32 v166, 16, v111
    v_and_b32 v167, 0xffff0000, v111
    v_lshlrev_b32 v170, 16, v119
    v_and_b32 v171, 0xffff0000, v119
    v_pk_fma_f32 v[72:73], v[140:141], v[136:137], v[72:73] op_sel:[0,0,0] op_sel_hi:[1,0,1]
    v_pk_fma_f32 v[74:75], v[142:143], v[136:137], v[74:75] op_sel:[0,0,0] op_sel_hi:[1,0,1]
    v_pk_fma_f32 v[76:77], v[148:149], v[136:137], v[76:77] op_sel:[0,0,0] op_sel_hi:[1,0,1]
    v_pk_fma_f32 v[78:79], v[150:151], v[136:137], v[78:79] op_sel:[0,0,0] op_sel_hi:[1,0,1]
    v_pk_fma_f32 v[80:81], v[156:157], v[136:137], v[80:81] op_sel:[0,0,0] op_sel_hi:[1,0,1]
    v_pk_fma_f32 v[82:83], v[158:159], v[136:137], v[82:83] op_sel:[0,0,0] op_sel_hi:[1,0,1]
    v_pk_fma_f32 v[84:85], v[164:165], v[136:137], v[84:85] op_sel:[0,0,0] op_sel_hi:[1,0,1]
    v_pk_fma_f32 v[86:87], v[166:167], v[136:137], v[86:87] op_sel:[0,0,0] op_sel_hi:[1,0,1]
    v_pk_add_f32 v[72:73], v[72:73], v[144:145]
    v_pk_add_f32 v[74:75], v[74:75], v[146:147]
    v_pk_add_f32 v[76:77], v[76:77], v[152:153]
    v_pk_add_f32 v[78:79], v[78:79], v[154:155]
    v_pk_add_f32 v[80:81], v[80:81], v[160:161]
    v_pk_add_f32 v[82:83], v[82:83], v[162:163]
    v_pk_add_f32 v[84:85], v[84:85], v[168:169]
    v_pk_add_f32 v[86:87], v[86:87], v[170:171]
    v_cvt_pk_bf16_f32 v120, v72, v73
    v_cvt_pk_bf16_f32 v121, v74, v75
    ds_write_b64 v18, v[120:121] offset:34816
    v_cvt_pk_bf16_f32 v122, v76, v77
    v_cvt_pk_bf16_f32 v123, v78, v79
    ds_write_b64 v18, v[122:123] offset:35328
    v_cvt_pk_bf16_f32 v124, v80, v81
    v_cvt_pk_bf16_f32 v125, v82, v83
    ds_write_b64 v18, v[124:125] offset:35840
    v_cvt_pk_bf16_f32 v126, v84, v85
    v_cvt_pk_bf16_f32 v127, v86, v87
    ds_write_b64 v18, v[126:127] offset:36352
BL1_JOIN:
    s_waitcnt lgkmcnt(0)
    s_barrier
    ds_read_b32 v24, v19 offset:34816
    ds_read_b32 v25, v19 offset:36864
    ds_read_b32 v26, v19 offset:38912
    ds_read_b32 v27, v19 offset:40960
    s_mov_b32 s12, s66
    s_mov_b32 s13, s67
    s_mov_b32 s14, 2097152
    s_mov_b32 s15, 0x20000
    s_mov_b32 s46, 0x05040100
    s_mov_b32 s47, 0x07060302
    s_waitcnt lgkmcnt(0)
    v_perm_b32 v28, v25, v24, s46
    v_perm_b32 v29, v27, v26, s46
    v_perm_b32 v30, v25, v24, s47
    v_perm_b32 v31, v27, v26, s47
    buffer_store_dwordx2 v[28:29], v10, s[12:15], s54 offen
    buffer_store_dwordx2 v[30:31], v10, s[12:15], s54 offen offset:1024
    s_cmp_lg_u32 s2, 0
    s_cbranch_scc1 PK_FIN
    s_cmp_lg_u32 s28, 0
    s_cbranch_scc1 PK_FIN
    v_mov_b32 v4, s34
    v_mov_b32 v5, 0
    s_mov_b64 exec, 1
    global_store_dword v5, v4, s[8:9] sc1
    s_mov_b64 exec, -1
PK_FIN:
PK_END:
    s_endpgm
.section .rodata,"a"
.p2align 6
.amdhsa_kernel interleave_layers__sliding_local_dilated__ssm_conv_s4d__prompt_kernel
  .amdhsa_next_free_vgpr 256
  .amdhsa_next_free_sgpr 102
  .amdhsa_accum_offset 256
  .amdhsa_group_segment_fixed_size 0
  .amdhsa_kernarg_size 104
  .amdhsa_user_sgpr_count 2
  .amdhsa_user_sgpr_kernarg_segment_ptr 1
  .amdhsa_system_sgpr_workgroup_id_x 1
.end_amdhsa_kernel
```
